```python
import torch

def _softmax(x, axis=-1):
    return torch.softmax(x, dim=axis)
def _gelu(x):
    return torch.nn.functional.gelu(x, approximate="tanh")
def _silu(x):
    return torch.nn.functional.silu(x)
def _sigmoid(x):
    return torch.sigmoid(x)
def _layernorm(x, axis=-1, eps=1e-5):
    m = x.mean(dim=axis, keepdim=True)
    v = x.var(dim=axis, keepdim=True, unbiased=False)
    return (x - m) / torch.sqrt(v + eps)
def _scatter_add(tgt, idx, src, axis=0):
    return tgt.clone().index_add_(axis, idx, src)
def _segment_sum(src, seg, n):
    out = torch.zeros((n,) + src.shape[1:], dtype=src.dtype)
    return out.index_add_(0, seg, src)
def _pad(x, pw):
    flat = tuple(v for pair in reversed(pw) for v in pair)
    return torch.nn.functional.pad(x, flat)

kernel_name = 'interleave_layers__spectral_gfnet__softmax_full_mha__prompt'

def setup_inputs():

    _w = (lambda a: (lambda t: t.to(torch.bfloat16) if t.is_floating_point() else t)(torch.as_tensor(a)))
    def _A_setup():
        B, S, D = 1, 2048, 640
        Df = D // 2 + 1
        return {
            "x": _w((lambda *s: torch.randn(*s, dtype=torch.bfloat16) * 0.05)(B, S, D)),
            "w_r": _w((lambda *s: torch.randn(*s, dtype=torch.bfloat16) * 1.6)(S, Df) * 0.02),
            "w_i": _w((lambda *s: torch.randn(*s, dtype=torch.bfloat16) * 1.6)(S, Df) * 0.02),
        }
    _A_in = _A_setup()

    def _B_setup():
        B, S, D = 1, 2048, 640
        return {
            "x": _w((lambda *s: torch.randn(*s, dtype=torch.bfloat16) * 0.05)(B, S, D)),
            "wqkv": _w((lambda *s: torch.randn(*s, dtype=torch.bfloat16) * 0.05)(D, 3 * D)),
            "wo": _w((lambda *s: torch.randn(*s, dtype=torch.bfloat16) * 0.05)(D, D)),
        }
    _B_in = _B_setup()

    return {
        "A_x": _A_in["x"],
        "A_w_r": _A_in["w_r"],
        "A_w_i": _A_in["w_i"],
        "B_x": _B_in["x"],
        "B_wqkv": _B_in["wqkv"],
        "B_wo": _B_in["wo"],
    }

def reference(A_x, A_w_r, A_w_i, B_x, B_wqkv, B_wo):
    def _A_ref(x, w_r, w_i):
        B, S, D = x.shape
        X = (lambda x, axes=(-2,-1): torch.fft.rfft2(x.float(), dim=axes))(x, axes=(-2, -1))
        W = w_r + 1j * w_i
        X = X * W
        y = (lambda x, s, axes=(-2,-1): torch.fft.irfft2(x, s=s, dim=axes).to(torch.bfloat16))(X, (S, D), axes=(-2, -1))
        return y

    def _B_ref(x, wqkv, wo):
        B, S, D = x.shape
        H = 32; Dh = D // H
        qkv = (lambda x, *d: x.permute(*d))((x @ wqkv).reshape(B, S, 3, H, Dh), 2, 0, 3, 1, 4)
        q, k, v = qkv[0], qkv[1], qkv[2]
        scale = Dh ** -0.5
        scores = torch.einsum("bhqd,bhkd->bhqk", q, k) * scale
        p = _softmax(scores, axis=-1)
        o = torch.einsum("bhqk,bhkd->bhqd", p, v)
        return (lambda x, *d: x.permute(*d))(o, 0, 2, 1, 3).reshape(B, S, D) @ wo

    x = A_x
    x = x + _A_ref(_layernorm(x, axis=-1), A_w_r, A_w_i)
    x = x + _B_ref(_layernorm(x, axis=-1), B_wqkv, B_wo)
    x = x + _A_ref(_layernorm(x, axis=-1), A_w_r, A_w_i)
    x = x + _B_ref(_layernorm(x, axis=-1), B_wqkv, B_wo)
    return x
```

```asm
; @launch kernel=k1_kernel grid=(256,1,1) block=(512,1,1) lds=92160
; @launch kernel=k2_kernel grid=(512,1,1) block=(256,1,1) lds=81920
; @launch kernel=k3_kernel grid=(252,1,1) block=(512,1,1) lds=149504
; @launch kernel=k4_kernel grid=(256,1,1) block=(512,1,1) lds=163840
; @launch kernel=k6_kernel grid=(420,1,1) block=(256,1,1) lds=16384
; @launch kernel=k7_kernel grid=(256,1,1) block=(512,1,1) lds=149504
; @launch kernel=k4_kernel grid=(256,1,1) block=(512,1,1) lds=163840
.amdgcn_target "amdgcn-amd-amdhsa--gfx950"
.text
.globl k1_kernel
.p2align 8
.type k1_kernel,@function
k1_kernel:
    s_cmp_lt_u32 s2, 256
    s_cbranch_scc1 L_k1_kernel_1
    s_endpgm
L_k1_kernel_1:
    s_load_dwordx16 s[8:23], s[0:1], 0
    s_load_dwordx2 s[24:25], s[0:1], 64
    v_lshrrev_b32 v1, 6, v0
    v_and_b32 v0, 63, v0
    s_nop 0
    v_readfirstlane_b32 s3, v1
    s_sub_u32 s55, s3, 4
    s_lshr_b32 s54, s2, 3
    s_cmp_lt_u32 s55, 2
    s_cselect_b32 s54, s54, 99
    s_lshl1_add_u32 s55, s54, s55
    s_lshl_b32 s58, s55, 10
    s_cmp_ge_u32 s58, code_end-k1_kernel
    s_cbranch_scc1 L_k1_kernel_8
    s_getpc_b64 s[56:57]
L_k1_kernel_7:
    s_add_u32 s56, s56, k1_kernel-L_k1_kernel_7
    s_addc_u32 s57, s57, -1
    v_lshl_add_u32 v12, v0, 4, s58
    v_min_u32 v12, code_end-k1_kernel-16, v12
    global_load_dwordx4 v[12:15], v12, s[56:57]
L_k1_kernel_8:
    s_and_b32 s27, s2, 7
    s_lshl_b32 s27, s27, 3
    s_lshr_b32 s32, s2, 5
    s_or_b32 s27, s27, s32
    s_bfe_u32 s33, s2, 0x20003
    s_mov_b32 s38, 0
    v_lshlrev_b32 v4, 4, v0
    v_and_b32 v1, 15, v0
    v_lshrrev_b32 v2, 4, v0
    s_cmp_lt_u32 s3, 4
    s_cbranch_scc1 L_k1_kernel_9
    s_sub_u32 s32, s3, 3
    s_mul_i32 s38, s33, 5
    s_add_u32 s38, s38, s32
    v_and_b32 v136, 15, v0
    s_lshl_b32 s40, s32, 4
    v_add_u32 v136, s40, v136
    v_lshlrev_b32 v136, 2, v136
    v_add_u32 v136, s33, v136
    v_cmp_eq_u32 vcc, 0, v136
    v_mov_b32 v137, 320
    v_mov_b32 v138, 0x3e000000
    v_cndmask_b32 v136, v136, v137, vcc
    v_cndmask_b32 v138, 0, v138, vcc
    s_mov_b64 s[42:43], vcc
    v_cvt_f32_u32 v136, v136
    v_mul_f32 v136, 0x3acccccd, v136
    v_lshrrev_b32 v137, 4, v0
    v_lshlrev_b32 v137, 3, v137
    v_cvt_f32_u32 v137, v137
    v_fma_f32 v137, v137, v136, v138
    v_mul_f32 v140, 0x42000000, v136
    v_cos_f32 v138, v136
    v_cos_f32 v140, v140
    v_fmamk_f32 v142, v136, 0x3f800000, v137
    v_fmamk_f32 v143, v136, 0x42000000, v137
    v_fmamk_f32 v144, v136, 0x42040000, v137
    v_cos_f32 v16, v137
    v_sin_f32_e64 v24, -v137
    v_cos_f32 v17, v142
    v_sin_f32_e64 v25, -v142
    v_cos_f32 v32, v143
    v_sin_f32_e64 v40, -v143
    v_cos_f32 v33, v144
    v_sin_f32_e64 v41, -v144
    v_add_f32 v138, v138, v138
    v_add_f32 v140, v140, v140
    v_fma_f32 v18, v138, v17, -v16
    v_fma_f32 v26, v138, v25, -v24
    v_fma_f32 v34, v138, v33, -v32
    v_fma_f32 v42, v138, v41, -v40
    v_fma_f32 v19, v138, v18, -v17
    v_fma_f32 v27, v138, v26, -v25
    v_fma_f32 v35, v138, v34, -v33
    v_fma_f32 v43, v138, v42, -v41
    v_fma_f32 v20, v138, v19, -v18
    v_fma_f32 v28, v138, v27, -v26
    v_fma_f32 v36, v138, v35, -v34
    v_fma_f32 v44, v138, v43, -v42
    v_fma_f32 v21, v138, v20, -v19
    v_fma_f32 v29, v138, v28, -v27
    v_fma_f32 v37, v138, v36, -v35
    v_fma_f32 v45, v138, v44, -v43
    v_fma_f32 v22, v138, v21, -v20
    v_fma_f32 v30, v138, v29, -v28
    v_fma_f32 v38, v138, v37, -v36
    v_fma_f32 v46, v138, v45, -v44
    v_fma_f32 v23, v138, v22, -v21
    v_fma_f32 v31, v138, v30, -v29
    v_fma_f32 v39, v138, v38, -v37
    v_fma_f32 v47, v138, v46, -v45
    v_cvt_pk_bf16_f32 v96, v16, v17
    v_cvt_pk_bf16_f32 v97, v18, v19
    v_cvt_pk_bf16_f32 v98, v20, v21
    v_cvt_pk_bf16_f32 v99, v22, v23
    v_cvt_pk_bf16_f32 v116, v24, v25
    v_cvt_pk_bf16_f32 v117, v26, v27
    v_cvt_pk_bf16_f32 v118, v28, v29
    v_cvt_pk_bf16_f32 v119, v30, v31
    v_cvt_pk_bf16_f32 v100, v32, v33
    v_cvt_pk_bf16_f32 v101, v34, v35
    v_cvt_pk_bf16_f32 v102, v36, v37
    v_cvt_pk_bf16_f32 v103, v38, v39
    v_cvt_pk_bf16_f32 v120, v40, v41
    v_cvt_pk_bf16_f32 v121, v42, v43
    v_cvt_pk_bf16_f32 v122, v44, v45
    v_cvt_pk_bf16_f32 v123, v46, v47
    v_pk_fma_f32 v[48:49], v[140:141], v[32:33], v[16:17] op_sel_hi:[0,1,1] neg_lo:[0,0,1] neg_hi:[0,0,1]
    v_pk_fma_f32 v[50:51], v[140:141], v[34:35], v[18:19] op_sel_hi:[0,1,1] neg_lo:[0,0,1] neg_hi:[0,0,1]
    v_pk_fma_f32 v[52:53], v[140:141], v[36:37], v[20:21] op_sel_hi:[0,1,1] neg_lo:[0,0,1] neg_hi:[0,0,1]
    v_pk_fma_f32 v[54:55], v[140:141], v[38:39], v[22:23] op_sel_hi:[0,1,1] neg_lo:[0,0,1] neg_hi:[0,0,1]
    v_pk_fma_f32 v[56:57], v[140:141], v[40:41], v[24:25] op_sel_hi:[0,1,1] neg_lo:[0,0,1] neg_hi:[0,0,1]
    v_pk_fma_f32 v[58:59], v[140:141], v[42:43], v[26:27] op_sel_hi:[0,1,1] neg_lo:[0,0,1] neg_hi:[0,0,1]
    v_pk_fma_f32 v[60:61], v[140:141], v[44:45], v[28:29] op_sel_hi:[0,1,1] neg_lo:[0,0,1] neg_hi:[0,0,1]
    v_pk_fma_f32 v[62:63], v[140:141], v[46:47], v[30:31] op_sel_hi:[0,1,1] neg_lo:[0,0,1] neg_hi:[0,0,1]
    v_cvt_pk_bf16_f32 v104, v48, v49
    v_cvt_pk_bf16_f32 v105, v50, v51
    v_cvt_pk_bf16_f32 v106, v52, v53
    v_cvt_pk_bf16_f32 v107, v54, v55
    v_cvt_pk_bf16_f32 v124, v56, v57
    v_cvt_pk_bf16_f32 v125, v58, v59
    v_cvt_pk_bf16_f32 v126, v60, v61
    v_cvt_pk_bf16_f32 v127, v62, v63
    v_pk_fma_f32 v[16:17], v[140:141], v[48:49], v[32:33] op_sel_hi:[0,1,1] neg_lo:[0,0,1] neg_hi:[0,0,1]
    v_pk_fma_f32 v[18:19], v[140:141], v[50:51], v[34:35] op_sel_hi:[0,1,1] neg_lo:[0,0,1] neg_hi:[0,0,1]
    v_pk_fma_f32 v[20:21], v[140:141], v[52:53], v[36:37] op_sel_hi:[0,1,1] neg_lo:[0,0,1] neg_hi:[0,0,1]
    v_pk_fma_f32 v[22:23], v[140:141], v[54:55], v[38:39] op_sel_hi:[0,1,1] neg_lo:[0,0,1] neg_hi:[0,0,1]
    v_pk_fma_f32 v[24:25], v[140:141], v[56:57], v[40:41] op_sel_hi:[0,1,1] neg_lo:[0,0,1] neg_hi:[0,0,1]
    v_pk_fma_f32 v[26:27], v[140:141], v[58:59], v[42:43] op_sel_hi:[0,1,1] neg_lo:[0,0,1] neg_hi:[0,0,1]
    v_pk_fma_f32 v[28:29], v[140:141], v[60:61], v[44:45] op_sel_hi:[0,1,1] neg_lo:[0,0,1] neg_hi:[0,0,1]
    v_pk_fma_f32 v[30:31], v[140:141], v[62:63], v[46:47] op_sel_hi:[0,1,1] neg_lo:[0,0,1] neg_hi:[0,0,1]
    v_cvt_pk_bf16_f32 v108, v16, v17
    v_cvt_pk_bf16_f32 v109, v18, v19
    v_cvt_pk_bf16_f32 v110, v20, v21
    v_cvt_pk_bf16_f32 v111, v22, v23
    v_cvt_pk_bf16_f32 v128, v24, v25
    v_cvt_pk_bf16_f32 v129, v26, v27
    v_cvt_pk_bf16_f32 v130, v28, v29
    v_cvt_pk_bf16_f32 v131, v30, v31
    v_pk_fma_f32 v[32:33], v[140:141], v[16:17], v[48:49] op_sel_hi:[0,1,1] neg_lo:[0,0,1] neg_hi:[0,0,1]
    v_pk_fma_f32 v[34:35], v[140:141], v[18:19], v[50:51] op_sel_hi:[0,1,1] neg_lo:[0,0,1] neg_hi:[0,0,1]
    v_pk_fma_f32 v[36:37], v[140:141], v[20:21], v[52:53] op_sel_hi:[0,1,1] neg_lo:[0,0,1] neg_hi:[0,0,1]
    v_pk_fma_f32 v[38:39], v[140:141], v[22:23], v[54:55] op_sel_hi:[0,1,1] neg_lo:[0,0,1] neg_hi:[0,0,1]
    v_pk_fma_f32 v[40:41], v[140:141], v[24:25], v[56:57] op_sel_hi:[0,1,1] neg_lo:[0,0,1] neg_hi:[0,0,1]
    v_pk_fma_f32 v[42:43], v[140:141], v[26:27], v[58:59] op_sel_hi:[0,1,1] neg_lo:[0,0,1] neg_hi:[0,0,1]
    v_pk_fma_f32 v[44:45], v[140:141], v[28:29], v[60:61] op_sel_hi:[0,1,1] neg_lo:[0,0,1] neg_hi:[0,0,1]
    v_pk_fma_f32 v[46:47], v[140:141], v[30:31], v[62:63] op_sel_hi:[0,1,1] neg_lo:[0,0,1] neg_hi:[0,0,1]
    v_cvt_pk_bf16_f32 v112, v32, v33
    v_cvt_pk_bf16_f32 v113, v34, v35
    v_cvt_pk_bf16_f32 v114, v36, v37
    v_cvt_pk_bf16_f32 v115, v38, v39
    v_cvt_pk_bf16_f32 v132, v40, v41
    v_cvt_pk_bf16_f32 v133, v42, v43
    v_cvt_pk_bf16_f32 v134, v44, v45
    v_cvt_pk_bf16_f32 v135, v46, v47
    s_cmp_lg_u32 s38, 0
    s_cbranch_scc1 L_k1_kernel_10
    s_mov_b64 exec, s[42:43]
    v_mov_b32 v116, 0x3f353f35
    v_mov_b32 v117, 0x3f353f35
    v_mov_b32 v118, 0x3f353f35
    v_mov_b32 v119, 0x3f353f35
    v_mov_b32 v120, 0x3f353f35
    v_mov_b32 v121, 0x3f353f35
    v_mov_b32 v122, 0x3f353f35
    v_mov_b32 v123, 0x3f353f35
    v_mov_b32 v124, 0x3f353f35
    v_mov_b32 v125, 0x3f353f35
    v_mov_b32 v126, 0x3f353f35
    v_mov_b32 v127, 0x3f353f35
    v_mov_b32 v128, 0x3f353f35
    v_mov_b32 v129, 0x3f353f35
    v_mov_b32 v130, 0x3f353f35
    v_mov_b32 v131, 0x3f353f35
    v_mov_b32 v132, 0x3f353f35
    v_mov_b32 v133, 0x3f353f35
    v_mov_b32 v134, 0x3f353f35
    v_mov_b32 v135, 0x3f353f35
    s_mov_b64 exec, -1
L_k1_kernel_10:
    s_mul_i32 s32, s32, 10240
    v_add_u32 v6, s32, v4
    ds_write_b128 v6, v[96:99] offset:0
    ds_write_b128 v6, v[116:119] offset:1024
    ds_write_b128 v6, v[100:103] offset:2048
    ds_write_b128 v6, v[120:123] offset:3072
    ds_write_b128 v6, v[104:107] offset:4096
    ds_write_b128 v6, v[124:127] offset:5120
    ds_write_b128 v6, v[108:111] offset:6144
    ds_write_b128 v6, v[128:131] offset:7168
    ds_write_b128 v6, v[112:115] offset:8192
    ds_write_b128 v6, v[132:135] offset:9216
L_k1_kernel_9:
    s_cmp_ge_u32 s3, 4
    s_cbranch_scc1 L_k1_kernel_6
    v_lshrrev_b32 v5, 3, v0
    v_and_b32 v6, 7, v0
    v_mul_u32_u24 v3, 40960, v5
    v_lshrrev_b32 v5, 1, v5
    s_and_b32 s35, s3, 1
    s_lshl_b32 s36, s35, 2
    v_xor_b32 v5, s36, v5
    s_and_b32 s34, s27, 1
    s_lshl2_add_u32 s34, s34, s3
    s_mul_i32 s34, s34, 327680
    s_lshr_b32 s36, s27, 1
    s_mul_i32 s36, s36, 1280
    s_add_u32 s34, s34, s36
    s_lshr_b32 s36, s3, 1
    s_mul_i32 s36, s36, 20480
    s_lshl_b32 s35, s35, 10
    s_add_u32 s36, s36, s35
    s_add_u32 m0, s36, 51200
    s_movk_i32 s51, 128
    s_movk_i32 s52, 2048
    s_mov_b32 s30, 2621440
    s_branch L_k1_kernel_2
L_k1_kernel_6:
    v_lshrrev_b32 v5, 3, v0
    v_mul_u32_u24 v3, 3840, v5
    v_and_b32 v6, 7, v0
    v_mov_b32 v5, 0
    s_bfe_u32 s35, s2, 0x30003
    s_mul_i32 s34, s35, 307200
    s_lshr_b32 s35, s2, 6
    s_lshl_b32 s35, s35, 3
    s_and_b32 s36, s2, 7
    s_add_u32 s35, s35, s36
    s_lshl_b32 s36, s35, 7
    s_add_u32 s34, s34, s36
    s_mov_b32 s30, 2457600
    s_cmp_ge_u32 s35, 30
    s_cselect_b32 s30, 0, s30
L_k1_kernel_2:
    v_xor_b32 v5, v5, v6
    v_lshl_add_u32 v3, v5, 4, v3
    s_mov_b32 s31, 0x00020000
    s_waitcnt lgkmcnt(0)
    s_mov_b32 s4, s24
    s_and_b32 s5, s25, 0xffff
    s_mov_b32 s6, 30408704
    s_mov_b32 s7, 0x00020000
    s_cmp_lt_u32 s3, 4
    s_cselect_b32 s28, s8, s16
    s_cselect_b32 s29, s9, s17
    s_and_b32 s29, s29, 0xffff
    s_cmp_ge_u32 s3, 4
    s_cbranch_scc1 L_k1_kernel_3
    buffer_load_dwordx4 v3, s[28:31], s34 offen lds
    s_add_u32 m0, m0, s52
    s_add_u32 s34, s34, s51
    buffer_load_dwordx4 v3, s[28:31], s34 offen lds
    s_add_u32 m0, m0, s52
    s_add_u32 s34, s34, s51
    buffer_load_dwordx4 v3, s[28:31], s34 offen lds
    s_add_u32 m0, m0, s52
    s_add_u32 s34, s34, s51
    buffer_load_dwordx4 v3, s[28:31], s34 offen lds
    s_add_u32 m0, m0, s52
    s_add_u32 s34, s34, s51
    buffer_load_dwordx4 v3, s[28:31], s34 offen lds
    s_add_u32 m0, m0, s52
    s_add_u32 s34, s34, s51
    buffer_load_dwordx4 v3, s[28:31], s34 offen lds
    s_add_u32 m0, m0, s52
    s_add_u32 s34, s34, s51
    buffer_load_dwordx4 v3, s[28:31], s34 offen lds
    s_add_u32 m0, m0, s52
    s_add_u32 s34, s34, s51
    buffer_load_dwordx4 v3, s[28:31], s34 offen lds
    s_add_u32 m0, m0, s52
    s_add_u32 s34, s34, s51
    buffer_load_dwordx4 v3, s[28:31], s34 offen lds
    s_add_u32 m0, m0, s52
    s_add_u32 s34, s34, s51
    buffer_load_dwordx4 v3, s[28:31], s34 offen lds
    s_cmp_lg_u32 s3, 3
    s_cbranch_scc1 L_k1_kernel_11
    s_sub_u32 s32, s3, 3
    s_mul_i32 s38, s33, 5
    s_add_u32 s38, s38, s32
    v_and_b32 v136, 15, v0
    s_lshl_b32 s40, s32, 4
    v_add_u32 v136, s40, v136
    v_lshlrev_b32 v136, 2, v136
    v_add_u32 v136, s33, v136
    v_cmp_eq_u32 vcc, 0, v136
    v_mov_b32 v137, 320
    v_mov_b32 v138, 0x3e000000
    v_cndmask_b32 v136, v136, v137, vcc
    v_cndmask_b32 v138, 0, v138, vcc
    s_mov_b64 s[42:43], vcc
    v_cvt_f32_u32 v136, v136
    v_mul_f32 v136, 0x3acccccd, v136
    v_lshrrev_b32 v137, 4, v0
    v_lshlrev_b32 v137, 3, v137
    v_cvt_f32_u32 v137, v137
    v_fma_f32 v137, v137, v136, v138
    v_mul_f32 v140, 0x42000000, v136
    v_cos_f32 v138, v136
    v_cos_f32 v140, v140
    v_fmamk_f32 v142, v136, 0x3f800000, v137
    v_fmamk_f32 v143, v136, 0x42000000, v137
    v_fmamk_f32 v144, v136, 0x42040000, v137
    v_cos_f32 v16, v137
    v_sin_f32_e64 v24, -v137
    v_cos_f32 v17, v142
    v_sin_f32_e64 v25, -v142
    v_cos_f32 v32, v143
    v_sin_f32_e64 v40, -v143
    v_cos_f32 v33, v144
    v_sin_f32_e64 v41, -v144
    v_add_f32 v138, v138, v138
    v_add_f32 v140, v140, v140
    v_fma_f32 v18, v138, v17, -v16
    v_fma_f32 v26, v138, v25, -v24
    v_fma_f32 v34, v138, v33, -v32
    v_fma_f32 v42, v138, v41, -v40
    v_fma_f32 v19, v138, v18, -v17
    v_fma_f32 v27, v138, v26, -v25
    v_fma_f32 v35, v138, v34, -v33
    v_fma_f32 v43, v138, v42, -v41
    v_fma_f32 v20, v138, v19, -v18
    v_fma_f32 v28, v138, v27, -v26
    v_fma_f32 v36, v138, v35, -v34
    v_fma_f32 v44, v138, v43, -v42
    v_fma_f32 v21, v138, v20, -v19
    v_fma_f32 v29, v138, v28, -v27
    v_fma_f32 v37, v138, v36, -v35
    v_fma_f32 v45, v138, v44, -v43
    v_fma_f32 v22, v138, v21, -v20
    v_fma_f32 v30, v138, v29, -v28
    v_fma_f32 v38, v138, v37, -v36
    v_fma_f32 v46, v138, v45, -v44
    v_fma_f32 v23, v138, v22, -v21
    v_fma_f32 v31, v138, v30, -v29
    v_fma_f32 v39, v138, v38, -v37
    v_fma_f32 v47, v138, v46, -v45
    v_cvt_pk_bf16_f32 v96, v16, v17
    v_cvt_pk_bf16_f32 v97, v18, v19
    v_cvt_pk_bf16_f32 v98, v20, v21
    v_cvt_pk_bf16_f32 v99, v22, v23
    v_cvt_pk_bf16_f32 v116, v24, v25
    v_cvt_pk_bf16_f32 v117, v26, v27
    v_cvt_pk_bf16_f32 v118, v28, v29
    v_cvt_pk_bf16_f32 v119, v30, v31
    v_cvt_pk_bf16_f32 v100, v32, v33
    v_cvt_pk_bf16_f32 v101, v34, v35
    v_cvt_pk_bf16_f32 v102, v36, v37
    v_cvt_pk_bf16_f32 v103, v38, v39
    v_cvt_pk_bf16_f32 v120, v40, v41
    v_cvt_pk_bf16_f32 v121, v42, v43
    v_cvt_pk_bf16_f32 v122, v44, v45
    v_cvt_pk_bf16_f32 v123, v46, v47
    v_pk_fma_f32 v[48:49], v[140:141], v[32:33], v[16:17] op_sel_hi:[0,1,1] neg_lo:[0,0,1] neg_hi:[0,0,1]
    v_pk_fma_f32 v[50:51], v[140:141], v[34:35], v[18:19] op_sel_hi:[0,1,1] neg_lo:[0,0,1] neg_hi:[0,0,1]
    v_pk_fma_f32 v[52:53], v[140:141], v[36:37], v[20:21] op_sel_hi:[0,1,1] neg_lo:[0,0,1] neg_hi:[0,0,1]
    v_pk_fma_f32 v[54:55], v[140:141], v[38:39], v[22:23] op_sel_hi:[0,1,1] neg_lo:[0,0,1] neg_hi:[0,0,1]
    v_pk_fma_f32 v[56:57], v[140:141], v[40:41], v[24:25] op_sel_hi:[0,1,1] neg_lo:[0,0,1] neg_hi:[0,0,1]
    v_pk_fma_f32 v[58:59], v[140:141], v[42:43], v[26:27] op_sel_hi:[0,1,1] neg_lo:[0,0,1] neg_hi:[0,0,1]
    v_pk_fma_f32 v[60:61], v[140:141], v[44:45], v[28:29] op_sel_hi:[0,1,1] neg_lo:[0,0,1] neg_hi:[0,0,1]
    v_pk_fma_f32 v[62:63], v[140:141], v[46:47], v[30:31] op_sel_hi:[0,1,1] neg_lo:[0,0,1] neg_hi:[0,0,1]
    v_cvt_pk_bf16_f32 v104, v48, v49
    v_cvt_pk_bf16_f32 v105, v50, v51
    v_cvt_pk_bf16_f32 v106, v52, v53
    v_cvt_pk_bf16_f32 v107, v54, v55
    v_cvt_pk_bf16_f32 v124, v56, v57
    v_cvt_pk_bf16_f32 v125, v58, v59
    v_cvt_pk_bf16_f32 v126, v60, v61
    v_cvt_pk_bf16_f32 v127, v62, v63
    v_pk_fma_f32 v[16:17], v[140:141], v[48:49], v[32:33] op_sel_hi:[0,1,1] neg_lo:[0,0,1] neg_hi:[0,0,1]
    v_pk_fma_f32 v[18:19], v[140:141], v[50:51], v[34:35] op_sel_hi:[0,1,1] neg_lo:[0,0,1] neg_hi:[0,0,1]
    v_pk_fma_f32 v[20:21], v[140:141], v[52:53], v[36:37] op_sel_hi:[0,1,1] neg_lo:[0,0,1] neg_hi:[0,0,1]
    v_pk_fma_f32 v[22:23], v[140:141], v[54:55], v[38:39] op_sel_hi:[0,1,1] neg_lo:[0,0,1] neg_hi:[0,0,1]
    v_pk_fma_f32 v[24:25], v[140:141], v[56:57], v[40:41] op_sel_hi:[0,1,1] neg_lo:[0,0,1] neg_hi:[0,0,1]
    v_pk_fma_f32 v[26:27], v[140:141], v[58:59], v[42:43] op_sel_hi:[0,1,1] neg_lo:[0,0,1] neg_hi:[0,0,1]
    v_pk_fma_f32 v[28:29], v[140:141], v[60:61], v[44:45] op_sel_hi:[0,1,1] neg_lo:[0,0,1] neg_hi:[0,0,1]
    v_pk_fma_f32 v[30:31], v[140:141], v[62:63], v[46:47] op_sel_hi:[0,1,1] neg_lo:[0,0,1] neg_hi:[0,0,1]
    v_cvt_pk_bf16_f32 v108, v16, v17
    v_cvt_pk_bf16_f32 v109, v18, v19
    v_cvt_pk_bf16_f32 v110, v20, v21
    v_cvt_pk_bf16_f32 v111, v22, v23
    v_cvt_pk_bf16_f32 v128, v24, v25
    v_cvt_pk_bf16_f32 v129, v26, v27
    v_cvt_pk_bf16_f32 v130, v28, v29
    v_cvt_pk_bf16_f32 v131, v30, v31
    v_pk_fma_f32 v[32:33], v[140:141], v[16:17], v[48:49] op_sel_hi:[0,1,1] neg_lo:[0,0,1] neg_hi:[0,0,1]
    v_pk_fma_f32 v[34:35], v[140:141], v[18:19], v[50:51] op_sel_hi:[0,1,1] neg_lo:[0,0,1] neg_hi:[0,0,1]
    v_pk_fma_f32 v[36:37], v[140:141], v[20:21], v[52:53] op_sel_hi:[0,1,1] neg_lo:[0,0,1] neg_hi:[0,0,1]
    v_pk_fma_f32 v[38:39], v[140:141], v[22:23], v[54:55] op_sel_hi:[0,1,1] neg_lo:[0,0,1] neg_hi:[0,0,1]
    v_pk_fma_f32 v[40:41], v[140:141], v[24:25], v[56:57] op_sel_hi:[0,1,1] neg_lo:[0,0,1] neg_hi:[0,0,1]
    v_pk_fma_f32 v[42:43], v[140:141], v[26:27], v[58:59] op_sel_hi:[0,1,1] neg_lo:[0,0,1] neg_hi:[0,0,1]
    v_pk_fma_f32 v[44:45], v[140:141], v[28:29], v[60:61] op_sel_hi:[0,1,1] neg_lo:[0,0,1] neg_hi:[0,0,1]
    v_pk_fma_f32 v[46:47], v[140:141], v[30:31], v[62:63] op_sel_hi:[0,1,1] neg_lo:[0,0,1] neg_hi:[0,0,1]
    v_cvt_pk_bf16_f32 v112, v32, v33
    v_cvt_pk_bf16_f32 v113, v34, v35
    v_cvt_pk_bf16_f32 v114, v36, v37
    v_cvt_pk_bf16_f32 v115, v38, v39
    v_cvt_pk_bf16_f32 v132, v40, v41
    v_cvt_pk_bf16_f32 v133, v42, v43
    v_cvt_pk_bf16_f32 v134, v44, v45
    v_cvt_pk_bf16_f32 v135, v46, v47
    s_cmp_lg_u32 s38, 0
    s_cbranch_scc1 L_k1_kernel_12
    s_mov_b64 exec, s[42:43]
    v_mov_b32 v116, 0x3f353f35
    v_mov_b32 v117, 0x3f353f35
    v_mov_b32 v118, 0x3f353f35
    v_mov_b32 v119, 0x3f353f35
    v_mov_b32 v120, 0x3f353f35
    v_mov_b32 v121, 0x3f353f35
    v_mov_b32 v122, 0x3f353f35
    v_mov_b32 v123, 0x3f353f35
    v_mov_b32 v124, 0x3f353f35
    v_mov_b32 v125, 0x3f353f35
    v_mov_b32 v126, 0x3f353f35
    v_mov_b32 v127, 0x3f353f35
    v_mov_b32 v128, 0x3f353f35
    v_mov_b32 v129, 0x3f353f35
    v_mov_b32 v130, 0x3f353f35
    v_mov_b32 v131, 0x3f353f35
    v_mov_b32 v132, 0x3f353f35
    v_mov_b32 v133, 0x3f353f35
    v_mov_b32 v134, 0x3f353f35
    v_mov_b32 v135, 0x3f353f35
    s_mov_b64 exec, -1
L_k1_kernel_12:
    s_mul_i32 s32, s32, 10240
    v_add_u32 v6, s32, v4
    ds_write_b128 v6, v[96:99] offset:0
    ds_write_b128 v6, v[116:119] offset:1024
    ds_write_b128 v6, v[100:103] offset:2048
    ds_write_b128 v6, v[120:123] offset:3072
    ds_write_b128 v6, v[104:107] offset:4096
    ds_write_b128 v6, v[124:127] offset:5120
    ds_write_b128 v6, v[108:111] offset:6144
    ds_write_b128 v6, v[128:131] offset:7168
    ds_write_b128 v6, v[112:115] offset:8192
    ds_write_b128 v6, v[132:135] offset:9216
L_k1_kernel_11:
    s_and_b32 s35, s3, 1
    s_lshr_b32 s47, s3, 1
    v_lshrrev_b32 v3, 1, v1
    v_xor_b32 v3, v3, v2
    v_lshlrev_b32 v3, 4, v3
    v_lshl_add_u32 v3, v1, 7, v3
    s_mul_i32 s36, s35, 20480
    s_add_u32 s36, s36, 51200
    v_add_u32 v3, s36, v3
    v_xor_b32 v11, 64, v3
    s_lshl1_add_u32 s45, s27, s35
    v_lshrrev_b32 v9, 1, v2
    v_lshlrev_b32 v9, 4, v9
    v_and_b32 v6, 1, v2
    v_lshl_add_u32 v8, v1, 6, v9
    v_lshl_add_u32 v8, v6, 5, v8
    s_mul_i32 s34, s45, 20608
    s_mul_i32 s36, s33, 5120
    s_add_u32 s34, s34, s36
    s_mul_i32 s36, s47, 3072
    s_add_u32 s34, s34, s36
    s_add_u32 s34, s34, 0
    v_mov_b32 v5, 2147483632
    s_add_u32 s36, s33, s47
    v_add_u32 v10, s36, v1
    v_cmp_eq_u32 vcc, 0, v10
    v_lshlrev_b32 v7, 3, v2
    v_add_u32 v7, 32, v7
    v_cndmask_b32 v7, v5, v7, vcc
    v_xor_b32 v6, 1, v6
    v_add_u32 v10, v10, v6
    v_cmp_eq_u32 vcc, 0, v10
    v_add_u32 v10, 20480, v9
    s_nop 0
    v_cndmask_b32 v10, v8, v10, vcc
    s_sub_u32 s34, s34, 1024
    s_mov_b32 s40, 0x3d64f92e
    s_mul_i32 s37, s47, 30720
    v_add_u32 v13, s37, v4
    s_add_u32 s37, s37, 10240
    s_sub_u32 s39, 3, s47
    s_mov_b32 s35, 0
    s_waitcnt vmcnt(0) lgkmcnt(0)
    s_barrier
    s_cmp_lt_u32 s3, 3
    s_cselect_b32 s32, 1, s27
    s_cmp_lg_u32 s32, 63
    s_cbranch_scc1 L_k1_kernel_13
    s_mul_i32 s46, s38, 10240
    s_add_u32 s46, s46, 26279936
    s_add_u32 s41, s46, 4096
    s_add_u32 s42, s46, 8192
    buffer_store_dwordx4 v[96:99], v4, s[4:7], s46 offen offset:0
    buffer_store_dwordx4 v[100:103], v4, s[4:7], s46 offen offset:1024
    buffer_store_dwordx4 v[104:107], v4, s[4:7], s46 offen offset:2048
    buffer_store_dwordx4 v[108:111], v4, s[4:7], s46 offen offset:3072
    buffer_store_dwordx4 v[112:115], v4, s[4:7], s41 offen offset:0
    buffer_store_dwordx4 v[116:119], v4, s[4:7], s41 offen offset:1024
    buffer_store_dwordx4 v[120:123], v4, s[4:7], s41 offen offset:2048
    buffer_store_dwordx4 v[124:127], v4, s[4:7], s41 offen offset:3072
    buffer_store_dwordx4 v[128:131], v4, s[4:7], s42 offen offset:0
    buffer_store_dwordx4 v[132:135], v4, s[4:7], s42 offen offset:1024
L_k1_kernel_13:
    ds_read_b128 v[96:99], v13 offset:0
    ds_read_b128 v[100:103], v13 offset:1024
    ds_read_b128 v[104:107], v13 offset:2048
    ds_read_b128 v[108:111], v13 offset:3072
    ds_read_b128 v[112:115], v13 offset:4096
    ds_read_b128 v[116:119], v13 offset:5120
    ds_read_b128 v[120:123], v13 offset:6144
    ds_read_b128 v[124:127], v13 offset:7168
    ds_read_b128 v[128:131], v13 offset:8192
    ds_read_b128 v[132:135], v13 offset:9216
    ds_read_b128 v[16:19], v3 offset:0
    ds_read_b128 v[36:39], v11 offset:4096
    ds_read_b128 v[56:59], v3 offset:10240
    ds_read_b128 v[76:79], v11 offset:14336
    ds_read_b128 v[20:23], v11 offset:0
    ds_read_b128 v[40:43], v3 offset:6144
    ds_read_b128 v[60:63], v11 offset:10240
    ds_read_b128 v[80:83], v3 offset:16384
    ds_read_b128 v[24:27], v3 offset:2048
    ds_read_b128 v[44:47], v11 offset:6144
    ds_read_b128 v[64:67], v3 offset:12288
    ds_read_b128 v[84:87], v11 offset:16384
    ds_read_b128 v[28:31], v11 offset:2048
    ds_read_b128 v[48:51], v3 offset:8192
    ds_read_b128 v[68:71], v11 offset:12288
    ds_read_b128 v[88:91], v3 offset:18432
    ds_read_b128 v[32:35], v3 offset:4096
    ds_read_b128 v[52:55], v11 offset:8192
    ds_read_b128 v[72:75], v3 offset:14336
    ds_read_b128 v[92:95], v11 offset:18432
    s_cmp_eq_u32 s33, 1
    s_cbranch_scc1 L_k1_kernel_15
    s_cmp_eq_u32 s33, 2
    s_cbranch_scc1 L_k1_kernel_16
    s_cmp_eq_u32 s33, 3
    s_cbranch_scc1 L_k1_kernel_17
L_k1_kernel_14:
L_k1_kernel_18:
    s_waitcnt lgkmcnt(8)
    v_mfma_f32_16x16x32_bf16 v[136:139], v[16:19], v[96:99], 0
    v_add_u32 v13, s37, v4
    v_mfma_f32_16x16x32_bf16 v[140:143], v[56:59], v[96:99], 0
    v_add_f32 v156, v144, v148
    v_add_f32 v157, v145, v149
    v_mfma_f32_16x16x32_bf16 v[136:139], v[36:39], v[96:99], v[136:139]
    v_add_f32 v158, v146, v150
    v_add_f32 v159, v147, v151
    v_mfma_f32_16x16x32_bf16 v[140:143], v[76:79], v[96:99], v[140:143]
    v_mfma_f32_16x16x32_bf16 v[144:147], v[16:19], v[100:103], 0
    s_cmp_lg_u32 s35, 1
    s_cbranch_scc1 L_k1_kernel_19
    v_mov_b32_dpp v164, v156 row_newbcast:0 row_mask:0xf bank_mask:0xf
    v_mov_b32_dpp v165, v157 row_newbcast:0 row_mask:0xf bank_mask:0xf
    v_mov_b32_dpp v166, v158 row_newbcast:0 row_mask:0xf bank_mask:0xf
    v_mov_b32_dpp v167, v159 row_newbcast:0 row_mask:0xf bank_mask:0xf
L_k1_kernel_19:
    v_mfma_f32_16x16x32_bf16 v[148:151], v[56:59], v[100:103], 0
    v_mul_f32 v152, s40, v152
    v_mul_f32 v153, s40, v153
    v_mfma_f32_16x16x32_bf16 v[144:147], v[36:39], v[100:103], v[144:147]
    v_mul_f32 v154, s40, v154
    v_mul_f32 v155, s40, v155
    v_mfma_f32_16x16x32_bf16 v[148:151], v[76:79], v[100:103], v[148:151]
    v_mul_f32 v156, s40, v156
    v_mul_f32 v157, s40, v157
    ds_read_b128 v[96:99], v13 offset:0
    ds_read_b128 v[100:103], v13 offset:1024
    s_waitcnt lgkmcnt(8)
    v_mfma_f32_16x16x32_bf16 v[136:139], v[20:23], v[104:107], v[136:139]
    v_mul_f32 v158, s40, v158
    v_mul_f32 v159, s40, v159
    v_mfma_f32_16x16x32_bf16 v[144:147], v[20:23], v[108:111], v[144:147]
    v_cvt_pk_bf16_f32 v160, v152, v153
    v_cvt_pk_bf16_f32 v161, v154, v155
    v_mfma_f32_16x16x32_bf16 v[140:143], v[60:63], v[104:107], v[140:143]
    v_cvt_pk_bf16_f32 v162, v156, v157
    v_cvt_pk_bf16_f32 v163, v158, v159
    v_mfma_f32_16x16x32_bf16 v[148:151], v[60:63], v[108:111], v[148:151]
    s_nop 1
    v_permlane16_swap_b32 v160, v162
    v_permlane16_swap_b32 v161, v163
    v_mfma_f32_16x16x32_bf16 v[136:139], v[40:43], v[104:107], v[136:139]
    buffer_store_dwordx4 v[160:163], v5, s[4:7], s34 offen sc1
    v_mfma_f32_16x16x32_bf16 v[144:147], v[40:43], v[108:111], v[144:147]
    v_mov_b32 v5, v10
    v_mov_b32 v10, v8
    s_add_u32 s34, s34, 1024
    v_mfma_f32_16x16x32_bf16 v[140:143], v[80:83], v[104:107], v[140:143]
    v_mfma_f32_16x16x32_bf16 v[148:151], v[80:83], v[108:111], v[148:151]
    ds_read_b128 v[104:107], v13 offset:2048
    ds_read_b128 v[108:111], v13 offset:3072
    s_waitcnt lgkmcnt(8)
    v_mfma_f32_16x16x32_bf16 v[136:139], v[24:27], v[112:115], v[136:139]
    v_mfma_f32_16x16x32_bf16 v[144:147], v[24:27], v[116:119], v[144:147]
    v_mfma_f32_16x16x32_bf16 v[140:143], v[64:67], v[112:115], v[140:143]
    v_mfma_f32_16x16x32_bf16 v[148:151], v[64:67], v[116:119], v[148:151]
    v_mfma_f32_16x16x32_bf16 v[136:139], v[44:47], v[112:115], v[136:139]
    v_mfma_f32_16x16x32_bf16 v[144:147], v[44:47], v[116:119], v[144:147]
    v_mfma_f32_16x16x32_bf16 v[140:143], v[84:87], v[112:115], v[140:143]
    v_mfma_f32_16x16x32_bf16 v[148:151], v[84:87], v[116:119], v[148:151]
    ds_read_b128 v[112:115], v13 offset:4096
    ds_read_b128 v[116:119], v13 offset:5120
    s_waitcnt lgkmcnt(8)
    v_mfma_f32_16x16x32_bf16 v[136:139], v[28:31], v[120:123], v[136:139]
    v_mfma_f32_16x16x32_bf16 v[144:147], v[28:31], v[124:127], v[144:147]
    v_mfma_f32_16x16x32_bf16 v[140:143], v[68:71], v[120:123], v[140:143]
    v_mfma_f32_16x16x32_bf16 v[148:151], v[68:71], v[124:127], v[148:151]
    v_mfma_f32_16x16x32_bf16 v[136:139], v[48:51], v[120:123], v[136:139]
    v_mfma_f32_16x16x32_bf16 v[144:147], v[48:51], v[124:127], v[144:147]
    v_mfma_f32_16x16x32_bf16 v[140:143], v[88:91], v[120:123], v[140:143]
    v_mfma_f32_16x16x32_bf16 v[148:151], v[88:91], v[124:127], v[148:151]
    ds_read_b128 v[120:123], v13 offset:6144
    ds_read_b128 v[124:127], v13 offset:7168
    s_waitcnt lgkmcnt(8)
    v_mfma_f32_16x16x32_bf16 v[136:139], v[32:35], v[128:131], v[136:139]
    v_mfma_f32_16x16x32_bf16 v[140:143], v[72:75], v[128:131], v[140:143]
    v_mfma_f32_16x16x32_bf16 v[136:139], v[52:55], v[128:131], v[136:139]
    v_mfma_f32_16x16x32_bf16 v[140:143], v[92:95], v[128:131], v[140:143]
    v_mfma_f32_16x16x32_bf16 v[144:147], v[32:35], v[132:135], v[144:147]
    s_add_u32 s37, s37, 10240
    s_cmp_eq_u32 s37, 51200
    v_mfma_f32_16x16x32_bf16 v[148:151], v[72:75], v[132:135], v[148:151]
    s_cselect_b32 s37, 0, s37
    s_add_u32 s35, s35, 1
    v_mfma_f32_16x16x32_bf16 v[144:147], v[52:55], v[132:135], v[144:147]
    s_cmp_lt_u32 s35, s39
    v_add_f32 v152, v136, v140
    v_add_f32 v153, v137, v141
    v_mfma_f32_16x16x32_bf16 v[148:151], v[92:95], v[132:135], v[148:151]
    v_add_f32 v154, v138, v142
    v_add_f32 v155, v139, v143
    ds_read_b128 v[128:131], v13 offset:8192
    ds_read_b128 v[132:135], v13 offset:9216
    s_cbranch_scc1 L_k1_kernel_18
    s_nop 2
    v_add_f32 v156, v144, v148
    v_add_f32 v157, v145, v149
    v_add_f32 v158, v146, v150
    v_add_f32 v159, v147, v151
    v_mul_f32 v152, s40, v152
    v_mul_f32 v153, s40, v153
    v_mul_f32 v154, s40, v154
    v_mul_f32 v155, s40, v155
    v_mul_f32 v156, s40, v156
    v_mul_f32 v157, s40, v157
    v_mul_f32 v158, s40, v158
    v_mul_f32 v159, s40, v159
    v_cvt_pk_bf16_f32 v160, v152, v153
    v_cvt_pk_bf16_f32 v161, v154, v155
    v_cvt_pk_bf16_f32 v162, v156, v157
    v_cvt_pk_bf16_f32 v163, v158, v159
    s_nop 1
    v_permlane16_swap_b32 v160, v162
    v_permlane16_swap_b32 v161, v163
    buffer_store_dwordx4 v[160:163], v5, s[4:7], s34 offen sc1
    s_cmp_ge_u32 s3, 2
    s_cbranch_scc1 L_k1_kernel_20
    v_mfma_f32_16x16x32_bf16 v[136:139], v[16:19], v[16:19], 0
    v_mfma_f32_16x16x32_bf16 v[140:143], v[20:23], v[20:23], 0
    v_mfma_f32_16x16x32_bf16 v[144:147], v[24:27], v[24:27], 0
    v_mfma_f32_16x16x32_bf16 v[148:151], v[28:31], v[28:31], 0
    v_mfma_f32_16x16x32_bf16 v[136:139], v[32:35], v[32:35], v[136:139]
    v_mfma_f32_16x16x32_bf16 v[140:143], v[36:39], v[36:39], v[140:143]
    v_mfma_f32_16x16x32_bf16 v[144:147], v[40:43], v[40:43], v[144:147]
    v_mfma_f32_16x16x32_bf16 v[148:151], v[44:47], v[44:47], v[148:151]
    v_mfma_f32_16x16x32_bf16 v[136:139], v[48:51], v[48:51], v[136:139]
    v_mfma_f32_16x16x32_bf16 v[140:143], v[52:55], v[52:55], v[140:143]
    v_mfma_f32_16x16x32_bf16 v[144:147], v[56:59], v[56:59], v[144:147]
    v_mfma_f32_16x16x32_bf16 v[148:151], v[60:63], v[60:63], v[148:151]
    v_mfma_f32_16x16x32_bf16 v[136:139], v[64:67], v[64:67], v[136:139]
    v_mfma_f32_16x16x32_bf16 v[140:143], v[68:71], v[68:71], v[140:143]
    v_mfma_f32_16x16x32_bf16 v[144:147], v[72:75], v[72:75], v[144:147]
    v_mfma_f32_16x16x32_bf16 v[148:151], v[76:79], v[76:79], v[148:151]
    v_mfma_f32_16x16x32_bf16 v[136:139], v[80:83], v[80:83], v[136:139]
    v_mfma_f32_16x16x32_bf16 v[140:143], v[84:87], v[84:87], v[140:143]
    v_mfma_f32_16x16x32_bf16 v[144:147], v[88:91], v[88:91], v[144:147]
    v_mfma_f32_16x16x32_bf16 v[148:151], v[92:95], v[92:95], v[148:151]
    s_mov_b32 s40, 0xbb4cd801
    v_and_b32 v3, 3, v0
    v_lshrrev_b32 v5, 2, v1
    v_cmp_eq_u32 vcc, v5, v2
    v_lshlrev_b32 v6, 2, v1
    v_mov_b32 v8, 2147483632
    s_mul_i32 s36, s45, 20608
    s_add_u32 s36, s36, 0
    s_lshl_b32 s34, s45, 6
    s_add_u32 s34, s34, 26214400
    v_cndmask_b32 v6, v8, v6, vcc
    v_mov_b32 v8, 0
    v_mov_b32 v9, 0
    s_add_u32 s41, s34, 8192
    buffer_store_dword v9, v6, s[4:7], s41 offen
    buffer_store_dwordx2 v[8:9], v7, s[4:7], s36 offen
    v_cmp_eq_u32 s[42:43], 1, v3
    v_cmp_eq_u32 s[50:51], 2, v3
    v_cmp_eq_u32 s[46:47], 3, v3
    v_pk_add_f32 v[136:137], v[136:137], v[144:145]
    v_pk_add_f32 v[138:139], v[138:139], v[146:147]
    v_pk_add_f32 v[140:141], v[140:141], v[148:149]
    v_pk_add_f32 v[142:143], v[142:143], v[150:151]
    v_pk_add_f32 v[160:161], v[136:137], v[140:141]
    v_pk_add_f32 v[162:163], v[138:139], v[142:143]
    v_mul_f32 v164, v164, v164
    v_fma_f32 v160, v164, s40, v160
    v_mul_f32 v165, v165, v165
    v_fma_f32 v161, v165, s40, v161
    v_mul_f32 v166, v166, v166
    v_fma_f32 v162, v166, s40, v162
    v_mul_f32 v167, v167, v167
    v_fma_f32 v163, v167, s40, v163
    v_cndmask_b32 v160, v160, v161, s[42:43]
    v_cndmask_b32 v160, v160, v162, s[50:51]
    v_cndmask_b32 v160, v160, v163, s[46:47]
    buffer_store_dword v160, v6, s[4:7], s34 offen
L_k1_kernel_20:
    s_endpgm
L_k1_kernel_15:
L_k1_kernel_21:
    s_waitcnt lgkmcnt(8)
    v_mfma_f32_16x16x32_bf16 v[136:139], v[16:19], v[96:99], 0
    v_add_u32 v13, s37, v4
    v_mfma_f32_16x16x32_bf16 v[140:143], v[56:59], v[96:99], 0
    v_sub_f32 v156, v144, v148
    v_sub_f32 v157, v145, v149
    v_mfma_f32_16x16x32_bf16 v[136:139], v[36:39], v[100:103], v[136:139]
    v_sub_f32 v158, v146, v150
    v_sub_f32 v159, v147, v151
    v_mfma_f32_16x16x32_bf16 v[140:143], v[76:79], v[100:103], v[140:143]
    v_mfma_f32_16x16x32_bf16 v[144:147], v[16:19], v[100:103], 0
    v_mul_f32 v152, s40, v152
    v_mul_f32 v153, s40, v153
    v_mfma_f32_16x16x32_bf16 v[148:151], v[36:39], v[96:99], 0
    v_mul_f32 v154, s40, v154
    v_mul_f32 v155, s40, v155
    v_mfma_f32_16x16x32_bf16 v[144:147], v[76:79], v[96:99], v[144:147]
    v_mul_f32 v156, s40, v156
    v_mul_f32 v157, s40, v157
    v_mfma_f32_16x16x32_bf16 v[148:151], v[56:59], v[100:103], v[148:151]
    v_mul_f32 v158, s40, v158
    v_mul_f32 v159, s40, v159
    ds_read_b128 v[96:99], v13 offset:0
    ds_read_b128 v[100:103], v13 offset:1024
    s_waitcnt lgkmcnt(8)
    v_mfma_f32_16x16x32_bf16 v[136:139], v[20:23], v[104:107], v[136:139]
    v_cvt_pk_bf16_f32 v160, v152, v153
    v_cvt_pk_bf16_f32 v161, v154, v155
    v_mfma_f32_16x16x32_bf16 v[144:147], v[20:23], v[108:111], v[144:147]
    v_cvt_pk_bf16_f32 v162, v156, v157
    v_cvt_pk_bf16_f32 v163, v158, v159
    v_mfma_f32_16x16x32_bf16 v[140:143], v[60:63], v[104:107], v[140:143]
    s_nop 1
    v_permlane16_swap_b32 v160, v162
    v_permlane16_swap_b32 v161, v163
    v_mfma_f32_16x16x32_bf16 v[148:151], v[40:43], v[104:107], v[148:151]
    buffer_store_dwordx4 v[160:163], v5, s[4:7], s34 offen sc1
    v_mfma_f32_16x16x32_bf16 v[136:139], v[40:43], v[108:111], v[136:139]
    v_mov_b32 v5, v10
    v_mov_b32 v10, v8
    s_add_u32 s34, s34, 1024
    v_mfma_f32_16x16x32_bf16 v[144:147], v[80:83], v[104:107], v[144:147]
    v_mfma_f32_16x16x32_bf16 v[140:143], v[80:83], v[108:111], v[140:143]
    v_mfma_f32_16x16x32_bf16 v[148:151], v[60:63], v[108:111], v[148:151]
    ds_read_b128 v[104:107], v13 offset:2048
    ds_read_b128 v[108:111], v13 offset:3072
    s_waitcnt lgkmcnt(8)
    v_mfma_f32_16x16x32_bf16 v[136:139], v[24:27], v[112:115], v[136:139]
    v_mfma_f32_16x16x32_bf16 v[144:147], v[24:27], v[116:119], v[144:147]
    v_mfma_f32_16x16x32_bf16 v[140:143], v[64:67], v[112:115], v[140:143]
    v_mfma_f32_16x16x32_bf16 v[148:151], v[44:47], v[112:115], v[148:151]
    v_mfma_f32_16x16x32_bf16 v[136:139], v[44:47], v[116:119], v[136:139]
    v_mfma_f32_16x16x32_bf16 v[144:147], v[84:87], v[112:115], v[144:147]
    v_mfma_f32_16x16x32_bf16 v[140:143], v[84:87], v[116:119], v[140:143]
    v_mfma_f32_16x16x32_bf16 v[148:151], v[64:67], v[116:119], v[148:151]
    ds_read_b128 v[112:115], v13 offset:4096
    ds_read_b128 v[116:119], v13 offset:5120
    s_waitcnt lgkmcnt(8)
    v_mfma_f32_16x16x32_bf16 v[136:139], v[28:31], v[120:123], v[136:139]
    v_mfma_f32_16x16x32_bf16 v[144:147], v[28:31], v[124:127], v[144:147]
    v_mfma_f32_16x16x32_bf16 v[140:143], v[68:71], v[120:123], v[140:143]
    v_mfma_f32_16x16x32_bf16 v[148:151], v[48:51], v[120:123], v[148:151]
    v_mfma_f32_16x16x32_bf16 v[136:139], v[48:51], v[124:127], v[136:139]
    v_mfma_f32_16x16x32_bf16 v[144:147], v[88:91], v[120:123], v[144:147]
    v_mfma_f32_16x16x32_bf16 v[140:143], v[88:91], v[124:127], v[140:143]
    v_mfma_f32_16x16x32_bf16 v[148:151], v[68:71], v[124:127], v[148:151]
    ds_read_b128 v[120:123], v13 offset:6144
    ds_read_b128 v[124:127], v13 offset:7168
    s_waitcnt lgkmcnt(8)
    v_mfma_f32_16x16x32_bf16 v[136:139], v[32:35], v[128:131], v[136:139]
    v_mfma_f32_16x16x32_bf16 v[140:143], v[72:75], v[128:131], v[140:143]
    v_mfma_f32_16x16x32_bf16 v[136:139], v[52:55], v[132:135], v[136:139]
    v_mfma_f32_16x16x32_bf16 v[140:143], v[92:95], v[132:135], v[140:143]
    v_mfma_f32_16x16x32_bf16 v[144:147], v[32:35], v[132:135], v[144:147]
    s_add_u32 s37, s37, 10240
    s_cmp_eq_u32 s37, 51200
    v_mfma_f32_16x16x32_bf16 v[148:151], v[52:55], v[128:131], v[148:151]
    s_cselect_b32 s37, 0, s37
    s_add_u32 s35, s35, 1
    v_mfma_f32_16x16x32_bf16 v[144:147], v[92:95], v[128:131], v[144:147]
    s_cmp_lt_u32 s35, s39
    v_sub_f32 v152, v136, v140
    v_sub_f32 v153, v137, v141
    v_mfma_f32_16x16x32_bf16 v[148:151], v[72:75], v[132:135], v[148:151]
    v_sub_f32 v154, v138, v142
    v_sub_f32 v155, v139, v143
    ds_read_b128 v[128:131], v13 offset:8192
    ds_read_b128 v[132:135], v13 offset:9216
    s_cbranch_scc1 L_k1_kernel_21
    s_nop 2
    v_sub_f32 v156, v144, v148
    v_sub_f32 v157, v145, v149
    v_sub_f32 v158, v146, v150
    v_sub_f32 v159, v147, v151
    v_mul_f32 v152, s40, v152
    v_mul_f32 v153, s40, v153
    v_mul_f32 v154, s40, v154
    v_mul_f32 v155, s40, v155
    v_mul_f32 v156, s40, v156
    v_mul_f32 v157, s40, v157
    v_mul_f32 v158, s40, v158
    v_mul_f32 v159, s40, v159
    v_cvt_pk_bf16_f32 v160, v152, v153
    v_cvt_pk_bf16_f32 v161, v154, v155
    v_cvt_pk_bf16_f32 v162, v156, v157
    v_cvt_pk_bf16_f32 v163, v158, v159
    s_nop 1
    v_permlane16_swap_b32 v160, v162
    v_permlane16_swap_b32 v161, v163
    buffer_store_dwordx4 v[160:163], v5, s[4:7], s34 offen sc1
    s_endpgm
L_k1_kernel_16:
L_k1_kernel_22:
    s_waitcnt lgkmcnt(8)
    v_mfma_f32_16x16x32_bf16 v[136:139], v[16:19], v[96:99], 0
    v_add_u32 v13, s37, v4
    v_mfma_f32_16x16x32_bf16 v[140:143], v[36:39], v[96:99], 0
    v_sub_f32 v156, v144, v148
    v_sub_f32 v157, v145, v149
    v_mfma_f32_16x16x32_bf16 v[136:139], v[56:59], v[96:99], v[136:139]
    v_sub_f32 v158, v146, v150
    v_sub_f32 v159, v147, v151
    v_mfma_f32_16x16x32_bf16 v[140:143], v[76:79], v[96:99], v[140:143]
    v_mfma_f32_16x16x32_bf16 v[144:147], v[16:19], v[100:103], 0
    v_mul_f32 v152, s40, v152
    v_mul_f32 v153, s40, v153
    v_mfma_f32_16x16x32_bf16 v[148:151], v[36:39], v[100:103], 0
    v_mul_f32 v154, s40, v154
    v_mul_f32 v155, s40, v155
    v_mfma_f32_16x16x32_bf16 v[144:147], v[56:59], v[100:103], v[144:147]
    v_mul_f32 v156, s40, v156
    v_mul_f32 v157, s40, v157
    v_mfma_f32_16x16x32_bf16 v[148:151], v[76:79], v[100:103], v[148:151]
    v_mul_f32 v158, s40, v158
    v_mul_f32 v159, s40, v159
    ds_read_b128 v[96:99], v13 offset:0
    ds_read_b128 v[100:103], v13 offset:1024
    s_waitcnt lgkmcnt(8)
    v_mfma_f32_16x16x32_bf16 v[136:139], v[20:23], v[104:107], v[136:139]
    v_cvt_pk_bf16_f32 v160, v152, v153
    v_cvt_pk_bf16_f32 v161, v154, v155
    v_mfma_f32_16x16x32_bf16 v[144:147], v[20:23], v[108:111], v[144:147]
    v_cvt_pk_bf16_f32 v162, v156, v157
    v_cvt_pk_bf16_f32 v163, v158, v159
    v_mfma_f32_16x16x32_bf16 v[140:143], v[40:43], v[104:107], v[140:143]
    s_nop 1
    v_permlane16_swap_b32 v160, v162
    v_permlane16_swap_b32 v161, v163
    v_mfma_f32_16x16x32_bf16 v[148:151], v[40:43], v[108:111], v[148:151]
    buffer_store_dwordx4 v[160:163], v5, s[4:7], s34 offen sc1
    v_mfma_f32_16x16x32_bf16 v[136:139], v[60:63], v[104:107], v[136:139]
    v_mov_b32 v5, v10
    v_mov_b32 v10, v8
    s_add_u32 s34, s34, 1024
    v_mfma_f32_16x16x32_bf16 v[144:147], v[60:63], v[108:111], v[144:147]
    v_mfma_f32_16x16x32_bf16 v[140:143], v[80:83], v[104:107], v[140:143]
    v_mfma_f32_16x16x32_bf16 v[148:151], v[80:83], v[108:111], v[148:151]
    ds_read_b128 v[104:107], v13 offset:2048
    ds_read_b128 v[108:111], v13 offset:3072
    s_waitcnt lgkmcnt(8)
    v_mfma_f32_16x16x32_bf16 v[136:139], v[24:27], v[112:115], v[136:139]
    v_mfma_f32_16x16x32_bf16 v[144:147], v[24:27], v[116:119], v[144:147]
    v_mfma_f32_16x16x32_bf16 v[140:143], v[44:47], v[112:115], v[140:143]
    v_mfma_f32_16x16x32_bf16 v[148:151], v[44:47], v[116:119], v[148:151]
    v_mfma_f32_16x16x32_bf16 v[136:139], v[64:67], v[112:115], v[136:139]
    v_mfma_f32_16x16x32_bf16 v[144:147], v[64:67], v[116:119], v[144:147]
    v_mfma_f32_16x16x32_bf16 v[140:143], v[84:87], v[112:115], v[140:143]
    v_mfma_f32_16x16x32_bf16 v[148:151], v[84:87], v[116:119], v[148:151]
    ds_read_b128 v[112:115], v13 offset:4096
    ds_read_b128 v[116:119], v13 offset:5120
    s_waitcnt lgkmcnt(8)
    v_mfma_f32_16x16x32_bf16 v[136:139], v[28:31], v[120:123], v[136:139]
    v_mfma_f32_16x16x32_bf16 v[144:147], v[28:31], v[124:127], v[144:147]
    v_mfma_f32_16x16x32_bf16 v[140:143], v[48:51], v[120:123], v[140:143]
    v_mfma_f32_16x16x32_bf16 v[148:151], v[48:51], v[124:127], v[148:151]
    v_mfma_f32_16x16x32_bf16 v[136:139], v[68:71], v[120:123], v[136:139]
    v_mfma_f32_16x16x32_bf16 v[144:147], v[68:71], v[124:127], v[144:147]
    v_mfma_f32_16x16x32_bf16 v[140:143], v[88:91], v[120:123], v[140:143]
    v_mfma_f32_16x16x32_bf16 v[148:151], v[88:91], v[124:127], v[148:151]
    ds_read_b128 v[120:123], v13 offset:6144
    ds_read_b128 v[124:127], v13 offset:7168
    s_waitcnt lgkmcnt(8)
    v_mfma_f32_16x16x32_bf16 v[136:139], v[32:35], v[128:131], v[136:139]
    v_mfma_f32_16x16x32_bf16 v[140:143], v[52:55], v[128:131], v[140:143]
    v_mfma_f32_16x16x32_bf16 v[136:139], v[72:75], v[128:131], v[136:139]
    v_mfma_f32_16x16x32_bf16 v[140:143], v[92:95], v[128:131], v[140:143]
    v_mfma_f32_16x16x32_bf16 v[144:147], v[32:35], v[132:135], v[144:147]
    s_add_u32 s37, s37, 10240
    s_cmp_eq_u32 s37, 51200
    v_mfma_f32_16x16x32_bf16 v[148:151], v[52:55], v[132:135], v[148:151]
    s_cselect_b32 s37, 0, s37
    s_add_u32 s35, s35, 1
    v_mfma_f32_16x16x32_bf16 v[144:147], v[72:75], v[132:135], v[144:147]
    s_cmp_lt_u32 s35, s39
    v_sub_f32 v152, v136, v140
    v_sub_f32 v153, v137, v141
    v_mfma_f32_16x16x32_bf16 v[148:151], v[92:95], v[132:135], v[148:151]
    v_sub_f32 v154, v138, v142
    v_sub_f32 v155, v139, v143
    ds_read_b128 v[128:131], v13 offset:8192
    ds_read_b128 v[132:135], v13 offset:9216
    s_cbranch_scc1 L_k1_kernel_22
    s_nop 2
    v_sub_f32 v156, v144, v148
    v_sub_f32 v157, v145, v149
    v_sub_f32 v158, v146, v150
    v_sub_f32 v159, v147, v151
    v_mul_f32 v152, s40, v152
    v_mul_f32 v153, s40, v153
    v_mul_f32 v154, s40, v154
    v_mul_f32 v155, s40, v155
    v_mul_f32 v156, s40, v156
    v_mul_f32 v157, s40, v157
    v_mul_f32 v158, s40, v158
    v_mul_f32 v159, s40, v159
    v_cvt_pk_bf16_f32 v160, v152, v153
    v_cvt_pk_bf16_f32 v161, v154, v155
    v_cvt_pk_bf16_f32 v162, v156, v157
    v_cvt_pk_bf16_f32 v163, v158, v159
    s_nop 1
    v_permlane16_swap_b32 v160, v162
    v_permlane16_swap_b32 v161, v163
    buffer_store_dwordx4 v[160:163], v5, s[4:7], s34 offen sc1
    s_endpgm
L_k1_kernel_17:
L_k1_kernel_23:
    s_waitcnt lgkmcnt(8)
    v_mfma_f32_16x16x32_bf16 v[136:139], v[16:19], v[96:99], 0
    v_add_u32 v13, s37, v4
    v_mfma_f32_16x16x32_bf16 v[140:143], v[36:39], v[100:103], 0
    v_sub_f32 v156, v144, v148
    v_sub_f32 v157, v145, v149
    v_mfma_f32_16x16x32_bf16 v[136:139], v[76:79], v[100:103], v[136:139]
    v_sub_f32 v158, v146, v150
    v_sub_f32 v159, v147, v151
    v_mfma_f32_16x16x32_bf16 v[140:143], v[56:59], v[96:99], v[140:143]
    v_mfma_f32_16x16x32_bf16 v[144:147], v[16:19], v[100:103], 0
    v_mul_f32 v152, s40, v152
    v_mul_f32 v153, s40, v153
    v_mfma_f32_16x16x32_bf16 v[148:151], v[56:59], v[100:103], 0
    v_mul_f32 v154, s40, v154
    v_mul_f32 v155, s40, v155
    v_mfma_f32_16x16x32_bf16 v[144:147], v[36:39], v[96:99], v[144:147]
    v_mul_f32 v156, s40, v156
    v_mul_f32 v157, s40, v157
    v_mfma_f32_16x16x32_bf16 v[148:151], v[76:79], v[96:99], v[148:151]
    v_mul_f32 v158, s40, v158
    v_mul_f32 v159, s40, v159
    ds_read_b128 v[96:99], v13 offset:0
    ds_read_b128 v[100:103], v13 offset:1024
    s_waitcnt lgkmcnt(8)
    v_mfma_f32_16x16x32_bf16 v[136:139], v[20:23], v[104:107], v[136:139]
    v_cvt_pk_bf16_f32 v160, v152, v153
    v_cvt_pk_bf16_f32 v161, v154, v155
    v_mfma_f32_16x16x32_bf16 v[144:147], v[20:23], v[108:111], v[144:147]
    v_cvt_pk_bf16_f32 v162, v156, v157
    v_cvt_pk_bf16_f32 v163, v158, v159
    v_mfma_f32_16x16x32_bf16 v[140:143], v[40:43], v[108:111], v[140:143]
    s_nop 1
    v_permlane16_swap_b32 v160, v162
    v_permlane16_swap_b32 v161, v163
    v_mfma_f32_16x16x32_bf16 v[148:151], v[60:63], v[108:111], v[148:151]
    buffer_store_dwordx4 v[160:163], v5, s[4:7], s34 offen sc1
    v_mfma_f32_16x16x32_bf16 v[136:139], v[80:83], v[108:111], v[136:139]
    v_mov_b32 v5, v10
    v_mov_b32 v10, v8
    s_add_u32 s34, s34, 1024
    v_mfma_f32_16x16x32_bf16 v[144:147], v[40:43], v[104:107], v[144:147]
    v_mfma_f32_16x16x32_bf16 v[140:143], v[60:63], v[104:107], v[140:143]
    v_mfma_f32_16x16x32_bf16 v[148:151], v[80:83], v[104:107], v[148:151]
    ds_read_b128 v[104:107], v13 offset:2048
    ds_read_b128 v[108:111], v13 offset:3072
    s_waitcnt lgkmcnt(8)
    v_mfma_f32_16x16x32_bf16 v[136:139], v[24:27], v[112:115], v[136:139]
    v_mfma_f32_16x16x32_bf16 v[144:147], v[24:27], v[116:119], v[144:147]
    v_mfma_f32_16x16x32_bf16 v[140:143], v[44:47], v[116:119], v[140:143]
    v_mfma_f32_16x16x32_bf16 v[148:151], v[64:67], v[116:119], v[148:151]
    v_mfma_f32_16x16x32_bf16 v[136:139], v[84:87], v[116:119], v[136:139]
    v_mfma_f32_16x16x32_bf16 v[144:147], v[44:47], v[112:115], v[144:147]
    v_mfma_f32_16x16x32_bf16 v[140:143], v[64:67], v[112:115], v[140:143]
    v_mfma_f32_16x16x32_bf16 v[148:151], v[84:87], v[112:115], v[148:151]
    ds_read_b128 v[112:115], v13 offset:4096
    ds_read_b128 v[116:119], v13 offset:5120
    s_waitcnt lgkmcnt(8)
    v_mfma_f32_16x16x32_bf16 v[136:139], v[28:31], v[120:123], v[136:139]
    v_mfma_f32_16x16x32_bf16 v[144:147], v[28:31], v[124:127], v[144:147]
    v_mfma_f32_16x16x32_bf16 v[140:143], v[48:51], v[124:127], v[140:143]
    v_mfma_f32_16x16x32_bf16 v[148:151], v[68:71], v[124:127], v[148:151]
    v_mfma_f32_16x16x32_bf16 v[136:139], v[88:91], v[124:127], v[136:139]
    v_mfma_f32_16x16x32_bf16 v[144:147], v[48:51], v[120:123], v[144:147]
    v_mfma_f32_16x16x32_bf16 v[140:143], v[68:71], v[120:123], v[140:143]
    v_mfma_f32_16x16x32_bf16 v[148:151], v[88:91], v[120:123], v[148:151]
    ds_read_b128 v[120:123], v13 offset:6144
    ds_read_b128 v[124:127], v13 offset:7168
    s_waitcnt lgkmcnt(8)
    v_mfma_f32_16x16x32_bf16 v[136:139], v[32:35], v[128:131], v[136:139]
    v_mfma_f32_16x16x32_bf16 v[140:143], v[52:55], v[132:135], v[140:143]
    v_mfma_f32_16x16x32_bf16 v[136:139], v[92:95], v[132:135], v[136:139]
    v_mfma_f32_16x16x32_bf16 v[140:143], v[72:75], v[128:131], v[140:143]
    v_mfma_f32_16x16x32_bf16 v[144:147], v[32:35], v[132:135], v[144:147]
    s_add_u32 s37, s37, 10240
    s_cmp_eq_u32 s37, 51200
    v_mfma_f32_16x16x32_bf16 v[148:151], v[72:75], v[132:135], v[148:151]
    s_cselect_b32 s37, 0, s37
    s_add_u32 s35, s35, 1
    v_mfma_f32_16x16x32_bf16 v[144:147], v[52:55], v[128:131], v[144:147]
    s_cmp_lt_u32 s35, s39
    v_sub_f32 v152, v136, v140
    v_sub_f32 v153, v137, v141
    v_mfma_f32_16x16x32_bf16 v[148:151], v[92:95], v[128:131], v[148:151]
    v_sub_f32 v154, v138, v142
    v_sub_f32 v155, v139, v143
    ds_read_b128 v[128:131], v13 offset:8192
    ds_read_b128 v[132:135], v13 offset:9216
    s_cbranch_scc1 L_k1_kernel_23
    s_nop 2
    v_sub_f32 v156, v144, v148
    v_sub_f32 v157, v145, v149
    v_sub_f32 v158, v146, v150
    v_sub_f32 v159, v147, v151
    v_mul_f32 v152, s40, v152
    v_mul_f32 v153, s40, v153
    v_mul_f32 v154, s40, v154
    v_mul_f32 v155, s40, v155
    v_mul_f32 v156, s40, v156
    v_mul_f32 v157, s40, v157
    v_mul_f32 v158, s40, v158
    v_mul_f32 v159, s40, v159
    v_cvt_pk_bf16_f32 v160, v152, v153
    v_cvt_pk_bf16_f32 v161, v154, v155
    v_cvt_pk_bf16_f32 v162, v156, v157
    v_cvt_pk_bf16_f32 v163, v158, v159
    s_nop 1
    v_permlane16_swap_b32 v160, v162
    v_permlane16_swap_b32 v161, v163
    buffer_store_dwordx4 v[160:163], v5, s[4:7], s34 offen sc1
    s_endpgm
L_k1_kernel_3:
    s_mov_b32 s53, s34
    s_add_u32 s32, s3, s33
    s_cmp_eq_u32 s3, 5
    s_cselect_b32 s32, s32, s3
    s_cselect_b32 s34, 7, 6
    s_cmp_ge_u32 s32, s34
    s_cbranch_scc0 L_k1_kernel_4
    s_sub_u32 s32, s32, s34
    s_add_u32 s26, s27, 256
    s_cmp_eq_u32 s3, 5
    s_cselect_b32 s26, s26, s2
    s_mov_b32 s28, s10
    s_and_b32 s29, s11, 0xffff
    s_mov_b32 s30, 1314816
    s_mov_b32 s31, 0x00020000
    s_mov_b32 s44, s12
    s_and_b32 s45, s13, 0xffff
    s_mov_b32 s46, 1314816
    s_mov_b32 s47, 0x00020000
    s_andn2_b32 s36, s26, 63
    v_and_b32 v7, 60, v0
    v_add_u32 v7, s36, v7
    v_lshl_add_u32 v3, v7, 1, 2
    v_and_b32 v5, 1, v0
    v_bfe_u32 v6, v0, 1, 1
    v_lshl_add_u32 v5, v5, 10, v6
    v_mul_u32_u24 v5, 642, v5
    v_add_u32 v3, v3, v5
    s_bfe_u32 s37, s26, 0x40002
    s_lshl_b32 s37, s37, 1
    s_add_u32 s37, s37, s32
    s_and_b32 s51, s26, 3
    s_lshl_b32 s39, s37, 1
    s_lshl_b32 s40, s51, 8
    s_add_u32 s39, s39, s40
    s_mul_i32 s39, s39, 642
    s_add_u32 s40, s39, 41088
    s_add_u32 s41, s39, 82176
    s_add_u32 s42, s39, 123264
    buffer_load_dwordx2 v[16:17], v3, s[28:31], s39 offen
    buffer_load_dwordx2 v[24:25], v3, s[44:47], s39 offen
    buffer_load_dwordx2 v[18:19], v3, s[28:31], s40 offen
    buffer_load_dwordx2 v[26:27], v3, s[44:47], s40 offen
    buffer_load_dwordx2 v[20:21], v3, s[28:31], s41 offen
    buffer_load_dwordx2 v[28:29], v3, s[44:47], s41 offen
    buffer_load_dwordx2 v[22:23], v3, s[28:31], s42 offen
    buffer_load_dwordx2 v[30:31], v3, s[44:47], s42 offen
    v_cmp_ne_u32 vcc, 316, v7
    v_lshrrev_b32 v5, 2, v7
    s_lshr_b32 s50, s37, 3
    s_lshl_b32 s50, s50, 11
    v_add_u32 v6, 1, v5
    v_cndmask_b32 v6, 0, v6, vcc
    v_and_b32 v7, 3, v0
    v_lshlrev_b32 v7, 4, v7
    v_lshl_add_u32 v5, v5, 13, v7
    v_lshl_add_u32 v6, v6, 13, v7
    s_and_b32 s41, s37, 7
    s_lshl_b32 s41, s41, 6
    s_add_u32 s50, s50, s41
    s_lshl_b32 s41, s51, 9
    s_add_u32 s50, s50, s41
    s_add_u32 s50, s50, 3145728
    s_add_u32 s47, s50, 655360
    s_add_u32 s48, s50, 1310720
    s_add_u32 s49, s50, 1966080
    s_mov_b32 s40, 0x05040100
    s_mov_b32 s41, 0x07060302
    s_barrier
    s_waitcnt vmcnt(0)
    v_perm_b32 v32, v24, v16, s40
    v_perm_b32 v33, v26, v18, s40
    v_perm_b32 v34, v28, v20, s40
    v_perm_b32 v35, v30, v22, s40
    buffer_store_dwordx4 v[32:35], v5, s[4:7], s47 offen
    v_perm_b32 v36, v24, v16, s41
    v_perm_b32 v37, v26, v18, s41
    v_perm_b32 v38, v28, v20, s41
    v_perm_b32 v39, v30, v22, s41
    buffer_store_dwordx4 v[36:39], v5, s[4:7], s48 offen
    v_perm_b32 v40, v25, v17, s40
    v_perm_b32 v41, v27, v19, s40
    v_perm_b32 v42, v29, v21, s40
    v_perm_b32 v43, v31, v23, s40
    buffer_store_dwordx4 v[40:43], v5, s[4:7], s49 offen
    v_perm_b32 v44, v25, v17, s41
    v_perm_b32 v45, v27, v19, s41
    v_perm_b32 v46, v29, v21, s41
    v_perm_b32 v47, v31, v23, s41
    buffer_store_dwordx4 v[44:47], v6, s[4:7], s50 offen
L_k1_kernel_5:
    s_cmp_lt_u32 s3, 3
    s_cselect_b32 s32, 1, s27
    s_cmp_lg_u32 s32, 63
    s_cbranch_scc1 L_k1_kernel_24
    s_mul_i32 s46, s38, 10240
    s_add_u32 s46, s46, 26279936
    s_add_u32 s41, s46, 4096
    s_add_u32 s42, s46, 8192
    buffer_store_dwordx4 v[96:99], v4, s[4:7], s46 offen offset:0
    buffer_store_dwordx4 v[100:103], v4, s[4:7], s46 offen offset:1024
    buffer_store_dwordx4 v[104:107], v4, s[4:7], s46 offen offset:2048
    buffer_store_dwordx4 v[108:111], v4, s[4:7], s46 offen offset:3072
    buffer_store_dwordx4 v[112:115], v4, s[4:7], s41 offen offset:0
    buffer_store_dwordx4 v[116:119], v4, s[4:7], s41 offen offset:1024
    buffer_store_dwordx4 v[120:123], v4, s[4:7], s41 offen offset:2048
    buffer_store_dwordx4 v[124:127], v4, s[4:7], s41 offen offset:3072
    buffer_store_dwordx4 v[128:131], v4, s[4:7], s42 offen offset:0
    buffer_store_dwordx4 v[132:135], v4, s[4:7], s42 offen offset:1024
L_k1_kernel_24:
    s_endpgm
L_k1_kernel_4:
    s_barrier
    s_cmp_lg_u32 s3, 4
    s_cbranch_scc1 L_k1_kernel_25
    buffer_load_dwordx4 v[16:19], v3, s[28:31], s53 offen
    s_add_u32 s53, s53, 30720
    buffer_load_dwordx4 v[20:23], v3, s[28:31], s53 offen
    s_add_u32 s53, s53, 30720
    buffer_load_dwordx4 v[24:27], v3, s[28:31], s53 offen
    s_add_u32 s53, s53, 30720
    buffer_load_dwordx4 v[28:31], v3, s[28:31], s53 offen
    s_add_u32 s53, s53, 30720
    buffer_load_dwordx4 v[32:35], v3, s[28:31], s53 offen
    s_add_u32 s53, s53, 30720
    buffer_load_dwordx4 v[36:39], v3, s[28:31], s53 offen
    s_add_u32 s53, s53, 30720
    buffer_load_dwordx4 v[40:43], v3, s[28:31], s53 offen
    s_add_u32 s53, s53, 30720
    buffer_load_dwordx4 v[44:47], v3, s[28:31], s53 offen
    s_add_u32 s53, s53, 30720
    buffer_load_dwordx4 v[48:51], v3, s[28:31], s53 offen
    s_add_u32 s53, s53, 30720
    buffer_load_dwordx4 v[52:55], v3, s[28:31], s53 offen
    s_add_u32 s53, s53, 30720
L_k1_kernel_25:
    s_branch L_k1_kernel_5

.globl k2_kernel
.p2align 8
.type k2_kernel,@function
k2_kernel:
    s_load_dwordx16 s[8:23], s[0:1], 0
    s_load_dwordx2 s[24:25], s[0:1], 64
    v_lshrrev_b32 v1, 6, v0
    v_and_b32 v0, 63, v0
    s_nop 0
    v_readfirstlane_b32 s3, v1
    s_sub_u32 s26, s2, 320
    s_cmp_ge_u32 s26, 192
    s_cbranch_scc1 L_k2_kernel_1
    s_bfe_u32 s33, s26, 0x20003
    s_add_u32 s32, s3, 1
    s_bfe_u32 s38, s26, 0x10003
    s_lshl1_add_u32 s38, s38, 1
    s_cmp_ge_u32 s26, 128
    s_cselect_b32 s33, s38, s33
    s_cselect_b32 s32, 4, s32
    s_mov_b32 s38, 1
    v_and_b32 v136, 15, v0
    s_lshl_b32 s40, s32, 4
    v_add_u32 v136, s40, v136
    v_lshlrev_b32 v136, 2, v136
    v_add_u32 v136, s33, v136
    v_cmp_eq_u32 vcc, 0, v136
    v_mov_b32 v137, 320
    v_mov_b32 v138, 0x3e000000
    v_cndmask_b32 v136, v136, v137, vcc
    v_cndmask_b32 v138, 0, v138, vcc
    s_mov_b64 s[42:43], vcc
    v_cvt_f32_u32 v136, v136
    v_mul_f32 v136, 0x3acccccd, v136
    v_lshrrev_b32 v137, 4, v0
    v_lshlrev_b32 v137, 3, v137
    v_cvt_f32_u32 v137, v137
    v_fma_f32 v137, v137, v136, v138
    v_mul_f32 v140, 0x42000000, v136
    v_cos_f32 v138, v136
    v_cos_f32 v140, v140
    v_fmamk_f32 v142, v136, 0x3f800000, v137
    v_fmamk_f32 v143, v136, 0x42000000, v137
    v_fmamk_f32 v144, v136, 0x42040000, v137
    v_cos_f32 v16, v137
    v_sin_f32_e64 v24, -v137
    v_cos_f32 v17, v142
    v_sin_f32_e64 v25, -v142
    v_cos_f32 v32, v143
    v_sin_f32_e64 v40, -v143
    v_cos_f32 v33, v144
    v_sin_f32_e64 v41, -v144
    v_add_f32 v138, v138, v138
    v_add_f32 v140, v140, v140
    v_fma_f32 v18, v138, v17, -v16
    v_fma_f32 v26, v138, v25, -v24
    v_fma_f32 v34, v138, v33, -v32
    v_fma_f32 v42, v138, v41, -v40
    v_fma_f32 v19, v138, v18, -v17
    v_fma_f32 v27, v138, v26, -v25
    v_fma_f32 v35, v138, v34, -v33
    v_fma_f32 v43, v138, v42, -v41
    v_fma_f32 v20, v138, v19, -v18
    v_fma_f32 v28, v138, v27, -v26
    v_fma_f32 v36, v138, v35, -v34
    v_fma_f32 v44, v138, v43, -v42
    v_fma_f32 v21, v138, v20, -v19
    v_fma_f32 v29, v138, v28, -v27
    v_fma_f32 v37, v138, v36, -v35
    v_fma_f32 v45, v138, v44, -v43
    v_fma_f32 v22, v138, v21, -v20
    v_fma_f32 v30, v138, v29, -v28
    v_fma_f32 v38, v138, v37, -v36
    v_fma_f32 v46, v138, v45, -v44
    v_fma_f32 v23, v138, v22, -v21
    v_fma_f32 v31, v138, v30, -v29
    v_fma_f32 v39, v138, v38, -v37
    v_fma_f32 v47, v138, v46, -v45
    v_cvt_pk_bf16_f32 v168, v16, v17
    v_cvt_pk_bf16_f32 v169, v18, v19
    v_cvt_pk_bf16_f32 v170, v20, v21
    v_cvt_pk_bf16_f32 v171, v22, v23
    v_cvt_pk_bf16_f32 v188, v24, v25
    v_cvt_pk_bf16_f32 v189, v26, v27
    v_cvt_pk_bf16_f32 v190, v28, v29
    v_cvt_pk_bf16_f32 v191, v30, v31
    v_cvt_pk_bf16_f32 v172, v32, v33
    v_cvt_pk_bf16_f32 v173, v34, v35
    v_cvt_pk_bf16_f32 v174, v36, v37
    v_cvt_pk_bf16_f32 v175, v38, v39
    v_cvt_pk_bf16_f32 v192, v40, v41
    v_cvt_pk_bf16_f32 v193, v42, v43
    v_cvt_pk_bf16_f32 v194, v44, v45
    v_cvt_pk_bf16_f32 v195, v46, v47
    v_pk_fma_f32 v[48:49], v[140:141], v[32:33], v[16:17] op_sel_hi:[0,1,1] neg_lo:[0,0,1] neg_hi:[0,0,1]
    v_pk_fma_f32 v[50:51], v[140:141], v[34:35], v[18:19] op_sel_hi:[0,1,1] neg_lo:[0,0,1] neg_hi:[0,0,1]
    v_pk_fma_f32 v[52:53], v[140:141], v[36:37], v[20:21] op_sel_hi:[0,1,1] neg_lo:[0,0,1] neg_hi:[0,0,1]
    v_pk_fma_f32 v[54:55], v[140:141], v[38:39], v[22:23] op_sel_hi:[0,1,1] neg_lo:[0,0,1] neg_hi:[0,0,1]
    v_pk_fma_f32 v[56:57], v[140:141], v[40:41], v[24:25] op_sel_hi:[0,1,1] neg_lo:[0,0,1] neg_hi:[0,0,1]
    v_pk_fma_f32 v[58:59], v[140:141], v[42:43], v[26:27] op_sel_hi:[0,1,1] neg_lo:[0,0,1] neg_hi:[0,0,1]
    v_pk_fma_f32 v[60:61], v[140:141], v[44:45], v[28:29] op_sel_hi:[0,1,1] neg_lo:[0,0,1] neg_hi:[0,0,1]
    v_pk_fma_f32 v[62:63], v[140:141], v[46:47], v[30:31] op_sel_hi:[0,1,1] neg_lo:[0,0,1] neg_hi:[0,0,1]
    v_cvt_pk_bf16_f32 v176, v48, v49
    v_cvt_pk_bf16_f32 v177, v50, v51
    v_cvt_pk_bf16_f32 v178, v52, v53
    v_cvt_pk_bf16_f32 v179, v54, v55
    v_cvt_pk_bf16_f32 v196, v56, v57
    v_cvt_pk_bf16_f32 v197, v58, v59
    v_cvt_pk_bf16_f32 v198, v60, v61
    v_cvt_pk_bf16_f32 v199, v62, v63
    v_pk_fma_f32 v[16:17], v[140:141], v[48:49], v[32:33] op_sel_hi:[0,1,1] neg_lo:[0,0,1] neg_hi:[0,0,1]
    v_pk_fma_f32 v[18:19], v[140:141], v[50:51], v[34:35] op_sel_hi:[0,1,1] neg_lo:[0,0,1] neg_hi:[0,0,1]
    v_pk_fma_f32 v[20:21], v[140:141], v[52:53], v[36:37] op_sel_hi:[0,1,1] neg_lo:[0,0,1] neg_hi:[0,0,1]
    v_pk_fma_f32 v[22:23], v[140:141], v[54:55], v[38:39] op_sel_hi:[0,1,1] neg_lo:[0,0,1] neg_hi:[0,0,1]
    v_pk_fma_f32 v[24:25], v[140:141], v[56:57], v[40:41] op_sel_hi:[0,1,1] neg_lo:[0,0,1] neg_hi:[0,0,1]
    v_pk_fma_f32 v[26:27], v[140:141], v[58:59], v[42:43] op_sel_hi:[0,1,1] neg_lo:[0,0,1] neg_hi:[0,0,1]
    v_pk_fma_f32 v[28:29], v[140:141], v[60:61], v[44:45] op_sel_hi:[0,1,1] neg_lo:[0,0,1] neg_hi:[0,0,1]
    v_pk_fma_f32 v[30:31], v[140:141], v[62:63], v[46:47] op_sel_hi:[0,1,1] neg_lo:[0,0,1] neg_hi:[0,0,1]
    v_cvt_pk_bf16_f32 v180, v16, v17
    v_cvt_pk_bf16_f32 v181, v18, v19
    v_cvt_pk_bf16_f32 v182, v20, v21
    v_cvt_pk_bf16_f32 v183, v22, v23
    v_cvt_pk_bf16_f32 v200, v24, v25
    v_cvt_pk_bf16_f32 v201, v26, v27
    v_cvt_pk_bf16_f32 v202, v28, v29
    v_cvt_pk_bf16_f32 v203, v30, v31
    v_pk_fma_f32 v[32:33], v[140:141], v[16:17], v[48:49] op_sel_hi:[0,1,1] neg_lo:[0,0,1] neg_hi:[0,0,1]
    v_pk_fma_f32 v[34:35], v[140:141], v[18:19], v[50:51] op_sel_hi:[0,1,1] neg_lo:[0,0,1] neg_hi:[0,0,1]
    v_pk_fma_f32 v[36:37], v[140:141], v[20:21], v[52:53] op_sel_hi:[0,1,1] neg_lo:[0,0,1] neg_hi:[0,0,1]
    v_pk_fma_f32 v[38:39], v[140:141], v[22:23], v[54:55] op_sel_hi:[0,1,1] neg_lo:[0,0,1] neg_hi:[0,0,1]
    v_pk_fma_f32 v[40:41], v[140:141], v[24:25], v[56:57] op_sel_hi:[0,1,1] neg_lo:[0,0,1] neg_hi:[0,0,1]
    v_pk_fma_f32 v[42:43], v[140:141], v[26:27], v[58:59] op_sel_hi:[0,1,1] neg_lo:[0,0,1] neg_hi:[0,0,1]
    v_pk_fma_f32 v[44:45], v[140:141], v[28:29], v[60:61] op_sel_hi:[0,1,1] neg_lo:[0,0,1] neg_hi:[0,0,1]
    v_pk_fma_f32 v[46:47], v[140:141], v[30:31], v[62:63] op_sel_hi:[0,1,1] neg_lo:[0,0,1] neg_hi:[0,0,1]
    v_cvt_pk_bf16_f32 v184, v32, v33
    v_cvt_pk_bf16_f32 v185, v34, v35
    v_cvt_pk_bf16_f32 v186, v36, v37
    v_cvt_pk_bf16_f32 v187, v38, v39
    v_cvt_pk_bf16_f32 v204, v40, v41
    v_cvt_pk_bf16_f32 v205, v42, v43
    v_cvt_pk_bf16_f32 v206, v44, v45
    v_cvt_pk_bf16_f32 v207, v46, v47
    s_cmp_lg_u32 s38, 0
    s_cbranch_scc1 L_k2_kernel_2
    s_mov_b64 exec, s[42:43]
    v_mov_b32 v188, 0x3f353f35
    v_mov_b32 v189, 0x3f353f35
    v_mov_b32 v190, 0x3f353f35
    v_mov_b32 v191, 0x3f353f35
    v_mov_b32 v192, 0x3f353f35
    v_mov_b32 v193, 0x3f353f35
    v_mov_b32 v194, 0x3f353f35
    v_mov_b32 v195, 0x3f353f35
    v_mov_b32 v196, 0x3f353f35
    v_mov_b32 v197, 0x3f353f35
    v_mov_b32 v198, 0x3f353f35
    v_mov_b32 v199, 0x3f353f35
    v_mov_b32 v200, 0x3f353f35
    v_mov_b32 v201, 0x3f353f35
    v_mov_b32 v202, 0x3f353f35
    v_mov_b32 v203, 0x3f353f35
    v_mov_b32 v204, 0x3f353f35
    v_mov_b32 v205, 0x3f353f35
    v_mov_b32 v206, 0x3f353f35
    v_mov_b32 v207, 0x3f353f35
    s_mov_b64 exec, -1
L_k2_kernel_2:
L_k2_kernel_1:
    s_waitcnt lgkmcnt(0)
    s_mov_b32 s4, s24
    s_and_b32 s5, s25, 0xffff
    s_mov_b32 s6, 30408704
    s_mov_b32 s7, 0x00020000
    s_sub_u32 s26, s2, 0
    s_cmp_lt_u32 s2, 320
    s_cbranch_scc1 J_k2_kernel_3
    s_sub_u32 s26, s2, 320
    s_cmp_lt_u32 s2, 512
    s_cbranch_scc1 J_k2_kernel_4
    s_endpgm
J_k2_kernel_3:
    s_setprio 3
    s_and_b32 s27, s26, 7
    s_lshl_b32 s27, s27, 1
    s_bfe_u32 s28, s26, 0x10003
    s_or_b32 s27, s27, s28
    s_andn2_b32 s28, s26, 15
    s_or_b32 s27, s27, s28
    v_and_b32 v1, 15, v0
    v_lshrrev_b32 v2, 4, v0
    v_mul_u32_u24 v3, 82432, v1
    v_lshl_add_u32 v3, v2, 3, v3
    s_mul_i32 s28, s3, 20608
    s_lshl_b32 s29, s27, 6
    s_add_u32 s28, s28, s29
    s_add_u32 s28, s28, 0
    s_add_u32 s29, s28, 1318912
    v_lshlrev_b32 v4, 8, v1
    v_lshl_add_u32 v4, v2, 4, v4
    s_lshl_b32 s30, s3, 6
    s_add_u32 s30, s30, 26214400
    s_add_u32 s31, s30, 4096
    v_lshlrev_b32 v5, 5, v0
    s_lshl_b32 s32, s27, 13
    s_lshl_b32 s33, s3, 11
    s_add_u32 s32, s32, s33
    s_add_u32 s32, s32, 3145728
    buffer_load_dwordx4 v[136:139], v4, s[4:7], s30 offen
    buffer_load_dwordx2 v[88:89], v3, s[4:7], s28 offen offset:0
    buffer_load_dwordx2 v[90:91], v3, s[4:7], s28 offen offset:32
    buffer_load_dwordx4 v[140:143], v4, s[4:7], s31 offen
    buffer_load_dwordx2 v[92:93], v3, s[4:7], s29 offen offset:0
    buffer_load_dwordx2 v[94:95], v3, s[4:7], s29 offen offset:32
    buffer_load_dwordx4 v[96:99], v5, s[4:7], s32 offen offset:0
    buffer_load_dwordx4 v[100:103], v5, s[4:7], s32 offen offset:16
    s_lshl_b32 s33, s3, 4
    v_add_u32 v6, s33, v1
    v_cvt_f32_u32 v6, v6
    v_cvt_f32_u32 v7, v1
    v_lshlrev_b32 v4, 2, v2
    v_cvt_f32_u32 v4, v4
    v_bfe_i32 v104, v0, 0, 1
    v_and_b32 v104, 0x80008000, v104
    v_xor_b32 v106, 0x80000000, v104
    v_mul_f32 v164, 0x3c800000, v6
    v_add_f32 v165, v4, v4
    v_mul_f32 v165, v165, v164
    v_fmamk_f32 v152, v164, 0x00000000, v165
    v_fmamk_f32 v153, v164, 0x3f800000, v165
    v_fmamk_f32 v154, v164, 0x40000000, v165
    v_fmamk_f32 v155, v164, 0x40400000, v165
    v_cos_f32 v156, v152
    v_cos_f32 v157, v153
    v_cos_f32 v158, v154
    v_cos_f32 v159, v155
    v_sin_f32 v160, v152
    v_sin_f32 v161, v153
    v_sin_f32 v162, v154
    v_sin_f32 v163, v155
    v_cvt_pk_bf16_f32 v8, v156, v157
    v_cvt_pk_bf16_f32 v9, v158, v159
    v_cvt_pk_bf16_f32 v24, v160, v161
    v_cvt_pk_bf16_f32 v25, v162, v163
    v_xor_b32 v16, 0x80008000, v24
    v_xor_b32 v17, 0x80008000, v25
    v_fmamk_f32 v152, v164, 0x40800000, v165
    v_fmamk_f32 v153, v164, 0x40a00000, v165
    v_fmamk_f32 v154, v164, 0x40c00000, v165
    v_fmamk_f32 v155, v164, 0x40e00000, v165
    v_cos_f32 v156, v152
    v_cos_f32 v157, v153
    v_cos_f32 v158, v154
    v_cos_f32 v159, v155
    v_sin_f32 v160, v152
    v_sin_f32 v161, v153
    v_sin_f32 v162, v154
    v_sin_f32 v163, v155
    v_cvt_pk_bf16_f32 v10, v156, v157
    v_cvt_pk_bf16_f32 v11, v158, v159
    v_cvt_pk_bf16_f32 v26, v160, v161
    v_cvt_pk_bf16_f32 v27, v162, v163
    v_xor_b32 v18, 0x80008000, v26
    v_xor_b32 v19, 0x80008000, v27
    v_xor_b32 v12, v104, v8
    v_xor_b32 v13, v104, v9
    v_xor_b32 v14, v104, v10
    v_xor_b32 v15, v104, v11
    v_xor_b32 v20, v104, v16
    v_xor_b32 v21, v104, v17
    v_xor_b32 v22, v104, v18
    v_xor_b32 v23, v104, v19
    v_xor_b32 v28, v104, v24
    v_xor_b32 v29, v104, v25
    v_xor_b32 v30, v104, v26
    v_xor_b32 v31, v104, v27
    v_mul_f32 v164, 0x3a000000, v6
    v_mul_f32 v165, v4, v164
    v_fmamk_f32 v152, v164, 0x00000000, v165
    v_fmamk_f32 v153, v164, 0x3f800000, v165
    v_fmamk_f32 v154, v164, 0x40000000, v165
    v_fmamk_f32 v155, v164, 0x40400000, v165
    v_cos_f32 v56, v152
    v_cos_f32 v57, v153
    v_cos_f32 v58, v154
    v_cos_f32 v59, v155
    v_sin_f32_e64 v64, -v152
    v_sin_f32_e64 v65, -v153
    v_sin_f32_e64 v66, -v154
    v_sin_f32_e64 v67, -v155
    v_fmamk_f32 v152, v164, 0x41800000, v165
    v_fmamk_f32 v153, v164, 0x41880000, v165
    v_fmamk_f32 v154, v164, 0x41900000, v165
    v_fmamk_f32 v155, v164, 0x41980000, v165
    v_cos_f32 v60, v152
    v_cos_f32 v61, v153
    v_cos_f32 v62, v154
    v_cos_f32 v63, v155
    v_sin_f32_e64 v68, -v152
    v_sin_f32_e64 v69, -v153
    v_sin_f32_e64 v70, -v154
    v_sin_f32_e64 v71, -v155
    v_mul_f32 v164, 0x3d000000, v7
    v_mul_f32 v165, v4, v164
    v_fmamk_f32 v152, v164, 0x00000000, v165
    v_fmamk_f32 v153, v164, 0x3f800000, v165
    v_fmamk_f32 v154, v164, 0x40000000, v165
    v_fmamk_f32 v155, v164, 0x40400000, v165
    v_cos_f32 v156, v152
    v_cos_f32 v157, v153
    v_cos_f32 v158, v154
    v_cos_f32 v159, v155
    v_sin_f32 v160, v152
    v_sin_f32 v161, v153
    v_sin_f32 v162, v154
    v_sin_f32 v163, v155
    v_cvt_pk_bf16_f32 v32, v156, v157
    v_cvt_pk_bf16_f32 v33, v158, v159
    v_cvt_pk_bf16_f32 v48, v160, v161
    v_cvt_pk_bf16_f32 v49, v162, v163
    v_xor_b32 v40, 0x80008000, v48
    v_xor_b32 v41, 0x80008000, v49
    v_xor_b32 v34, v104, v32
    v_xor_b32 v36, 0x80000000, v32
    v_xor_b32 v38, v106, v32
    v_xor_b32 v35, v104, v33
    v_xor_b32 v37, 0x80000000, v33
    v_xor_b32 v39, v106, v33
    v_xor_b32 v42, v104, v40
    v_xor_b32 v44, 0x80000000, v40
    v_xor_b32 v46, v106, v40
    v_xor_b32 v43, v104, v41
    v_xor_b32 v45, 0x80000000, v41
    v_xor_b32 v47, v106, v41
    v_xor_b32 v50, v104, v48
    v_xor_b32 v52, 0x80000000, v48
    v_xor_b32 v54, v106, v48
    v_xor_b32 v51, v104, v49
    v_xor_b32 v53, 0x80000000, v49
    v_xor_b32 v55, v106, v49
    v_cvt_f32_u32 v6, s33
    v_add_f32 v6, v6, v4
    v_add_f32 v164, 0x00000000, v7
    v_mul_f32 v164, 0x3a000000, v164
    v_mul_f32 v165, v6, v164
    v_fmamk_f32 v152, v164, 0x00000000, v165
    v_fmamk_f32 v153, v164, 0x3f800000, v165
    v_fmamk_f32 v154, v164, 0x40000000, v165
    v_fmamk_f32 v155, v164, 0x40400000, v165
    v_cos_f32 v72, v152
    v_cos_f32 v73, v153
    v_cos_f32 v74, v154
    v_cos_f32 v75, v155
    v_sin_f32_e64 v80, v152
    v_sin_f32_e64 v81, v153
    v_sin_f32_e64 v82, v154
    v_sin_f32_e64 v83, v155
    v_add_f32 v164, 0x41800000, v7
    v_mul_f32 v164, 0x3a000000, v164
    v_mul_f32 v165, v6, v164
    v_fmamk_f32 v152, v164, 0x00000000, v165
    v_fmamk_f32 v153, v164, 0x3f800000, v165
    v_fmamk_f32 v154, v164, 0x40000000, v165
    v_fmamk_f32 v155, v164, 0x40400000, v165
    v_cos_f32 v76, v152
    v_cos_f32 v77, v153
    v_cos_f32 v78, v154
    v_cos_f32 v79, v155
    v_sin_f32_e64 v84, v152
    v_sin_f32_e64 v85, v153
    v_sin_f32_e64 v86, v154
    v_sin_f32_e64 v87, v155
    s_lshr_b32 s34, s3, 1
    s_lshl_b32 s34, s34, 10
    s_and_b32 s35, s3, 1
    s_lshl_b32 s35, s35, 9
    s_add_u32 s34, s34, s35
    v_lshrrev_b32 v6, 1, v2
    v_lshlrev_b32 v6, 8, v6
    v_lshl_add_u32 v6, v1, 4, v6
    v_and_b32 v7, 1, v2
    v_lshl_add_u32 v6, v7, 3, v6
    v_add_u32 v6, s34, v6
    v_lshlrev_b32 v7, 4, v0
    s_mov_b32 s36, 0x3acccccd
    v_mov_b32 v4, 0x3727c5ac
    s_mov_b32 s37, 0xffff0000
    s_waitcnt vmcnt(2)
    v_fma_f32 v136, v136, s36, v4
    v_fma_f32 v137, v137, s36, v4
    v_fma_f32 v138, v138, s36, v4
    v_fma_f32 v139, v139, s36, v4
    v_fma_f32 v140, v140, s36, v4
    v_fma_f32 v141, v141, s36, v4
    v_fma_f32 v142, v142, s36, v4
    v_fma_f32 v143, v143, s36, v4
    v_rsq_f32 v136, v136
    v_rsq_f32 v137, v137
    v_rsq_f32 v138, v138
    v_rsq_f32 v139, v139
    v_rsq_f32 v140, v140
    v_rsq_f32 v141, v141
    v_rsq_f32 v142, v142
    v_rsq_f32 v143, v143
    v_lshlrev_b32 v152, 16, v88
    v_and_b32 v153, s37, v88
    v_lshlrev_b32 v154, 16, v89
    v_and_b32 v155, s37, v89
    v_lshlrev_b32 v156, 16, v90
    v_and_b32 v157, s37, v90
    v_lshlrev_b32 v158, 16, v91
    v_and_b32 v159, s37, v91
    v_lshlrev_b32 v160, 16, v92
    v_and_b32 v161, s37, v92
    v_lshlrev_b32 v162, 16, v93
    v_and_b32 v163, s37, v93
    v_lshlrev_b32 v164, 16, v94
    v_and_b32 v165, s37, v94
    v_lshlrev_b32 v166, 16, v95
    v_and_b32 v167, s37, v95
    v_pk_mul_f32 v[152:153], v[152:153], v[136:137]
    v_pk_mul_f32 v[154:155], v[154:155], v[138:139]
    v_cvt_pk_bf16_f32 v152, v152, v153
    v_cvt_pk_bf16_f32 v153, v154, v155
    ds_write_b64 v6, v[152:153] offset:0
    v_pk_mul_f32 v[156:157], v[156:157], v[136:137]
    v_pk_mul_f32 v[158:159], v[158:159], v[138:139]
    v_cvt_pk_bf16_f32 v156, v156, v157
    v_cvt_pk_bf16_f32 v157, v158, v159
    ds_write_b64 v6, v[156:157] offset:4096
    v_pk_mul_f32 v[160:161], v[160:161], v[140:141]
    v_pk_mul_f32 v[162:163], v[162:163], v[142:143]
    v_cvt_pk_bf16_f32 v160, v160, v161
    v_cvt_pk_bf16_f32 v161, v162, v163
    ds_write_b64 v6, v[160:161] offset:2048
    v_pk_mul_f32 v[164:165], v[164:165], v[140:141]
    v_pk_mul_f32 v[166:167], v[166:167], v[142:143]
    v_cvt_pk_bf16_f32 v164, v164, v165
    v_cvt_pk_bf16_f32 v165, v166, v167
    ds_write_b64 v6, v[164:165] offset:6144
    s_waitcnt lgkmcnt(0)
    s_barrier
    ds_read_b128 v[104:107], v7 offset:0
    ds_read_b128 v[108:111], v7 offset:1024
    ds_read_b128 v[112:115], v7 offset:4096
    ds_read_b128 v[116:119], v7 offset:5120
    ds_read_b128 v[120:123], v7 offset:2048
    ds_read_b128 v[124:127], v7 offset:3072
    ds_read_b128 v[128:131], v7 offset:6144
    ds_read_b128 v[132:135], v7 offset:7168
    s_waitcnt lgkmcnt(4)
    v_mfma_f32_16x16x32_bf16 v[136:139], v[104:107], v[8:11], 0
    v_mfma_f32_16x16x32_bf16 v[144:147], v[104:107], v[16:19], 0
    v_mfma_f32_16x16x32_bf16 v[136:139], v[112:115], v[24:27], v[136:139]
    v_mfma_f32_16x16x32_bf16 v[144:147], v[112:115], v[8:11], v[144:147]
    v_mfma_f32_16x16x32_bf16 v[136:139], v[108:111], v[12:15], v[136:139]
    v_mfma_f32_16x16x32_bf16 v[144:147], v[108:111], v[20:23], v[144:147]
    v_mfma_f32_16x16x32_bf16 v[136:139], v[116:119], v[28:31], v[136:139]
    v_mfma_f32_16x16x32_bf16 v[144:147], v[116:119], v[12:15], v[144:147]
    s_waitcnt lgkmcnt(0)
    v_mfma_f32_16x16x32_bf16 v[140:143], v[120:123], v[8:11], 0
    v_mfma_f32_16x16x32_bf16 v[148:151], v[120:123], v[16:19], 0
    v_mfma_f32_16x16x32_bf16 v[140:143], v[128:131], v[24:27], v[140:143]
    v_mfma_f32_16x16x32_bf16 v[148:151], v[128:131], v[8:11], v[148:151]
    v_mfma_f32_16x16x32_bf16 v[140:143], v[124:127], v[12:15], v[140:143]
    v_mfma_f32_16x16x32_bf16 v[148:151], v[124:127], v[20:23], v[148:151]
    v_mfma_f32_16x16x32_bf16 v[140:143], v[132:135], v[28:31], v[140:143]
    v_mfma_f32_16x16x32_bf16 v[148:151], v[132:135], v[12:15], v[148:151]
    s_nop 7
    v_mul_f32 v152, v136, v56
    v_mul_f32 v160, v136, v64
    v_mul_f32 v153, v137, v57
    v_mul_f32 v161, v137, v65
    v_mul_f32 v154, v138, v58
    v_mul_f32 v162, v138, v66
    v_mul_f32 v155, v139, v59
    v_mul_f32 v163, v139, v67
    v_mul_f32 v156, v140, v60
    v_mul_f32 v164, v140, v68
    v_mul_f32 v157, v141, v61
    v_mul_f32 v165, v141, v69
    v_mul_f32 v158, v142, v62
    v_mul_f32 v166, v142, v70
    v_mul_f32 v159, v143, v63
    v_mul_f32 v167, v143, v71
    v_fma_f32 v152, -v144, v64, v152
    v_fmac_f32 v160, v144, v56
    v_fma_f32 v153, -v145, v65, v153
    v_fmac_f32 v161, v145, v57
    v_fma_f32 v154, -v146, v66, v154
    v_fmac_f32 v162, v146, v58
    v_fma_f32 v155, -v147, v67, v155
    v_fmac_f32 v163, v147, v59
    v_fma_f32 v156, -v148, v68, v156
    v_fmac_f32 v164, v148, v60
    v_fma_f32 v157, -v149, v69, v157
    v_fmac_f32 v165, v149, v61
    v_fma_f32 v158, -v150, v70, v158
    v_fmac_f32 v166, v150, v62
    v_fma_f32 v159, -v151, v71, v159
    v_fmac_f32 v167, v151, v63
    v_cvt_pk_bf16_f32 v104, v152, v153
    v_cvt_pk_bf16_f32 v108, v160, v161
    v_cvt_pk_bf16_f32 v105, v154, v155
    v_cvt_pk_bf16_f32 v109, v162, v163
    v_cvt_pk_bf16_f32 v106, v156, v157
    v_cvt_pk_bf16_f32 v110, v164, v165
    v_cvt_pk_bf16_f32 v107, v158, v159
    v_cvt_pk_bf16_f32 v111, v166, v167
    s_nop 1
    v_mfma_f32_16x16x32_bf16 v[136:139], v[32:35], v[104:107], 0
    v_mfma_f32_16x16x32_bf16 v[144:147], v[40:43], v[104:107], 0
    v_mfma_f32_16x16x32_bf16 v[136:139], v[48:51], v[108:111], v[136:139]
    v_mfma_f32_16x16x32_bf16 v[144:147], v[32:35], v[108:111], v[144:147]
    v_mfma_f32_16x16x32_bf16 v[140:143], v[36:39], v[104:107], 0
    v_mfma_f32_16x16x32_bf16 v[148:151], v[44:47], v[104:107], 0
    v_mfma_f32_16x16x32_bf16 v[140:143], v[52:55], v[108:111], v[140:143]
    v_mfma_f32_16x16x32_bf16 v[148:151], v[36:39], v[108:111], v[148:151]
    s_waitcnt vmcnt(0)
    v_lshlrev_b32 v112, 16, v96
    v_and_b32 v120, s37, v96
    v_lshlrev_b32 v113, 16, v97
    v_and_b32 v121, s37, v97
    v_lshlrev_b32 v114, 16, v98
    v_and_b32 v122, s37, v98
    v_lshlrev_b32 v115, 16, v99
    v_and_b32 v123, s37, v99
    v_lshlrev_b32 v116, 16, v100
    v_and_b32 v124, s37, v100
    v_lshlrev_b32 v117, 16, v101
    v_and_b32 v125, s37, v101
    v_lshlrev_b32 v118, 16, v102
    v_and_b32 v126, s37, v102
    v_lshlrev_b32 v119, 16, v103
    v_and_b32 v127, s37, v103
    v_mul_f32 v152, v136, v112
    v_mul_f32 v160, v136, v120
    v_mul_f32 v153, v137, v113
    v_mul_f32 v161, v137, v121
    v_mul_f32 v154, v138, v114
    v_mul_f32 v162, v138, v122
    v_mul_f32 v155, v139, v115
    v_mul_f32 v163, v139, v123
    v_mul_f32 v156, v140, v116
    v_mul_f32 v164, v140, v124
    v_mul_f32 v157, v141, v117
    v_mul_f32 v165, v141, v125
    v_mul_f32 v158, v142, v118
    v_mul_f32 v166, v142, v126
    v_mul_f32 v159, v143, v119
    v_mul_f32 v167, v143, v127
    v_fma_f32 v152, -v144, v120, v152
    v_fmac_f32 v160, v144, v112
    v_fma_f32 v153, -v145, v121, v153
    v_fmac_f32 v161, v145, v113
    v_fma_f32 v154, -v146, v122, v154
    v_fmac_f32 v162, v146, v114
    v_fma_f32 v155, -v147, v123, v155
    v_fmac_f32 v163, v147, v115
    v_fma_f32 v156, -v148, v124, v156
    v_fmac_f32 v164, v148, v116
    v_fma_f32 v157, -v149, v125, v157
    v_fmac_f32 v165, v149, v117
    v_fma_f32 v158, -v150, v126, v158
    v_fmac_f32 v166, v150, v118
    v_fma_f32 v159, -v151, v127, v159
    v_fmac_f32 v167, v151, v119
    v_cvt_pk_bf16_f32 v104, v152, v153
    v_cvt_pk_bf16_f32 v108, v160, v161
    v_cvt_pk_bf16_f32 v105, v154, v155
    v_cvt_pk_bf16_f32 v109, v162, v163
    v_cvt_pk_bf16_f32 v106, v156, v157
    v_cvt_pk_bf16_f32 v110, v164, v165
    v_cvt_pk_bf16_f32 v107, v158, v159
    v_cvt_pk_bf16_f32 v111, v166, v167
    s_nop 1
    v_mfma_f32_16x16x32_bf16 v[136:139], v[104:107], v[32:35], 0
    v_mfma_f32_16x16x32_bf16 v[144:147], v[104:107], v[48:51], 0
    v_mfma_f32_16x16x32_bf16 v[136:139], v[108:111], v[40:43], v[136:139]
    v_mfma_f32_16x16x32_bf16 v[144:147], v[108:111], v[32:35], v[144:147]
    v_mfma_f32_16x16x32_bf16 v[140:143], v[104:107], v[36:39], 0
    v_mfma_f32_16x16x32_bf16 v[148:151], v[104:107], v[52:55], 0
    v_mfma_f32_16x16x32_bf16 v[140:143], v[108:111], v[44:47], v[140:143]
    v_mfma_f32_16x16x32_bf16 v[148:151], v[108:111], v[36:39], v[148:151]
    s_nop 7
    v_mul_f32 v152, v136, v72
    v_mul_f32 v160, v136, v80
    v_mul_f32 v153, v137, v73
    v_mul_f32 v161, v137, v81
    v_mul_f32 v154, v138, v74
    v_mul_f32 v162, v138, v82
    v_mul_f32 v155, v139, v75
    v_mul_f32 v163, v139, v83
    v_mul_f32 v156, v140, v76
    v_mul_f32 v164, v140, v84
    v_mul_f32 v157, v141, v77
    v_mul_f32 v165, v141, v85
    v_mul_f32 v158, v142, v78
    v_mul_f32 v166, v142, v86
    v_mul_f32 v159, v143, v79
    v_mul_f32 v167, v143, v87
    v_fma_f32 v152, -v144, v80, v152
    v_fmac_f32 v160, v144, v72
    v_fma_f32 v153, -v145, v81, v153
    v_fmac_f32 v161, v145, v73
    v_fma_f32 v154, -v146, v82, v154
    v_fmac_f32 v162, v146, v74
    v_fma_f32 v155, -v147, v83, v155
    v_fmac_f32 v163, v147, v75
    v_fma_f32 v156, -v148, v84, v156
    v_fmac_f32 v164, v148, v76
    v_fma_f32 v157, -v149, v85, v157
    v_fmac_f32 v165, v149, v77
    v_fma_f32 v158, -v150, v86, v158
    v_fmac_f32 v166, v150, v78
    v_fma_f32 v159, -v151, v87, v159
    v_fmac_f32 v167, v151, v79
    v_cvt_pk_bf16_f32 v104, v152, v153
    v_cvt_pk_bf16_f32 v108, v160, v161
    v_cvt_pk_bf16_f32 v105, v154, v155
    v_cvt_pk_bf16_f32 v109, v162, v163
    v_cvt_pk_bf16_f32 v106, v156, v157
    v_cvt_pk_bf16_f32 v110, v164, v165
    v_cvt_pk_bf16_f32 v107, v158, v159
    v_cvt_pk_bf16_f32 v111, v166, v167
    s_nop 1
    ds_write_b64 v6, v[104:105] offset:8192
    ds_write_b64 v6, v[108:109] offset:12288
    ds_write_b64 v6, v[106:107] offset:10240
    ds_write_b64 v6, v[110:111] offset:14336
    s_waitcnt lgkmcnt(0)
    s_barrier
    ds_read_b128 v[104:107], v7 offset:8192
    ds_read_b128 v[108:111], v7 offset:9216
    ds_read_b128 v[112:115], v7 offset:12288
    ds_read_b128 v[116:119], v7 offset:13312
    ds_read_b128 v[120:123], v7 offset:10240
    ds_read_b128 v[124:127], v7 offset:11264
    ds_read_b128 v[128:131], v7 offset:14336
    ds_read_b128 v[132:135], v7 offset:15360
    v_lshlrev_b32 v152, 16, v88
    v_and_b32 v153, s37, v88
    v_lshlrev_b32 v154, 16, v89
    v_and_b32 v155, s37, v89
    v_lshlrev_b32 v156, 16, v90
    v_and_b32 v157, s37, v90
    v_lshlrev_b32 v158, 16, v91
    v_and_b32 v159, s37, v91
    v_lshlrev_b32 v160, 16, v92
    v_and_b32 v161, s37, v92
    v_lshlrev_b32 v162, 16, v93
    v_and_b32 v163, s37, v93
    v_lshlrev_b32 v164, 16, v94
    v_and_b32 v165, s37, v94
    v_lshlrev_b32 v166, 16, v95
    v_and_b32 v167, s37, v95
    s_waitcnt lgkmcnt(4)
    v_mfma_f32_16x16x32_bf16 v[136:139], v[8:11], v[104:107], 0
    v_mfma_f32_16x16x32_bf16 v[144:147], v[24:27], v[104:107], 0
    v_mfma_f32_16x16x32_bf16 v[136:139], v[16:19], v[112:115], v[136:139]
    v_mfma_f32_16x16x32_bf16 v[144:147], v[8:11], v[112:115], v[144:147]
    v_mfma_f32_16x16x32_bf16 v[136:139], v[12:15], v[108:111], v[136:139]
    v_mfma_f32_16x16x32_bf16 v[144:147], v[28:31], v[108:111], v[144:147]
    v_mfma_f32_16x16x32_bf16 v[136:139], v[20:23], v[116:119], v[136:139]
    v_mfma_f32_16x16x32_bf16 v[144:147], v[12:15], v[116:119], v[144:147]
    s_waitcnt lgkmcnt(0)
    v_mfma_f32_16x16x32_bf16 v[140:143], v[8:11], v[120:123], 0
    v_mfma_f32_16x16x32_bf16 v[148:151], v[24:27], v[120:123], 0
    v_mfma_f32_16x16x32_bf16 v[140:143], v[16:19], v[128:131], v[140:143]
    v_mfma_f32_16x16x32_bf16 v[148:151], v[8:11], v[128:131], v[148:151]
    v_mfma_f32_16x16x32_bf16 v[140:143], v[12:15], v[124:127], v[140:143]
    v_mfma_f32_16x16x32_bf16 v[148:151], v[28:31], v[124:127], v[148:151]
    v_mfma_f32_16x16x32_bf16 v[140:143], v[20:23], v[132:135], v[140:143]
    v_mfma_f32_16x16x32_bf16 v[148:151], v[12:15], v[132:135], v[148:151]
    s_mov_b32 s36, 0x3a000000
    s_cmp_eq_u32 s27, 0
    s_cselect_b32 s37, 0, s36
    s_nop 5
    v_fmac_f32 v152, s36, v136
    v_fmac_f32 v153, s36, v137
    v_fmac_f32 v154, s36, v138
    v_fmac_f32 v155, s36, v139
    v_cvt_pk_bf16_f32 v152, v152, v153
    v_cvt_pk_bf16_f32 v153, v154, v155
    buffer_store_dwordx2 v[152:153], v3, s[4:7], s28 offen offset:0 sc1
    v_fmac_f32 v156, s37, v144
    v_fmac_f32 v157, s37, v145
    v_fmac_f32 v158, s37, v146
    v_fmac_f32 v159, s37, v147
    v_cvt_pk_bf16_f32 v156, v156, v157
    v_cvt_pk_bf16_f32 v157, v158, v159
    buffer_store_dwordx2 v[156:157], v3, s[4:7], s28 offen offset:32 sc1
    v_fmac_f32 v160, s36, v140
    v_fmac_f32 v161, s36, v141
    v_fmac_f32 v162, s36, v142
    v_fmac_f32 v163, s36, v143
    v_cvt_pk_bf16_f32 v160, v160, v161
    v_cvt_pk_bf16_f32 v161, v162, v163
    buffer_store_dwordx2 v[160:161], v3, s[4:7], s29 offen offset:0 sc1
    v_fmac_f32 v164, s37, v148
    v_fmac_f32 v165, s37, v149
    v_fmac_f32 v166, s37, v150
    v_fmac_f32 v167, s37, v151
    v_cvt_pk_bf16_f32 v164, v164, v165
    v_cvt_pk_bf16_f32 v165, v166, v167
    buffer_store_dwordx2 v[164:165], v3, s[4:7], s29 offen offset:32 sc1
    s_endpgm
J_k2_kernel_4:
    s_lshr_b32 s48, s26, 5
    s_bfe_u32 s32, s26, 0x20004
    s_cmp_ge_u32 s26, 128
    s_cselect_b32 s48, s32, s48
    s_lshl_b32 s48, s48, 3
    s_and_b32 s32, s26, 7
    s_add_u32 s48, s48, s32
    s_cmp_lt_u32 s48, 30
    s_cbranch_scc1 L_k2_kernel_6
    s_endpgm
L_k2_kernel_6:
    s_mov_b32 s28, s16
    s_and_b32 s29, s17, 0xffff
    s_mov_b32 s30, 2457600
    s_mov_b32 s31, 0x00020000
    s_setprio 0
    v_lshrrev_b32 v5, 3, v0
    v_and_b32 v6, 7, v0
    v_mul_u32_u24 v3, 3840, v5
    v_and_b32 v5, 2, v5
    s_mul_i32 s34, s3, 61440
    s_lshl_b32 s36, s48, 7
    s_add_u32 s34, s34, s36
    s_lshl_b32 m0, s3, 11
    v_xor_b32 v5, v5, v6
    v_lshl_add_u32 v3, v5, 4, v3
    v_xor_b32 v11, 64, v3
    v_add_u32 v11, 30720, v11
    buffer_load_dwordx4 v3, s[28:31], s34 offen lds
    s_add_u32 m0, m0, 1024
    s_nop 0
    buffer_load_dwordx4 v11, s[28:31], s34 offen lds
    s_add_u32 m0, m0, 7168
    s_add_u32 s34, s34, 245760
    buffer_load_dwordx4 v3, s[28:31], s34 offen lds
    s_add_u32 m0, m0, 1024
    s_nop 0
    buffer_load_dwordx4 v11, s[28:31], s34 offen lds
    s_add_u32 m0, m0, 7168
    s_add_u32 s34, s34, 245760
    buffer_load_dwordx4 v3, s[28:31], s34 offen lds
    s_add_u32 m0, m0, 1024
    s_nop 0
    buffer_load_dwordx4 v11, s[28:31], s34 offen lds
    s_add_u32 m0, m0, 7168
    s_add_u32 s34, s34, 245760
    buffer_load_dwordx4 v3, s[28:31], s34 offen lds
    s_add_u32 m0, m0, 1024
    s_nop 0
    buffer_load_dwordx4 v11, s[28:31], s34 offen lds
    s_add_u32 m0, m0, 7168
    s_add_u32 s34, s34, 245760
    buffer_load_dwordx4 v3, s[28:31], s34 offen lds
    s_add_u32 m0, m0, 1024
    s_nop 0
    buffer_load_dwordx4 v11, s[28:31], s34 offen lds
    s_add_u32 m0, m0, 7168
    s_add_u32 s34, s34, 245760
    buffer_load_dwordx4 v3, s[28:31], s34 offen lds
    s_add_u32 m0, m0, 1024
    s_nop 0
    buffer_load_dwordx4 v11, s[28:31], s34 offen lds
    s_add_u32 m0, m0, 7168
    s_add_u32 s34, s34, 245760
    buffer_load_dwordx4 v3, s[28:31], s34 offen lds
    s_add_u32 m0, m0, 1024
    s_nop 0
    buffer_load_dwordx4 v11, s[28:31], s34 offen lds
    s_add_u32 m0, m0, 7168
    s_add_u32 s34, s34, 245760
    buffer_load_dwordx4 v3, s[28:31], s34 offen lds
    s_add_u32 m0, m0, 1024
    s_nop 0
    buffer_load_dwordx4 v11, s[28:31], s34 offen lds
    s_add_u32 m0, m0, 7168
    s_add_u32 s34, s34, 245760
    buffer_load_dwordx4 v3, s[28:31], s34 offen lds
    s_add_u32 m0, m0, 1024
    s_nop 0
    buffer_load_dwordx4 v11, s[28:31], s34 offen lds
    s_add_u32 m0, m0, 7168
    s_add_u32 s34, s34, 245760
    buffer_load_dwordx4 v3, s[28:31], s34 offen lds
    s_add_u32 m0, m0, 1024
    s_nop 0
    buffer_load_dwordx4 v11, s[28:31], s34 offen lds
    s_bfe_u32 s33, s26, 0x20003
    s_bfe_u32 s32, s26, 0x10003
    s_lshl_b32 s32, s32, 1
    s_cmp_ge_u32 s26, 128
    s_cselect_b32 s33, s32, s33
    s_cselect_b32 s32, 4, 0
    s_mul_i32 s49, s32, 10240
    v_and_b32 v136, 15, v0
    s_lshl_b32 s40, s32, 4
    v_add_u32 v136, s40, v136
    v_lshlrev_b32 v136, 2, v136
    v_add_u32 v136, s33, v136
    v_cmp_eq_u32 vcc, 0, v136
    v_mov_b32 v137, 320
    v_mov_b32 v138, 0x3e000000
    v_cndmask_b32 v136, v136, v137, vcc
    v_cndmask_b32 v138, 0, v138, vcc
    s_mov_b64 s[42:43], vcc
    v_cvt_f32_u32 v136, v136
    v_mul_f32 v136, 0x3acccccd, v136
    v_lshrrev_b32 v137, 4, v0
    v_lshlrev_b32 v137, 3, v137
    v_cvt_f32_u32 v137, v137
    v_fma_f32 v137, v137, v136, v138
    v_mul_f32 v140, 0x42000000, v136
    v_cos_f32 v138, v136
    v_cos_f32 v140, v140
    v_fmamk_f32 v142, v136, 0x3f800000, v137
    v_fmamk_f32 v143, v136, 0x42000000, v137
    v_fmamk_f32 v144, v136, 0x42040000, v137
    v_cos_f32 v16, v137
    v_sin_f32_e64 v24, -v137
    v_cos_f32 v17, v142
    v_sin_f32_e64 v25, -v142
    v_cos_f32 v32, v143
    v_sin_f32_e64 v40, -v143
    v_cos_f32 v33, v144
    v_sin_f32_e64 v41, -v144
    v_add_f32 v138, v138, v138
    v_add_f32 v140, v140, v140
    v_fma_f32 v18, v138, v17, -v16
    v_fma_f32 v26, v138, v25, -v24
    v_fma_f32 v34, v138, v33, -v32
    v_fma_f32 v42, v138, v41, -v40
    v_fma_f32 v19, v138, v18, -v17
    v_fma_f32 v27, v138, v26, -v25
    v_fma_f32 v35, v138, v34, -v33
    v_fma_f32 v43, v138, v42, -v41
    v_fma_f32 v20, v138, v19, -v18
    v_fma_f32 v28, v138, v27, -v26
    v_fma_f32 v36, v138, v35, -v34
    v_fma_f32 v44, v138, v43, -v42
    v_fma_f32 v21, v138, v20, -v19
    v_fma_f32 v29, v138, v28, -v27
    v_fma_f32 v37, v138, v36, -v35
    v_fma_f32 v45, v138, v44, -v43
    v_fma_f32 v22, v138, v21, -v20
    v_fma_f32 v30, v138, v29, -v28
    v_fma_f32 v38, v138, v37, -v36
    v_fma_f32 v46, v138, v45, -v44
    v_fma_f32 v23, v138, v22, -v21
    v_fma_f32 v31, v138, v30, -v29
    v_fma_f32 v39, v138, v38, -v37
    v_fma_f32 v47, v138, v46, -v45
    v_cvt_pk_bf16_f32 v96, v16, v17
    v_cvt_pk_bf16_f32 v97, v18, v19
    v_cvt_pk_bf16_f32 v98, v20, v21
    v_cvt_pk_bf16_f32 v99, v22, v23
    v_cvt_pk_bf16_f32 v100, v24, v25
    v_cvt_pk_bf16_f32 v101, v26, v27
    v_cvt_pk_bf16_f32 v102, v28, v29
    v_cvt_pk_bf16_f32 v103, v30, v31
    v_cvt_pk_bf16_f32 v104, v32, v33
    v_cvt_pk_bf16_f32 v105, v34, v35
    v_cvt_pk_bf16_f32 v106, v36, v37
    v_cvt_pk_bf16_f32 v107, v38, v39
    v_cvt_pk_bf16_f32 v108, v40, v41
    v_cvt_pk_bf16_f32 v109, v42, v43
    v_cvt_pk_bf16_f32 v110, v44, v45
    v_cvt_pk_bf16_f32 v111, v46, v47
    v_pk_fma_f32 v[48:49], v[140:141], v[32:33], v[16:17] op_sel_hi:[0,1,1] neg_lo:[0,0,1] neg_hi:[0,0,1]
    v_pk_fma_f32 v[50:51], v[140:141], v[34:35], v[18:19] op_sel_hi:[0,1,1] neg_lo:[0,0,1] neg_hi:[0,0,1]
    v_pk_fma_f32 v[52:53], v[140:141], v[36:37], v[20:21] op_sel_hi:[0,1,1] neg_lo:[0,0,1] neg_hi:[0,0,1]
    v_pk_fma_f32 v[54:55], v[140:141], v[38:39], v[22:23] op_sel_hi:[0,1,1] neg_lo:[0,0,1] neg_hi:[0,0,1]
    v_pk_fma_f32 v[56:57], v[140:141], v[40:41], v[24:25] op_sel_hi:[0,1,1] neg_lo:[0,0,1] neg_hi:[0,0,1]
    v_pk_fma_f32 v[58:59], v[140:141], v[42:43], v[26:27] op_sel_hi:[0,1,1] neg_lo:[0,0,1] neg_hi:[0,0,1]
    v_pk_fma_f32 v[60:61], v[140:141], v[44:45], v[28:29] op_sel_hi:[0,1,1] neg_lo:[0,0,1] neg_hi:[0,0,1]
    v_pk_fma_f32 v[62:63], v[140:141], v[46:47], v[30:31] op_sel_hi:[0,1,1] neg_lo:[0,0,1] neg_hi:[0,0,1]
    v_cvt_pk_bf16_f32 v112, v48, v49
    v_cvt_pk_bf16_f32 v113, v50, v51
    v_cvt_pk_bf16_f32 v114, v52, v53
    v_cvt_pk_bf16_f32 v115, v54, v55
    v_cvt_pk_bf16_f32 v116, v56, v57
    v_cvt_pk_bf16_f32 v117, v58, v59
    v_cvt_pk_bf16_f32 v118, v60, v61
    v_cvt_pk_bf16_f32 v119, v62, v63
    v_pk_fma_f32 v[16:17], v[140:141], v[48:49], v[32:33] op_sel_hi:[0,1,1] neg_lo:[0,0,1] neg_hi:[0,0,1]
    v_pk_fma_f32 v[18:19], v[140:141], v[50:51], v[34:35] op_sel_hi:[0,1,1] neg_lo:[0,0,1] neg_hi:[0,0,1]
    v_pk_fma_f32 v[20:21], v[140:141], v[52:53], v[36:37] op_sel_hi:[0,1,1] neg_lo:[0,0,1] neg_hi:[0,0,1]
    v_pk_fma_f32 v[22:23], v[140:141], v[54:55], v[38:39] op_sel_hi:[0,1,1] neg_lo:[0,0,1] neg_hi:[0,0,1]
    v_pk_fma_f32 v[24:25], v[140:141], v[56:57], v[40:41] op_sel_hi:[0,1,1] neg_lo:[0,0,1] neg_hi:[0,0,1]
    v_pk_fma_f32 v[26:27], v[140:141], v[58:59], v[42:43] op_sel_hi:[0,1,1] neg_lo:[0,0,1] neg_hi:[0,0,1]
    v_pk_fma_f32 v[28:29], v[140:141], v[60:61], v[44:45] op_sel_hi:[0,1,1] neg_lo:[0,0,1] neg_hi:[0,0,1]
    v_pk_fma_f32 v[30:31], v[140:141], v[62:63], v[46:47] op_sel_hi:[0,1,1] neg_lo:[0,0,1] neg_hi:[0,0,1]
    v_cvt_pk_bf16_f32 v120, v16, v17
    v_cvt_pk_bf16_f32 v121, v18, v19
    v_cvt_pk_bf16_f32 v122, v20, v21
    v_cvt_pk_bf16_f32 v123, v22, v23
    v_cvt_pk_bf16_f32 v124, v24, v25
    v_cvt_pk_bf16_f32 v125, v26, v27
    v_cvt_pk_bf16_f32 v126, v28, v29
    v_cvt_pk_bf16_f32 v127, v30, v31
    v_pk_fma_f32 v[32:33], v[140:141], v[16:17], v[48:49] op_sel_hi:[0,1,1] neg_lo:[0,0,1] neg_hi:[0,0,1]
    v_pk_fma_f32 v[34:35], v[140:141], v[18:19], v[50:51] op_sel_hi:[0,1,1] neg_lo:[0,0,1] neg_hi:[0,0,1]
    v_pk_fma_f32 v[36:37], v[140:141], v[20:21], v[52:53] op_sel_hi:[0,1,1] neg_lo:[0,0,1] neg_hi:[0,0,1]
    v_pk_fma_f32 v[38:39], v[140:141], v[22:23], v[54:55] op_sel_hi:[0,1,1] neg_lo:[0,0,1] neg_hi:[0,0,1]
    v_pk_fma_f32 v[40:41], v[140:141], v[24:25], v[56:57] op_sel_hi:[0,1,1] neg_lo:[0,0,1] neg_hi:[0,0,1]
    v_pk_fma_f32 v[42:43], v[140:141], v[26:27], v[58:59] op_sel_hi:[0,1,1] neg_lo:[0,0,1] neg_hi:[0,0,1]
    v_pk_fma_f32 v[44:45], v[140:141], v[28:29], v[60:61] op_sel_hi:[0,1,1] neg_lo:[0,0,1] neg_hi:[0,0,1]
    v_pk_fma_f32 v[46:47], v[140:141], v[30:31], v[62:63] op_sel_hi:[0,1,1] neg_lo:[0,0,1] neg_hi:[0,0,1]
    v_cvt_pk_bf16_f32 v128, v32, v33
    v_cvt_pk_bf16_f32 v129, v34, v35
    v_cvt_pk_bf16_f32 v130, v36, v37
    v_cvt_pk_bf16_f32 v131, v38, v39
    v_cvt_pk_bf16_f32 v132, v40, v41
    v_cvt_pk_bf16_f32 v133, v42, v43
    v_cvt_pk_bf16_f32 v134, v44, v45
    v_cvt_pk_bf16_f32 v135, v46, v47
    s_cmp_lg_u32 s33, 0
    s_cbranch_scc1 L_k2_kernel_7
    s_mov_b64 exec, s[42:43]
    v_mov_b32 v100, 0x3f353f35
    v_mov_b32 v101, 0x3f353f35
    v_mov_b32 v102, 0x3f353f35
    v_mov_b32 v103, 0x3f353f35
    v_mov_b32 v108, 0x3f353f35
    v_mov_b32 v109, 0x3f353f35
    v_mov_b32 v110, 0x3f353f35
    v_mov_b32 v111, 0x3f353f35
    v_mov_b32 v116, 0x3f353f35
    v_mov_b32 v117, 0x3f353f35
    v_mov_b32 v118, 0x3f353f35
    v_mov_b32 v119, 0x3f353f35
    v_mov_b32 v124, 0x3f353f35
    v_mov_b32 v125, 0x3f353f35
    v_mov_b32 v126, 0x3f353f35
    v_mov_b32 v127, 0x3f353f35
    v_mov_b32 v132, 0x3f353f35
    v_mov_b32 v133, 0x3f353f35
    v_mov_b32 v134, 0x3f353f35
    v_mov_b32 v135, 0x3f353f35
    s_mov_b64 exec, -1
L_k2_kernel_7:
    v_and_b32 v1, 15, v0
    v_lshrrev_b32 v2, 4, v0
    v_lshlrev_b32 v4, 4, v0
    v_bfe_u32 v3, v0, 2, 2
    v_lshl_add_u32 v3, v2, 3, v3
    v_lshlrev_b32 v3, 7, v3
    v_and_b32 v5, 3, v0
    v_lshl_add_u32 v3, v5, 3, v3
    v_bfe_u32 v5, v0, 3, 2
    v_xor_b32 v5, s3, v5
    v_lshl_add_u32 v3, v5, 5, v3
    v_add_u32 v11, 40960, v3
    s_mul_i32 s32, s48, 26
    s_lshr_b32 s32, s32, 8
    s_mul_i32 s34, s32, 10
    s_sub_u32 s34, s48, s34
    s_lshl_b32 s34, s34, 2
    s_add_u32 s34, s34, s3
    s_lshl_b32 s36, s34, 4
    s_mul_i32 s44, s32, 819200
    s_mul_i32 s35, s33, 51200
    s_add_u32 s44, s44, s35
    s_add_u32 s44, s44, 6281216
    s_add_u32 s44, s44, s49
    s_mov_b32 s48, 0x3d64f92e
    s_cmp_eq_u32 s32, 0
    s_cselect_b32 s48, 0x3c93bb63, s48
    v_add_u32 v136, s36, v1
    v_mul_u32_u24 v137, 3277, v136
    v_lshrrev_b32 v137, 16, v137
    v_mul_u32_u24 v138, 20, v137
    v_sub_u32 v138, v136, v138
    v_and_b32 v139, 3, v137
    v_lshlrev_b32 v140, 10, v139
    v_lshlrev_b32 v139, 6, v139
    v_add_u32 v139, 3840, v139
    v_cmp_gt_u32 vcc, 16, v138
    v_lshrrev_b32 v136, 3, v137
    v_mul_u32_u24 v136, 204800, v136
    v_cndmask_b32 v139, v139, v140, vcc
    v_bfe_u32 v137, v137, 2, 1
    v_mul_u32_u24 v137, 5120, v137
    v_lshl_add_u32 v139, v138, 4, v139
    v_add3_u32 v139, v139, v136, v137
    v_lshl_add_u32 v14, v2, 8, v139
    v_mov_b32 v5, 2147483632
    s_mul_i32 s32, s3, 10240
    v_add_u32 v6, s32, v4
    s_mov_b32 s35, 0
    s_mov_b32 s37, 0
    s_cmp_ge_u32 s26, 128
    s_cselect_b32 s39, 1, 4
    s_waitcnt vmcnt(0)
    s_barrier
    s_setprio 0
    ds_read_b64_tr_b16 v[16:17], v3 offset:0
    ds_read_b64_tr_b16 v[18:19], v3 offset:512
    ds_read_b64_tr_b16 v[20:21], v3 offset:4096
    ds_read_b64_tr_b16 v[22:23], v3 offset:4608
    ds_read_b64_tr_b16 v[24:25], v3 offset:8192
    ds_read_b64_tr_b16 v[26:27], v3 offset:8704
    ds_read_b64_tr_b16 v[28:29], v3 offset:12288
    ds_read_b64_tr_b16 v[30:31], v3 offset:12800
    ds_read_b64_tr_b16 v[32:33], v3 offset:16384
    ds_read_b64_tr_b16 v[34:35], v3 offset:16896
    ds_read_b64_tr_b16 v[36:37], v3 offset:20480
    ds_read_b64_tr_b16 v[38:39], v3 offset:20992
    ds_read_b64_tr_b16 v[40:41], v3 offset:24576
    ds_read_b64_tr_b16 v[42:43], v3 offset:25088
    ds_read_b64_tr_b16 v[44:45], v3 offset:28672
    ds_read_b64_tr_b16 v[46:47], v3 offset:29184
    ds_read_b64_tr_b16 v[48:49], v3 offset:32768
    ds_read_b64_tr_b16 v[50:51], v3 offset:33280
    ds_read_b64_tr_b16 v[52:53], v3 offset:36864
    ds_read_b64_tr_b16 v[54:55], v3 offset:37376
    ds_read_b64_tr_b16 v[56:57], v11 offset:0
    ds_read_b64_tr_b16 v[58:59], v11 offset:512
    ds_read_b64_tr_b16 v[60:61], v11 offset:4096
    ds_read_b64_tr_b16 v[62:63], v11 offset:4608
    ds_read_b64_tr_b16 v[64:65], v11 offset:8192
    ds_read_b64_tr_b16 v[66:67], v11 offset:8704
    ds_read_b64_tr_b16 v[68:69], v11 offset:12288
    ds_read_b64_tr_b16 v[70:71], v11 offset:12800
    ds_read_b64_tr_b16 v[72:73], v11 offset:16384
    ds_read_b64_tr_b16 v[74:75], v11 offset:16896
    ds_read_b64_tr_b16 v[76:77], v11 offset:20480
    ds_read_b64_tr_b16 v[78:79], v11 offset:20992
    ds_read_b64_tr_b16 v[80:81], v11 offset:24576
    ds_read_b64_tr_b16 v[82:83], v11 offset:25088
    ds_read_b64_tr_b16 v[84:85], v11 offset:28672
    ds_read_b64_tr_b16 v[86:87], v11 offset:29184
    ds_read_b64_tr_b16 v[88:89], v11 offset:32768
    ds_read_b64_tr_b16 v[90:91], v11 offset:33280
    ds_read_b64_tr_b16 v[92:93], v11 offset:36864
    ds_read_b64_tr_b16 v[94:95], v11 offset:37376
    s_waitcnt lgkmcnt(0)
    s_barrier
    ds_write_b128 v6, v[168:171] offset:0
    ds_write_b128 v6, v[188:191] offset:1024
    ds_write_b128 v6, v[172:175] offset:2048
    ds_write_b128 v6, v[192:195] offset:3072
    ds_write_b128 v6, v[176:179] offset:4096
    ds_write_b128 v6, v[196:199] offset:5120
    ds_write_b128 v6, v[180:183] offset:6144
    ds_write_b128 v6, v[200:203] offset:7168
    ds_write_b128 v6, v[184:187] offset:8192
    ds_write_b128 v6, v[204:207] offset:9216
    s_waitcnt lgkmcnt(0)
    s_barrier
    s_cmp_eq_u32 s33, 1
    s_cbranch_scc1 L_k2_kernel_9
    s_cmp_eq_u32 s33, 2
    s_cbranch_scc1 L_k2_kernel_10
    s_cmp_eq_u32 s33, 3
    s_cbranch_scc1 L_k2_kernel_11
L_k2_kernel_8:
L_k2_kernel_12:
    s_waitcnt lgkmcnt(8)
    v_mfma_f32_16x16x32_bf16 v[136:139], v[96:99], v[16:19], 0
    v_add_u32 v13, s37, v4
    v_mfma_f32_16x16x32_bf16 v[140:143], v[96:99], v[56:59], 0
    v_add_f32 v156, v144, v148
    v_add_f32 v157, v145, v149
    v_mfma_f32_16x16x32_bf16 v[136:139], v[96:99], v[36:39], v[136:139]
    v_add_f32 v158, v146, v150
    v_add_f32 v159, v147, v151
    v_mfma_f32_16x16x32_bf16 v[140:143], v[96:99], v[76:79], v[140:143]
    v_mfma_f32_16x16x32_bf16 v[144:147], v[100:103], v[16:19], 0
    v_mul_f32 v152, s48, v152
    v_mul_f32 v153, s48, v153
    v_mfma_f32_16x16x32_bf16 v[148:151], v[100:103], v[56:59], 0
    v_mul_f32 v154, s48, v154
    v_mul_f32 v155, s48, v155
    v_mfma_f32_16x16x32_bf16 v[144:147], v[100:103], v[36:39], v[144:147]
    v_mul_f32 v156, s48, v156
    v_mul_f32 v157, s48, v157
    v_mfma_f32_16x16x32_bf16 v[148:151], v[100:103], v[76:79], v[148:151]
    v_mul_f32 v158, s48, v158
    v_mul_f32 v159, s48, v159
    ds_read_b128 v[96:99], v13 offset:0
    ds_read_b128 v[100:103], v13 offset:1024
    s_waitcnt lgkmcnt(8)
    v_mfma_f32_16x16x32_bf16 v[136:139], v[104:107], v[20:23], v[136:139]
    v_cvt_pk_bf16_f32 v160, v152, v156
    v_cvt_pk_bf16_f32 v161, v153, v157
    v_mfma_f32_16x16x32_bf16 v[144:147], v[108:111], v[20:23], v[144:147]
    v_cvt_pk_bf16_f32 v162, v154, v158
    v_cvt_pk_bf16_f32 v163, v155, v159
    v_mfma_f32_16x16x32_bf16 v[140:143], v[104:107], v[60:63], v[140:143]
    buffer_store_dwordx4 v[160:163], v5, s[4:7], s44 offen sc1
    v_mfma_f32_16x16x32_bf16 v[148:151], v[108:111], v[60:63], v[148:151]
    v_mov_b32 v5, v14
    s_add_u32 s44, s44, 10240
    v_mfma_f32_16x16x32_bf16 v[136:139], v[104:107], v[40:43], v[136:139]
    v_mfma_f32_16x16x32_bf16 v[144:147], v[108:111], v[40:43], v[144:147]
    v_mfma_f32_16x16x32_bf16 v[140:143], v[104:107], v[80:83], v[140:143]
    v_mfma_f32_16x16x32_bf16 v[148:151], v[108:111], v[80:83], v[148:151]
    ds_read_b128 v[104:107], v13 offset:2048
    ds_read_b128 v[108:111], v13 offset:3072
    s_waitcnt lgkmcnt(8)
    v_mfma_f32_16x16x32_bf16 v[136:139], v[112:115], v[24:27], v[136:139]
    v_mfma_f32_16x16x32_bf16 v[144:147], v[116:119], v[24:27], v[144:147]
    v_mfma_f32_16x16x32_bf16 v[140:143], v[112:115], v[64:67], v[140:143]
    v_mfma_f32_16x16x32_bf16 v[148:151], v[116:119], v[64:67], v[148:151]
    v_mfma_f32_16x16x32_bf16 v[136:139], v[112:115], v[44:47], v[136:139]
    v_mfma_f32_16x16x32_bf16 v[144:147], v[116:119], v[44:47], v[144:147]
    v_mfma_f32_16x16x32_bf16 v[140:143], v[112:115], v[84:87], v[140:143]
    v_mfma_f32_16x16x32_bf16 v[148:151], v[116:119], v[84:87], v[148:151]
    ds_read_b128 v[112:115], v13 offset:4096
    ds_read_b128 v[116:119], v13 offset:5120
    s_waitcnt lgkmcnt(8)
    v_mfma_f32_16x16x32_bf16 v[136:139], v[120:123], v[28:31], v[136:139]
    v_mfma_f32_16x16x32_bf16 v[144:147], v[124:127], v[28:31], v[144:147]
    v_mfma_f32_16x16x32_bf16 v[140:143], v[120:123], v[68:71], v[140:143]
    v_mfma_f32_16x16x32_bf16 v[148:151], v[124:127], v[68:71], v[148:151]
    v_mfma_f32_16x16x32_bf16 v[136:139], v[120:123], v[48:51], v[136:139]
    v_mfma_f32_16x16x32_bf16 v[144:147], v[124:127], v[48:51], v[144:147]
    v_mfma_f32_16x16x32_bf16 v[140:143], v[120:123], v[88:91], v[140:143]
    v_mfma_f32_16x16x32_bf16 v[148:151], v[124:127], v[88:91], v[148:151]
    ds_read_b128 v[120:123], v13 offset:6144
    ds_read_b128 v[124:127], v13 offset:7168
    s_waitcnt lgkmcnt(8)
    v_mfma_f32_16x16x32_bf16 v[136:139], v[128:131], v[32:35], v[136:139]
    v_mfma_f32_16x16x32_bf16 v[140:143], v[128:131], v[72:75], v[140:143]
    v_mfma_f32_16x16x32_bf16 v[136:139], v[128:131], v[52:55], v[136:139]
    v_mfma_f32_16x16x32_bf16 v[140:143], v[128:131], v[92:95], v[140:143]
    v_mfma_f32_16x16x32_bf16 v[144:147], v[132:135], v[32:35], v[144:147]
    s_add_u32 s37, s37, 10240
    s_cmp_eq_u32 s37, 51200
    v_mfma_f32_16x16x32_bf16 v[148:151], v[132:135], v[72:75], v[148:151]
    s_cselect_b32 s37, 0, s37
    s_add_u32 s35, s35, 1
    v_mfma_f32_16x16x32_bf16 v[144:147], v[132:135], v[52:55], v[144:147]
    s_cmp_lt_u32 s35, s39
    v_add_f32 v152, v136, v140
    v_add_f32 v153, v137, v141
    v_mfma_f32_16x16x32_bf16 v[148:151], v[132:135], v[92:95], v[148:151]
    v_add_f32 v154, v138, v142
    v_add_f32 v155, v139, v143
    ds_read_b128 v[128:131], v13 offset:8192
    ds_read_b128 v[132:135], v13 offset:9216
    s_cbranch_scc1 L_k2_kernel_12
    s_nop 2
    v_add_f32 v156, v144, v148
    v_add_f32 v157, v145, v149
    v_add_f32 v158, v146, v150
    v_add_f32 v159, v147, v151
    v_mul_f32 v152, s48, v152
    v_mul_f32 v153, s48, v153
    v_mul_f32 v154, s48, v154
    v_mul_f32 v155, s48, v155
    v_mul_f32 v156, s48, v156
    v_mul_f32 v157, s48, v157
    v_mul_f32 v158, s48, v158
    v_mul_f32 v159, s48, v159
    v_cvt_pk_bf16_f32 v160, v152, v156
    v_cvt_pk_bf16_f32 v161, v153, v157
    v_cvt_pk_bf16_f32 v162, v154, v158
    v_cvt_pk_bf16_f32 v163, v155, v159
    buffer_store_dwordx4 v[160:163], v5, s[4:7], s44 offen sc1
    s_add_u32 s44, s44, 40960
    s_mov_b32 s35, 0
    s_cmp_ge_u32 s26, 128
    v_mov_b32 v5, 2147483632
    s_cbranch_scc1 L_k2_kernel_9
    s_endpgm
L_k2_kernel_9:
L_k2_kernel_13:
    s_waitcnt lgkmcnt(8)
    v_mfma_f32_16x16x32_bf16 v[136:139], v[96:99], v[16:19], 0
    v_add_u32 v13, s37, v4
    v_mfma_f32_16x16x32_bf16 v[140:143], v[96:99], v[56:59], 0
    v_sub_f32 v156, v144, v148
    v_sub_f32 v157, v145, v149
    v_mfma_f32_16x16x32_bf16 v[136:139], v[100:103], v[36:39], v[136:139]
    v_sub_f32 v158, v146, v150
    v_sub_f32 v159, v147, v151
    v_mfma_f32_16x16x32_bf16 v[140:143], v[100:103], v[76:79], v[140:143]
    v_mfma_f32_16x16x32_bf16 v[144:147], v[100:103], v[16:19], 0
    v_mul_f32 v152, s48, v152
    v_mul_f32 v153, s48, v153
    v_mfma_f32_16x16x32_bf16 v[148:151], v[96:99], v[36:39], 0
    v_mul_f32 v154, s48, v154
    v_mul_f32 v155, s48, v155
    v_mfma_f32_16x16x32_bf16 v[144:147], v[96:99], v[76:79], v[144:147]
    v_mul_f32 v156, s48, v156
    v_mul_f32 v157, s48, v157
    v_mfma_f32_16x16x32_bf16 v[148:151], v[100:103], v[56:59], v[148:151]
    v_mul_f32 v158, s48, v158
    v_mul_f32 v159, s48, v159
    ds_read_b128 v[96:99], v13 offset:0
    ds_read_b128 v[100:103], v13 offset:1024
    s_waitcnt lgkmcnt(8)
    v_mfma_f32_16x16x32_bf16 v[136:139], v[104:107], v[20:23], v[136:139]
    v_cvt_pk_bf16_f32 v160, v152, v156
    v_cvt_pk_bf16_f32 v161, v153, v157
    v_mfma_f32_16x16x32_bf16 v[144:147], v[108:111], v[20:23], v[144:147]
    v_cvt_pk_bf16_f32 v162, v154, v158
    v_cvt_pk_bf16_f32 v163, v155, v159
    v_mfma_f32_16x16x32_bf16 v[140:143], v[104:107], v[60:63], v[140:143]
    buffer_store_dwordx4 v[160:163], v5, s[4:7], s44 offen sc1
    v_mfma_f32_16x16x32_bf16 v[148:151], v[104:107], v[40:43], v[148:151]
    v_mov_b32 v5, v14
    s_add_u32 s44, s44, 10240
    v_mfma_f32_16x16x32_bf16 v[136:139], v[108:111], v[40:43], v[136:139]
    v_mfma_f32_16x16x32_bf16 v[144:147], v[104:107], v[80:83], v[144:147]
    v_mfma_f32_16x16x32_bf16 v[140:143], v[108:111], v[80:83], v[140:143]
    v_mfma_f32_16x16x32_bf16 v[148:151], v[108:111], v[60:63], v[148:151]
    ds_read_b128 v[104:107], v13 offset:2048
    ds_read_b128 v[108:111], v13 offset:3072
    s_waitcnt lgkmcnt(8)
    v_mfma_f32_16x16x32_bf16 v[136:139], v[112:115], v[24:27], v[136:139]
    v_mfma_f32_16x16x32_bf16 v[144:147], v[116:119], v[24:27], v[144:147]
    v_mfma_f32_16x16x32_bf16 v[140:143], v[112:115], v[64:67], v[140:143]
    v_mfma_f32_16x16x32_bf16 v[148:151], v[112:115], v[44:47], v[148:151]
    v_mfma_f32_16x16x32_bf16 v[136:139], v[116:119], v[44:47], v[136:139]
    v_mfma_f32_16x16x32_bf16 v[144:147], v[112:115], v[84:87], v[144:147]
    v_mfma_f32_16x16x32_bf16 v[140:143], v[116:119], v[84:87], v[140:143]
    v_mfma_f32_16x16x32_bf16 v[148:151], v[116:119], v[64:67], v[148:151]
    ds_read_b128 v[112:115], v13 offset:4096
    ds_read_b128 v[116:119], v13 offset:5120
    s_waitcnt lgkmcnt(8)
    v_mfma_f32_16x16x32_bf16 v[136:139], v[120:123], v[28:31], v[136:139]
    v_mfma_f32_16x16x32_bf16 v[144:147], v[124:127], v[28:31], v[144:147]
    v_mfma_f32_16x16x32_bf16 v[140:143], v[120:123], v[68:71], v[140:143]
    v_mfma_f32_16x16x32_bf16 v[148:151], v[120:123], v[48:51], v[148:151]
    v_mfma_f32_16x16x32_bf16 v[136:139], v[124:127], v[48:51], v[136:139]
    v_mfma_f32_16x16x32_bf16 v[144:147], v[120:123], v[88:91], v[144:147]
    v_mfma_f32_16x16x32_bf16 v[140:143], v[124:127], v[88:91], v[140:143]
    v_mfma_f32_16x16x32_bf16 v[148:151], v[124:127], v[68:71], v[148:151]
    ds_read_b128 v[120:123], v13 offset:6144
    ds_read_b128 v[124:127], v13 offset:7168
    s_waitcnt lgkmcnt(8)
    v_mfma_f32_16x16x32_bf16 v[136:139], v[128:131], v[32:35], v[136:139]
    v_mfma_f32_16x16x32_bf16 v[140:143], v[128:131], v[72:75], v[140:143]
    v_mfma_f32_16x16x32_bf16 v[136:139], v[132:135], v[52:55], v[136:139]
    v_mfma_f32_16x16x32_bf16 v[140:143], v[132:135], v[92:95], v[140:143]
    v_mfma_f32_16x16x32_bf16 v[144:147], v[132:135], v[32:35], v[144:147]
    s_add_u32 s37, s37, 10240
    s_cmp_eq_u32 s37, 51200
    v_mfma_f32_16x16x32_bf16 v[148:151], v[128:131], v[52:55], v[148:151]
    s_cselect_b32 s37, 0, s37
    s_add_u32 s35, s35, 1
    v_mfma_f32_16x16x32_bf16 v[144:147], v[128:131], v[92:95], v[144:147]
    s_cmp_lt_u32 s35, s39
    v_sub_f32 v152, v136, v140
    v_sub_f32 v153, v137, v141
    v_mfma_f32_16x16x32_bf16 v[148:151], v[132:135], v[72:75], v[148:151]
    v_sub_f32 v154, v138, v142
    v_sub_f32 v155, v139, v143
    ds_read_b128 v[128:131], v13 offset:8192
    ds_read_b128 v[132:135], v13 offset:9216
    s_cbranch_scc1 L_k2_kernel_13
    s_nop 2
    v_sub_f32 v156, v144, v148
    v_sub_f32 v157, v145, v149
    v_sub_f32 v158, v146, v150
    v_sub_f32 v159, v147, v151
    v_mul_f32 v152, s48, v152
    v_mul_f32 v153, s48, v153
    v_mul_f32 v154, s48, v154
    v_mul_f32 v155, s48, v155
    v_mul_f32 v156, s48, v156
    v_mul_f32 v157, s48, v157
    v_mul_f32 v158, s48, v158
    v_mul_f32 v159, s48, v159
    v_cvt_pk_bf16_f32 v160, v152, v156
    v_cvt_pk_bf16_f32 v161, v153, v157
    v_cvt_pk_bf16_f32 v162, v154, v158
    v_cvt_pk_bf16_f32 v163, v155, v159
    buffer_store_dwordx4 v[160:163], v5, s[4:7], s44 offen sc1
    s_endpgm
L_k2_kernel_10:
L_k2_kernel_14:
    s_waitcnt lgkmcnt(8)
    v_mfma_f32_16x16x32_bf16 v[136:139], v[96:99], v[16:19], 0
    v_add_u32 v13, s37, v4
    v_mfma_f32_16x16x32_bf16 v[140:143], v[96:99], v[36:39], 0
    v_sub_f32 v156, v144, v148
    v_sub_f32 v157, v145, v149
    v_mfma_f32_16x16x32_bf16 v[136:139], v[96:99], v[56:59], v[136:139]
    v_sub_f32 v158, v146, v150
    v_sub_f32 v159, v147, v151
    v_mfma_f32_16x16x32_bf16 v[140:143], v[96:99], v[76:79], v[140:143]
    v_mfma_f32_16x16x32_bf16 v[144:147], v[100:103], v[16:19], 0
    v_mul_f32 v152, s48, v152
    v_mul_f32 v153, s48, v153
    v_mfma_f32_16x16x32_bf16 v[148:151], v[100:103], v[36:39], 0
    v_mul_f32 v154, s48, v154
    v_mul_f32 v155, s48, v155
    v_mfma_f32_16x16x32_bf16 v[144:147], v[100:103], v[56:59], v[144:147]
    v_mul_f32 v156, s48, v156
    v_mul_f32 v157, s48, v157
    v_mfma_f32_16x16x32_bf16 v[148:151], v[100:103], v[76:79], v[148:151]
    v_mul_f32 v158, s48, v158
    v_mul_f32 v159, s48, v159
    ds_read_b128 v[96:99], v13 offset:0
    ds_read_b128 v[100:103], v13 offset:1024
    s_waitcnt lgkmcnt(8)
    v_mfma_f32_16x16x32_bf16 v[136:139], v[104:107], v[20:23], v[136:139]
    v_cvt_pk_bf16_f32 v160, v152, v156
    v_cvt_pk_bf16_f32 v161, v153, v157
    v_mfma_f32_16x16x32_bf16 v[144:147], v[108:111], v[20:23], v[144:147]
    v_cvt_pk_bf16_f32 v162, v154, v158
    v_cvt_pk_bf16_f32 v163, v155, v159
    v_mfma_f32_16x16x32_bf16 v[140:143], v[104:107], v[40:43], v[140:143]
    buffer_store_dwordx4 v[160:163], v5, s[4:7], s44 offen sc1
    v_mfma_f32_16x16x32_bf16 v[148:151], v[108:111], v[40:43], v[148:151]
    v_mov_b32 v5, v14
    s_add_u32 s44, s44, 10240
    v_mfma_f32_16x16x32_bf16 v[136:139], v[104:107], v[60:63], v[136:139]
    v_mfma_f32_16x16x32_bf16 v[144:147], v[108:111], v[60:63], v[144:147]
    v_mfma_f32_16x16x32_bf16 v[140:143], v[104:107], v[80:83], v[140:143]
    v_mfma_f32_16x16x32_bf16 v[148:151], v[108:111], v[80:83], v[148:151]
    ds_read_b128 v[104:107], v13 offset:2048
    ds_read_b128 v[108:111], v13 offset:3072
    s_waitcnt lgkmcnt(8)
    v_mfma_f32_16x16x32_bf16 v[136:139], v[112:115], v[24:27], v[136:139]
    v_mfma_f32_16x16x32_bf16 v[144:147], v[116:119], v[24:27], v[144:147]
    v_mfma_f32_16x16x32_bf16 v[140:143], v[112:115], v[44:47], v[140:143]
    v_mfma_f32_16x16x32_bf16 v[148:151], v[116:119], v[44:47], v[148:151]
    v_mfma_f32_16x16x32_bf16 v[136:139], v[112:115], v[64:67], v[136:139]
    v_mfma_f32_16x16x32_bf16 v[144:147], v[116:119], v[64:67], v[144:147]
    v_mfma_f32_16x16x32_bf16 v[140:143], v[112:115], v[84:87], v[140:143]
    v_mfma_f32_16x16x32_bf16 v[148:151], v[116:119], v[84:87], v[148:151]
    ds_read_b128 v[112:115], v13 offset:4096
    ds_read_b128 v[116:119], v13 offset:5120
    s_waitcnt lgkmcnt(8)
    v_mfma_f32_16x16x32_bf16 v[136:139], v[120:123], v[28:31], v[136:139]
    v_mfma_f32_16x16x32_bf16 v[144:147], v[124:127], v[28:31], v[144:147]
    v_mfma_f32_16x16x32_bf16 v[140:143], v[120:123], v[48:51], v[140:143]
    v_mfma_f32_16x16x32_bf16 v[148:151], v[124:127], v[48:51], v[148:151]
    v_mfma_f32_16x16x32_bf16 v[136:139], v[120:123], v[68:71], v[136:139]
    v_mfma_f32_16x16x32_bf16 v[144:147], v[124:127], v[68:71], v[144:147]
    v_mfma_f32_16x16x32_bf16 v[140:143], v[120:123], v[88:91], v[140:143]
    v_mfma_f32_16x16x32_bf16 v[148:151], v[124:127], v[88:91], v[148:151]
    ds_read_b128 v[120:123], v13 offset:6144
    ds_read_b128 v[124:127], v13 offset:7168
    s_waitcnt lgkmcnt(8)
    v_mfma_f32_16x16x32_bf16 v[136:139], v[128:131], v[32:35], v[136:139]
    v_mfma_f32_16x16x32_bf16 v[140:143], v[128:131], v[52:55], v[140:143]
    v_mfma_f32_16x16x32_bf16 v[136:139], v[128:131], v[72:75], v[136:139]
    v_mfma_f32_16x16x32_bf16 v[140:143], v[128:131], v[92:95], v[140:143]
    v_mfma_f32_16x16x32_bf16 v[144:147], v[132:135], v[32:35], v[144:147]
    s_add_u32 s37, s37, 10240
    s_cmp_eq_u32 s37, 51200
    v_mfma_f32_16x16x32_bf16 v[148:151], v[132:135], v[52:55], v[148:151]
    s_cselect_b32 s37, 0, s37
    s_add_u32 s35, s35, 1
    v_mfma_f32_16x16x32_bf16 v[144:147], v[132:135], v[72:75], v[144:147]
    s_cmp_lt_u32 s35, s39
    v_sub_f32 v152, v136, v140
    v_sub_f32 v153, v137, v141
    v_mfma_f32_16x16x32_bf16 v[148:151], v[132:135], v[92:95], v[148:151]
    v_sub_f32 v154, v138, v142
    v_sub_f32 v155, v139, v143
    ds_read_b128 v[128:131], v13 offset:8192
    ds_read_b128 v[132:135], v13 offset:9216
    s_cbranch_scc1 L_k2_kernel_14
    s_nop 2
    v_sub_f32 v156, v144, v148
    v_sub_f32 v157, v145, v149
    v_sub_f32 v158, v146, v150
    v_sub_f32 v159, v147, v151
    v_mul_f32 v152, s48, v152
    v_mul_f32 v153, s48, v153
    v_mul_f32 v154, s48, v154
    v_mul_f32 v155, s48, v155
    v_mul_f32 v156, s48, v156
    v_mul_f32 v157, s48, v157
    v_mul_f32 v158, s48, v158
    v_mul_f32 v159, s48, v159
    v_cvt_pk_bf16_f32 v160, v152, v156
    v_cvt_pk_bf16_f32 v161, v153, v157
    v_cvt_pk_bf16_f32 v162, v154, v158
    v_cvt_pk_bf16_f32 v163, v155, v159
    buffer_store_dwordx4 v[160:163], v5, s[4:7], s44 offen sc1
    s_add_u32 s44, s44, 40960
    s_mov_b32 s35, 0
    s_cmp_ge_u32 s26, 128
    v_mov_b32 v5, 2147483632
    s_cbranch_scc1 L_k2_kernel_11
    s_endpgm
L_k2_kernel_11:
L_k2_kernel_15:
    s_waitcnt lgkmcnt(8)
    v_mfma_f32_16x16x32_bf16 v[136:139], v[96:99], v[16:19], 0
    v_add_u32 v13, s37, v4
    v_mfma_f32_16x16x32_bf16 v[140:143], v[100:103], v[36:39], 0
    v_sub_f32 v156, v144, v148
    v_sub_f32 v157, v145, v149
    v_mfma_f32_16x16x32_bf16 v[136:139], v[100:103], v[76:79], v[136:139]
    v_sub_f32 v158, v146, v150
    v_sub_f32 v159, v147, v151
    v_mfma_f32_16x16x32_bf16 v[140:143], v[96:99], v[56:59], v[140:143]
    v_mfma_f32_16x16x32_bf16 v[144:147], v[100:103], v[16:19], 0
    v_mul_f32 v152, s48, v152
    v_mul_f32 v153, s48, v153
    v_mfma_f32_16x16x32_bf16 v[148:151], v[100:103], v[56:59], 0
    v_mul_f32 v154, s48, v154
    v_mul_f32 v155, s48, v155
    v_mfma_f32_16x16x32_bf16 v[144:147], v[96:99], v[36:39], v[144:147]
    v_mul_f32 v156, s48, v156
    v_mul_f32 v157, s48, v157
    v_mfma_f32_16x16x32_bf16 v[148:151], v[96:99], v[76:79], v[148:151]
    v_mul_f32 v158, s48, v158
    v_mul_f32 v159, s48, v159
    ds_read_b128 v[96:99], v13 offset:0
    ds_read_b128 v[100:103], v13 offset:1024
    s_waitcnt lgkmcnt(8)
    v_mfma_f32_16x16x32_bf16 v[136:139], v[104:107], v[20:23], v[136:139]
    v_cvt_pk_bf16_f32 v160, v152, v156
    v_cvt_pk_bf16_f32 v161, v153, v157
    v_mfma_f32_16x16x32_bf16 v[144:147], v[108:111], v[20:23], v[144:147]
    v_cvt_pk_bf16_f32 v162, v154, v158
    v_cvt_pk_bf16_f32 v163, v155, v159
    v_mfma_f32_16x16x32_bf16 v[140:143], v[108:111], v[40:43], v[140:143]
    buffer_store_dwordx4 v[160:163], v5, s[4:7], s44 offen sc1
    v_mfma_f32_16x16x32_bf16 v[148:151], v[108:111], v[60:63], v[148:151]
    v_mov_b32 v5, v14
    s_add_u32 s44, s44, 10240
    v_mfma_f32_16x16x32_bf16 v[136:139], v[108:111], v[80:83], v[136:139]
    v_mfma_f32_16x16x32_bf16 v[144:147], v[104:107], v[40:43], v[144:147]
    v_mfma_f32_16x16x32_bf16 v[140:143], v[104:107], v[60:63], v[140:143]
    v_mfma_f32_16x16x32_bf16 v[148:151], v[104:107], v[80:83], v[148:151]
    ds_read_b128 v[104:107], v13 offset:2048
    ds_read_b128 v[108:111], v13 offset:3072
    s_waitcnt lgkmcnt(8)
    v_mfma_f32_16x16x32_bf16 v[136:139], v[112:115], v[24:27], v[136:139]
    v_mfma_f32_16x16x32_bf16 v[144:147], v[116:119], v[24:27], v[144:147]
    v_mfma_f32_16x16x32_bf16 v[140:143], v[116:119], v[44:47], v[140:143]
    v_mfma_f32_16x16x32_bf16 v[148:151], v[116:119], v[64:67], v[148:151]
    v_mfma_f32_16x16x32_bf16 v[136:139], v[116:119], v[84:87], v[136:139]
    v_mfma_f32_16x16x32_bf16 v[144:147], v[112:115], v[44:47], v[144:147]
    v_mfma_f32_16x16x32_bf16 v[140:143], v[112:115], v[64:67], v[140:143]
    v_mfma_f32_16x16x32_bf16 v[148:151], v[112:115], v[84:87], v[148:151]
    ds_read_b128 v[112:115], v13 offset:4096
    ds_read_b128 v[116:119], v13 offset:5120
    s_waitcnt lgkmcnt(8)
    v_mfma_f32_16x16x32_bf16 v[136:139], v[120:123], v[28:31], v[136:139]
    v_mfma_f32_16x16x32_bf16 v[144:147], v[124:127], v[28:31], v[144:147]
    v_mfma_f32_16x16x32_bf16 v[140:143], v[124:127], v[48:51], v[140:143]
    v_mfma_f32_16x16x32_bf16 v[148:151], v[124:127], v[68:71], v[148:151]
    v_mfma_f32_16x16x32_bf16 v[136:139], v[124:127], v[88:91], v[136:139]
    v_mfma_f32_16x16x32_bf16 v[144:147], v[120:123], v[48:51], v[144:147]
    v_mfma_f32_16x16x32_bf16 v[140:143], v[120:123], v[68:71], v[140:143]
    v_mfma_f32_16x16x32_bf16 v[148:151], v[120:123], v[88:91], v[148:151]
    ds_read_b128 v[120:123], v13 offset:6144
    ds_read_b128 v[124:127], v13 offset:7168
    s_waitcnt lgkmcnt(8)
    v_mfma_f32_16x16x32_bf16 v[136:139], v[128:131], v[32:35], v[136:139]
    v_mfma_f32_16x16x32_bf16 v[140:143], v[132:135], v[52:55], v[140:143]
    v_mfma_f32_16x16x32_bf16 v[136:139], v[132:135], v[92:95], v[136:139]
    v_mfma_f32_16x16x32_bf16 v[140:143], v[128:131], v[72:75], v[140:143]
    v_mfma_f32_16x16x32_bf16 v[144:147], v[132:135], v[32:35], v[144:147]
    s_add_u32 s37, s37, 10240
    s_cmp_eq_u32 s37, 51200
    v_mfma_f32_16x16x32_bf16 v[148:151], v[132:135], v[72:75], v[148:151]
    s_cselect_b32 s37, 0, s37
    s_add_u32 s35, s35, 1
    v_mfma_f32_16x16x32_bf16 v[144:147], v[128:131], v[52:55], v[144:147]
    s_cmp_lt_u32 s35, s39
    v_sub_f32 v152, v136, v140
    v_sub_f32 v153, v137, v141
    v_mfma_f32_16x16x32_bf16 v[148:151], v[128:131], v[92:95], v[148:151]
    v_sub_f32 v154, v138, v142
    v_sub_f32 v155, v139, v143
    ds_read_b128 v[128:131], v13 offset:8192
    ds_read_b128 v[132:135], v13 offset:9216
    s_cbranch_scc1 L_k2_kernel_15
    s_nop 2
    v_sub_f32 v156, v144, v148
    v_sub_f32 v157, v145, v149
    v_sub_f32 v158, v146, v150
    v_sub_f32 v159, v147, v151
    v_mul_f32 v152, s48, v152
    v_mul_f32 v153, s48, v153
    v_mul_f32 v154, s48, v154
    v_mul_f32 v155, s48, v155
    v_mul_f32 v156, s48, v156
    v_mul_f32 v157, s48, v157
    v_mul_f32 v158, s48, v158
    v_mul_f32 v159, s48, v159
    v_cvt_pk_bf16_f32 v160, v152, v156
    v_cvt_pk_bf16_f32 v161, v153, v157
    v_cvt_pk_bf16_f32 v162, v154, v158
    v_cvt_pk_bf16_f32 v163, v155, v159
    buffer_store_dwordx4 v[160:163], v5, s[4:7], s44 offen sc1
    s_endpgm

.globl k3_kernel
.p2align 8
.type k3_kernel,@function
k3_kernel:
    s_cmp_lt_u32 s2, 252
    s_cbranch_scc1 L_k3_kernel_1
    s_endpgm
L_k3_kernel_1:
    s_load_dwordx16 s[8:23], s[0:1], 0
    s_load_dwordx2 s[24:25], s[0:1], 64
    v_lshrrev_b32 v1, 6, v0
    v_and_b32 v0, 63, v0
    s_nop 0
    v_readfirstlane_b32 s3, v1
    s_waitcnt lgkmcnt(0)
    s_mov_b32 s4, s24
    s_and_b32 s5, s25, 0xffff
    s_mov_b32 s6, 30408704
    s_mov_b32 s7, 0x00020000
    s_sub_u32 s26, s2, 192
    s_cmp_ge_u32 s2, 192
    s_cbranch_scc1 L_k3_kernel_2
    s_and_b32 s27, s2, 7
    s_lshr_b32 s28, s2, 3
    s_lshr_b32 s29, s27, 1
    s_lshl_b32 s29, s29, 2
    s_and_b32 s30, s28, 3
    s_or_b32 s29, s29, s30
    s_and_b32 s27, s27, 1
    s_lshr_b32 s28, s28, 2
    s_mul_i32 s30, s27, 6
    s_lshl_b32 s31, s27, 1
    s_add_u32 s31, s31, 6
    s_cmp_lt_u32 s28, 6
    s_cselect_b32 s30, s30, s31
    s_add_u32 s28, s28, s30
    s_mov_b32 s27, s29
    v_lshrrev_b32 v2, 4, v0
    v_lshlrev_b32 v5, 4, v0
    s_cmp_lt_u32 s3, 4
    s_cbranch_scc1 L_k3_kernel_3
    s_sub_u32 s33, s3, 4
    v_and_b32 v3, 1, v2
    v_lshlrev_b32 v3, 7, v3
    v_xor_b32 v3, v3, v5
    v_add_u32 v4, 18560, v3
    s_lshl_b32 s37, s33, 12
    s_mul_i32 s36, s33, 5120
    s_lshl_b32 s31, s27, 3
    s_lshl_b32 s33, s33, 1
    s_add_u32 s31, s31, s33
    s_mul_i32 s31, s31, 20608
    s_add_u32 s31, s31, 0
    s_mul_i32 s32, s28, 204800
    s_add_u32 s32, s32, s36
    s_add_u32 s32, s32, 6291456
    s_add_u32 s36, s36, 16384
    s_add_u32 m0, s37, 0
    s_add_u32 s38, s36, 0
    buffer_load_dwordx4 v3, s[4:7], s31 offen lds
    buffer_load_dwordx4 v3, s[4:7], s31 offen offset:1024 lds
    buffer_load_dwordx4 v4, s[4:7], s31 offen offset:2048 lds
    buffer_load_dwordx4 v4, s[4:7], s31 offen offset:3072 lds
    s_mov_b32 m0, s38
    s_add_u32 s31, s31, 2048
    buffer_load_dwordx4 v5, s[4:7], s32 offen lds
    buffer_load_dwordx4 v5, s[4:7], s32 offen offset:1024 lds
    buffer_load_dwordx4 v5, s[4:7], s32 offen offset:2048 lds
    buffer_load_dwordx4 v5, s[4:7], s32 offen offset:3072 lds
    s_add_u32 m0, s38, 1024
    s_add_u32 s39, s32, 1024
    buffer_load_dwordx4 v5, s[4:7], s39 offen offset:3072 lds
    s_add_u32 s32, s32, 20480
    s_add_u32 m0, s37, 36864
    s_add_u32 s38, s36, 36864
    buffer_load_dwordx4 v3, s[4:7], s31 offen lds
    buffer_load_dwordx4 v3, s[4:7], s31 offen offset:1024 lds
    buffer_load_dwordx4 v4, s[4:7], s31 offen offset:2048 lds
    buffer_load_dwordx4 v4, s[4:7], s31 offen offset:3072 lds
    s_mov_b32 m0, s38
    s_add_u32 s31, s31, 2048
    buffer_load_dwordx4 v5, s[4:7], s32 offen lds
    buffer_load_dwordx4 v5, s[4:7], s32 offen offset:1024 lds
    buffer_load_dwordx4 v5, s[4:7], s32 offen offset:2048 lds
    buffer_load_dwordx4 v5, s[4:7], s32 offen offset:3072 lds
    s_add_u32 m0, s38, 1024
    s_add_u32 s39, s32, 1024
    buffer_load_dwordx4 v5, s[4:7], s39 offen offset:3072 lds
    s_add_u32 s32, s32, 20480
    s_waitcnt vmcnt(9)
    s_barrier
    s_add_u32 m0, s37, 73728
    s_add_u32 s38, s36, 73728
    buffer_load_dwordx4 v3, s[4:7], s31 offen lds
    buffer_load_dwordx4 v3, s[4:7], s31 offen offset:1024 lds
    buffer_load_dwordx4 v4, s[4:7], s31 offen offset:2048 lds
    buffer_load_dwordx4 v4, s[4:7], s31 offen offset:3072 lds
    s_mov_b32 m0, s38
    s_add_u32 s31, s31, 2048
    buffer_load_dwordx4 v5, s[4:7], s32 offen lds
    buffer_load_dwordx4 v5, s[4:7], s32 offen offset:1024 lds
    buffer_load_dwordx4 v5, s[4:7], s32 offen offset:2048 lds
    buffer_load_dwordx4 v5, s[4:7], s32 offen offset:3072 lds
    s_add_u32 m0, s38, 1024
    s_add_u32 s39, s32, 1024
    buffer_load_dwordx4 v5, s[4:7], s39 offen offset:3072 lds
    s_add_u32 s32, s32, 20480
    s_waitcnt vmcnt(9)
    s_barrier
    s_add_u32 m0, s37, 110592
    s_add_u32 s38, s36, 110592
    buffer_load_dwordx4 v3, s[4:7], s31 offen lds
    buffer_load_dwordx4 v3, s[4:7], s31 offen offset:1024 lds
    buffer_load_dwordx4 v4, s[4:7], s31 offen offset:2048 lds
    buffer_load_dwordx4 v4, s[4:7], s31 offen offset:3072 lds
    s_mov_b32 m0, s38
    s_add_u32 s31, s31, 2048
    buffer_load_dwordx4 v5, s[4:7], s32 offen lds
    buffer_load_dwordx4 v5, s[4:7], s32 offen offset:1024 lds
    buffer_load_dwordx4 v5, s[4:7], s32 offen offset:2048 lds
    buffer_load_dwordx4 v5, s[4:7], s32 offen offset:3072 lds
    s_add_u32 m0, s38, 1024
    s_add_u32 s39, s32, 1024
    buffer_load_dwordx4 v5, s[4:7], s39 offen offset:3072 lds
    s_add_u32 s32, s32, 20480
    s_waitcnt vmcnt(9)
    s_barrier
    s_add_u32 m0, s37, 0
    s_add_u32 s38, s36, 0
    buffer_load_dwordx4 v3, s[4:7], s31 offen lds
    buffer_load_dwordx4 v3, s[4:7], s31 offen offset:1024 lds
    buffer_load_dwordx4 v4, s[4:7], s31 offen offset:2048 lds
    buffer_load_dwordx4 v4, s[4:7], s31 offen offset:3072 lds
    s_mov_b32 m0, s38
    s_add_u32 s31, s31, 2048
    buffer_load_dwordx4 v5, s[4:7], s32 offen lds
    buffer_load_dwordx4 v5, s[4:7], s32 offen offset:1024 lds
    buffer_load_dwordx4 v5, s[4:7], s32 offen offset:2048 lds
    buffer_load_dwordx4 v5, s[4:7], s32 offen offset:3072 lds
    s_add_u32 m0, s38, 1024
    s_add_u32 s39, s32, 1024
    buffer_load_dwordx4 v5, s[4:7], s39 offen offset:3072 lds
    s_add_u32 s32, s32, 20480
    s_waitcnt vmcnt(9)
    s_barrier
    s_add_u32 m0, s37, 36864
    s_add_u32 s38, s36, 36864
    buffer_load_dwordx4 v3, s[4:7], s31 offen lds
    buffer_load_dwordx4 v3, s[4:7], s31 offen offset:1024 lds
    buffer_load_dwordx4 v4, s[4:7], s31 offen offset:2048 lds
    buffer_load_dwordx4 v4, s[4:7], s31 offen offset:3072 lds
    s_mov_b32 m0, s38
    s_add_u32 s31, s31, 2048
    buffer_load_dwordx4 v5, s[4:7], s32 offen lds
    buffer_load_dwordx4 v5, s[4:7], s32 offen offset:1024 lds
    buffer_load_dwordx4 v5, s[4:7], s32 offen offset:2048 lds
    buffer_load_dwordx4 v5, s[4:7], s32 offen offset:3072 lds
    s_add_u32 m0, s38, 1024
    s_add_u32 s39, s32, 1024
    buffer_load_dwordx4 v5, s[4:7], s39 offen offset:3072 lds
    s_add_u32 s32, s32, 20480
    s_waitcnt vmcnt(9)
    s_barrier
    s_add_u32 m0, s37, 73728
    s_add_u32 s38, s36, 73728
    buffer_load_dwordx4 v3, s[4:7], s31 offen lds
    buffer_load_dwordx4 v3, s[4:7], s31 offen offset:1024 lds
    buffer_load_dwordx4 v4, s[4:7], s31 offen offset:2048 lds
    buffer_load_dwordx4 v4, s[4:7], s31 offen offset:3072 lds
    s_mov_b32 m0, s38
    s_add_u32 s31, s31, 2048
    buffer_load_dwordx4 v5, s[4:7], s32 offen lds
    buffer_load_dwordx4 v5, s[4:7], s32 offen offset:1024 lds
    buffer_load_dwordx4 v5, s[4:7], s32 offen offset:2048 lds
    buffer_load_dwordx4 v5, s[4:7], s32 offen offset:3072 lds
    s_add_u32 m0, s38, 1024
    s_add_u32 s39, s32, 1024
    buffer_load_dwordx4 v5, s[4:7], s39 offen offset:3072 lds
    s_add_u32 s32, s32, 20480
    s_waitcnt vmcnt(9)
    s_barrier
    s_add_u32 m0, s37, 110592
    s_add_u32 s38, s36, 110592
    buffer_load_dwordx4 v3, s[4:7], s31 offen lds
    buffer_load_dwordx4 v3, s[4:7], s31 offen offset:1024 lds
    buffer_load_dwordx4 v4, s[4:7], s31 offen offset:2048 lds
    buffer_load_dwordx4 v4, s[4:7], s31 offen offset:3072 lds
    s_mov_b32 m0, s38
    s_add_u32 s31, s31, 2048
    buffer_load_dwordx4 v5, s[4:7], s32 offen lds
    buffer_load_dwordx4 v5, s[4:7], s32 offen offset:1024 lds
    buffer_load_dwordx4 v5, s[4:7], s32 offen offset:2048 lds
    buffer_load_dwordx4 v5, s[4:7], s32 offen offset:3072 lds
    s_add_u32 m0, s38, 1024
    s_add_u32 s39, s32, 1024
    buffer_load_dwordx4 v5, s[4:7], s39 offen offset:3072 lds
    s_add_u32 s32, s32, 20480
    s_waitcnt vmcnt(9)
    s_barrier
    s_add_u32 m0, s37, 0
    s_add_u32 s38, s36, 0
    buffer_load_dwordx4 v3, s[4:7], s31 offen lds
    buffer_load_dwordx4 v3, s[4:7], s31 offen offset:1024 lds
    buffer_load_dwordx4 v4, s[4:7], s31 offen offset:2048 lds
    buffer_load_dwordx4 v4, s[4:7], s31 offen offset:3072 lds
    s_mov_b32 m0, s38
    s_add_u32 s31, s31, 2048
    buffer_load_dwordx4 v5, s[4:7], s32 offen lds
    buffer_load_dwordx4 v5, s[4:7], s32 offen offset:1024 lds
    buffer_load_dwordx4 v5, s[4:7], s32 offen offset:2048 lds
    buffer_load_dwordx4 v5, s[4:7], s32 offen offset:3072 lds
    s_add_u32 m0, s38, 1024
    s_add_u32 s39, s32, 1024
    buffer_load_dwordx4 v5, s[4:7], s39 offen offset:3072 lds
    s_add_u32 s32, s32, 20480
    s_waitcnt vmcnt(9)
    s_barrier
    s_add_u32 m0, s37, 36864
    s_add_u32 s38, s36, 36864
    buffer_load_dwordx4 v3, s[4:7], s31 offen lds
    buffer_load_dwordx4 v3, s[4:7], s31 offen offset:1024 lds
    buffer_load_dwordx4 v4, s[4:7], s31 offen offset:2048 lds
    buffer_load_dwordx4 v4, s[4:7], s31 offen offset:3072 lds
    s_mov_b32 m0, s38
    s_add_u32 s31, s31, 2048
    buffer_load_dwordx4 v5, s[4:7], s32 offen lds
    buffer_load_dwordx4 v5, s[4:7], s32 offen offset:1024 lds
    buffer_load_dwordx4 v5, s[4:7], s32 offen offset:2048 lds
    buffer_load_dwordx4 v5, s[4:7], s32 offen offset:3072 lds
    s_add_u32 m0, s38, 1024
    s_add_u32 s39, s32, 1024
    buffer_load_dwordx4 v5, s[4:7], s39 offen offset:3072 lds
    s_add_u32 s32, s32, 20480
    s_waitcnt vmcnt(9)
    s_barrier
    s_waitcnt vmcnt(0)
    s_barrier
    s_cmp_lg_u32 s2, 0
    s_cbranch_scc1 L_k3_kernel_4
    v_mov_b32 v1, 20576
    v_mov_b32 v2, 0
    buffer_store_dword v2, v1, s[4:7], 0 offen sc1
    v_lshlrev_b32 v1, 7, v0
    v_mov_b32 v8, 0
    v_mov_b32 v9, 0
    v_mov_b32 v10, 0
    v_mov_b32 v11, 0
    s_lshl_b32 s38, s3, 13
    s_add_u32 s38, s38, 26198016
    buffer_store_dwordx4 v[8:11], v1, s[4:7], s38 offen sc1
L_k3_kernel_4:
    s_endpgm
L_k3_kernel_3:
    s_lshr_b32 s29, s3, 1
    s_and_b32 s30, s3, 1
    v_and_b32 v1, 15, v0
    v_lshlrev_b32 v12, 8, v2
    v_lshl_add_u32 v12, v1, 3, v12
    v_and_b32 v13, 1, v2
    v_lshl_add_u32 v12, v13, 7, v12
    s_lshl_b32 s38, s3, 12
    v_add_u32 v12, s38, v12
    v_xor_b32 v13, 0x80, v12
    v_xor_b32 v14, 0x1000, v12
    v_xor_b32 v15, 0x1000, v13
    s_mul_i32 s38, s30, 5120
    s_add_u32 s38, s38, 16384
    v_add_u32 v16, s38, v5
    s_mov_b32 s34, 0
    s_mov_b32 s35, 0
    v_mov_b32 v7, v12
    v_mov_b32 v8, v13
    v_mov_b32 v9, v14
    v_mov_b32 v10, v15
    v_mov_b32 v11, v16
    v_mov_b32 v92, 0
    v_mov_b32 v93, 0
    v_mov_b32 v94, 0
    v_mov_b32 v95, 0
    v_mov_b32 v96, 0
    v_mov_b32 v97, 0
    v_mov_b32 v98, 0
    v_mov_b32 v99, 0
    v_mov_b32 v100, 0
    v_mov_b32 v101, 0
    v_mov_b32 v102, 0
    v_mov_b32 v103, 0
    v_mov_b32 v104, 0
    v_mov_b32 v105, 0
    v_mov_b32 v106, 0
    v_mov_b32 v107, 0
    v_mov_b32 v108, 0
    v_mov_b32 v109, 0
    v_mov_b32 v110, 0
    v_mov_b32 v111, 0
    v_mov_b32 v112, 0
    v_mov_b32 v113, 0
    v_mov_b32 v114, 0
    v_mov_b32 v115, 0
    v_mov_b32 v116, 0
    v_mov_b32 v117, 0
    v_mov_b32 v118, 0
    v_mov_b32 v119, 0
    v_mov_b32 v120, 0
    v_mov_b32 v121, 0
    v_mov_b32 v122, 0
    v_mov_b32 v123, 0
    v_mov_b32 v124, 0
    v_mov_b32 v125, 0
    v_mov_b32 v126, 0
    v_mov_b32 v127, 0
    v_mov_b32 v128, 0
    v_mov_b32 v129, 0
    v_mov_b32 v130, 0
    v_mov_b32 v131, 0
    v_mov_b32 v132, 0
    v_mov_b32 v133, 0
    v_mov_b32 v134, 0
    v_mov_b32 v135, 0
    v_mov_b32 v136, 0
    v_mov_b32 v137, 0
    v_mov_b32 v138, 0
    v_mov_b32 v139, 0
    v_mov_b32 v140, 0
    v_mov_b32 v141, 0
    v_mov_b32 v142, 0
    v_mov_b32 v143, 0
    v_mov_b32 v144, 0
    v_mov_b32 v145, 0
    v_mov_b32 v146, 0
    v_mov_b32 v147, 0
    v_mov_b32 v148, 0
    v_mov_b32 v149, 0
    v_mov_b32 v150, 0
    v_mov_b32 v151, 0
    v_mov_b32 v152, 0
    v_mov_b32 v153, 0
    v_mov_b32 v154, 0
    v_mov_b32 v155, 0
    v_mov_b32 v156, 0
    v_mov_b32 v157, 0
    v_mov_b32 v158, 0
    v_mov_b32 v159, 0
    v_mov_b32 v160, 0
    v_mov_b32 v161, 0
    v_mov_b32 v162, 0
    v_mov_b32 v163, 0
    v_mov_b32 v164, 0
    v_mov_b32 v165, 0
    v_mov_b32 v166, 0
    v_mov_b32 v167, 0
    v_mov_b32 v168, 0
    v_mov_b32 v169, 0
    v_mov_b32 v170, 0
    v_mov_b32 v171, 0
    v_mov_b32 v172, 0
    v_mov_b32 v173, 0
    v_mov_b32 v174, 0
    v_mov_b32 v175, 0
    v_mov_b32 v176, 0
    v_mov_b32 v177, 0
    v_mov_b32 v178, 0
    v_mov_b32 v179, 0
    s_barrier
    ds_read_b64_tr_b16 v[20:21], v7 offset:0
    ds_read_b64_tr_b16 v[22:23], v8 offset:0
    ds_read_b128 v[36:39], v11 offset:0
    ds_read_b64_tr_b16 v[24:25], v7 offset:2048
    ds_read_b64_tr_b16 v[26:27], v8 offset:2048
    ds_read_b128 v[40:43], v11 offset:1024
    ds_read_b64_tr_b16 v[28:29], v9 offset:0
    ds_read_b64_tr_b16 v[30:31], v10 offset:0
    ds_read_b128 v[44:47], v11 offset:2048
    ds_read_b64_tr_b16 v[32:33], v9 offset:2048
    ds_read_b64_tr_b16 v[34:35], v10 offset:2048
    ds_read_b128 v[48:51], v11 offset:3072
    ds_read_b128 v[52:55], v11 offset:4096
    s_lshr_b32 s38, s28, 2
    s_cmp_eq_u32 s38, 2
    s_cbranch_scc1 L_k3_kernel_6
L_k3_kernel_5:
L_k3_kernel_7:
    s_waitcnt lgkmcnt(0)
    v_mfma_f32_16x16x32_bf16 v[172:175], v[20:23], v[20:23], v[172:175]
    ds_read_b64_tr_b16 v[56:57], v7 offset:1024
    v_mfma_f32_16x16x32_bf16 v[176:179], v[24:27], v[24:27], v[176:179]
    ds_read_b64_tr_b16 v[58:59], v8 offset:1024
    v_mfma_f32_16x16x32_bf16 v[92:95], v[36:39], v[20:23], v[92:95]
    ds_read_b128 v[72:75], v11 offset:10240
    v_mfma_f32_16x16x32_bf16 v[96:99], v[40:43], v[20:23], v[96:99]
    ds_read_b64_tr_b16 v[60:61], v7 offset:3072
    v_mfma_f32_16x16x32_bf16 v[100:103], v[44:47], v[20:23], v[100:103]
    ds_read_b64_tr_b16 v[62:63], v8 offset:3072
    v_mfma_f32_16x16x32_bf16 v[104:107], v[48:51], v[20:23], v[104:107]
    ds_read_b128 v[76:79], v11 offset:11264
    v_mfma_f32_16x16x32_bf16 v[108:111], v[52:55], v[20:23], v[108:111]
    ds_read_b64_tr_b16 v[64:65], v9 offset:1024
    v_mfma_f32_16x16x32_bf16 v[112:115], v[36:39], v[24:27], v[112:115]
    ds_read_b64_tr_b16 v[66:67], v10 offset:1024
    v_mfma_f32_16x16x32_bf16 v[116:119], v[40:43], v[24:27], v[116:119]
    ds_read_b128 v[80:83], v11 offset:12288
    v_mfma_f32_16x16x32_bf16 v[120:123], v[44:47], v[24:27], v[120:123]
    ds_read_b64_tr_b16 v[68:69], v9 offset:3072
    v_mfma_f32_16x16x32_bf16 v[124:127], v[48:51], v[24:27], v[124:127]
    ds_read_b64_tr_b16 v[70:71], v10 offset:3072
    v_mfma_f32_16x16x32_bf16 v[128:131], v[52:55], v[24:27], v[128:131]
    ds_read_b128 v[84:87], v11 offset:13312
    v_mfma_f32_16x16x32_bf16 v[132:135], v[36:39], v[28:31], v[132:135]
    ds_read_b128 v[88:91], v11 offset:14336
    v_mfma_f32_16x16x32_bf16 v[136:139], v[40:43], v[28:31], v[136:139]
    s_add_u32 s34, s34, 1
    s_add_u32 s35, s35, 36864
    v_mfma_f32_16x16x32_bf16 v[140:143], v[44:47], v[28:31], v[140:143]
    s_cmp_ge_u32 s35, 147456
    s_cselect_b32 s35, 0, s35
    v_mfma_f32_16x16x32_bf16 v[144:147], v[48:51], v[28:31], v[144:147]
    v_add_u32 v7, s35, v12
    v_mfma_f32_16x16x32_bf16 v[148:151], v[52:55], v[28:31], v[148:151]
    v_add_u32 v8, s35, v13
    v_mfma_f32_16x16x32_bf16 v[152:155], v[36:39], v[32:35], v[152:155]
    v_add_u32 v9, s35, v14
    v_mfma_f32_16x16x32_bf16 v[156:159], v[40:43], v[32:35], v[156:159]
    v_add_u32 v10, s35, v15
    v_mfma_f32_16x16x32_bf16 v[160:163], v[44:47], v[32:35], v[160:163]
    v_add_u32 v11, s35, v16
    v_mfma_f32_16x16x32_bf16 v[164:167], v[48:51], v[32:35], v[164:167]
    s_cmp_eq_u32 s34, 10
    v_mfma_f32_16x16x32_bf16 v[168:171], v[52:55], v[32:35], v[168:171]
    s_waitcnt lgkmcnt(0)
    s_cbranch_scc1 L_k3_kernel_8
    s_barrier
    v_mfma_f32_16x16x32_bf16 v[172:175], v[56:59], v[56:59], v[172:175]
    ds_read_b64_tr_b16 v[20:21], v7 offset:0
    v_mfma_f32_16x16x32_bf16 v[176:179], v[60:63], v[60:63], v[176:179]
    ds_read_b64_tr_b16 v[22:23], v8 offset:0
    v_mfma_f32_16x16x32_bf16 v[92:95], v[72:75], v[56:59], v[92:95]
    ds_read_b128 v[36:39], v11 offset:0
    v_mfma_f32_16x16x32_bf16 v[96:99], v[76:79], v[56:59], v[96:99]
    ds_read_b64_tr_b16 v[24:25], v7 offset:2048
    v_mfma_f32_16x16x32_bf16 v[100:103], v[80:83], v[56:59], v[100:103]
    ds_read_b64_tr_b16 v[26:27], v8 offset:2048
    v_mfma_f32_16x16x32_bf16 v[104:107], v[84:87], v[56:59], v[104:107]
    ds_read_b128 v[40:43], v11 offset:1024
    v_mfma_f32_16x16x32_bf16 v[108:111], v[88:91], v[56:59], v[108:111]
    ds_read_b64_tr_b16 v[28:29], v9 offset:0
    v_mfma_f32_16x16x32_bf16 v[112:115], v[72:75], v[60:63], v[112:115]
    ds_read_b64_tr_b16 v[30:31], v10 offset:0
    v_mfma_f32_16x16x32_bf16 v[116:119], v[76:79], v[60:63], v[116:119]
    ds_read_b128 v[44:47], v11 offset:2048
    v_mfma_f32_16x16x32_bf16 v[120:123], v[80:83], v[60:63], v[120:123]
    ds_read_b64_tr_b16 v[32:33], v9 offset:2048
    v_mfma_f32_16x16x32_bf16 v[124:127], v[84:87], v[60:63], v[124:127]
    ds_read_b64_tr_b16 v[34:35], v10 offset:2048
    v_mfma_f32_16x16x32_bf16 v[128:131], v[88:91], v[60:63], v[128:131]
    ds_read_b128 v[48:51], v11 offset:3072
    v_mfma_f32_16x16x32_bf16 v[132:135], v[72:75], v[64:67], v[132:135]
    ds_read_b128 v[52:55], v11 offset:4096
    v_mfma_f32_16x16x32_bf16 v[136:139], v[76:79], v[64:67], v[136:139]
    v_mfma_f32_16x16x32_bf16 v[140:143], v[80:83], v[64:67], v[140:143]
    v_mfma_f32_16x16x32_bf16 v[144:147], v[84:87], v[64:67], v[144:147]
    v_mfma_f32_16x16x32_bf16 v[148:151], v[88:91], v[64:67], v[148:151]
    v_mfma_f32_16x16x32_bf16 v[152:155], v[72:75], v[68:71], v[152:155]
    v_mfma_f32_16x16x32_bf16 v[156:159], v[76:79], v[68:71], v[156:159]
    v_mfma_f32_16x16x32_bf16 v[160:163], v[80:83], v[68:71], v[160:163]
    v_mfma_f32_16x16x32_bf16 v[164:167], v[84:87], v[68:71], v[164:167]
    v_mfma_f32_16x16x32_bf16 v[168:171], v[88:91], v[68:71], v[168:171]
    s_branch L_k3_kernel_7
L_k3_kernel_8:
    v_mfma_f32_16x16x32_bf16 v[172:175], v[56:59], v[56:59], v[172:175]
    s_lshl_b32 s38, s3, 7
    v_lshlrev_b32 v7, 2, v1
    v_mfma_f32_16x16x32_bf16 v[176:179], v[60:63], v[60:63], v[176:179]
    v_add_u32 v7, s38, v7
    v_lshrrev_b32 v10, 2, v1
    v_mfma_f32_16x16x32_bf16 v[92:95], v[72:75], v[56:59], v[92:95]
    v_cmp_eq_u32 s[44:45], v10, v2
    v_and_b32 v10, 3, v1
    v_mfma_f32_16x16x32_bf16 v[96:99], v[76:79], v[56:59], v[96:99]
    v_cmp_eq_u32 s[46:47], 1, v10
    v_cmp_eq_u32 s[48:49], 2, v10
    v_mfma_f32_16x16x32_bf16 v[100:103], v[80:83], v[56:59], v[100:103]
    v_cmp_eq_u32 s[50:51], 3, v10
    v_add_u32 v11, 512, v5
    v_mfma_f32_16x16x32_bf16 v[104:107], v[84:87], v[56:59], v[104:107]
    v_cndmask_b32 v6, v11, v7, s[44:45]
    v_mov_b32 v8, 0x3727c5ac
    s_mov_b32 s39, 0x3acccccd
    v_mfma_f32_16x16x32_bf16 v[108:111], v[88:91], v[56:59], v[108:111]
    v_cndmask_b32 v10, v172, v173, s[46:47]
    v_cndmask_b32 v11, v176, v177, s[46:47]
    v_mfma_f32_16x16x32_bf16 v[112:115], v[72:75], v[60:63], v[112:115]
    v_cndmask_b32 v10, v10, v174, s[48:49]
    v_cndmask_b32 v11, v11, v178, s[48:49]
    v_mfma_f32_16x16x32_bf16 v[116:119], v[76:79], v[60:63], v[116:119]
    v_cndmask_b32 v10, v10, v175, s[50:51]
    v_cndmask_b32 v11, v11, v179, s[50:51]
    v_mfma_f32_16x16x32_bf16 v[120:123], v[80:83], v[60:63], v[120:123]
    v_fma_f32 v10, v10, s39, v8
    v_fma_f32 v11, v11, s39, v8
    v_add_u32 v6, 147456, v6
    v_mfma_f32_16x16x32_bf16 v[124:127], v[84:87], v[60:63], v[124:127]
    v_rsq_f32 v10, v10
    v_rsq_f32 v11, v11
    s_add_u32 s38, s38, 147456
    v_mfma_f32_16x16x32_bf16 v[128:131], v[88:91], v[60:63], v[128:131]
    ds_write_b32 v6, v10
    ds_write_b32 v6, v11 offset:64
    v_lshlrev_b32 v7, 2, v1
    v_mfma_f32_16x16x32_bf16 v[132:135], v[72:75], v[64:67], v[132:135]
    v_add_u32 v7, s38, v7
    v_xor_b32 v8, 0x80, v7
    v_mfma_f32_16x16x32_bf16 v[136:139], v[76:79], v[64:67], v[136:139]
    s_waitcnt lgkmcnt(0)
    s_barrier
    v_mfma_f32_16x16x32_bf16 v[140:143], v[80:83], v[64:67], v[140:143]
    ds_read_b32 v20, v7 offset:0
    ds_read_b32 v24, v7 offset:64
    ds_read_b32 v28, v8 offset:0
    ds_read_b32 v32, v8 offset:64
    v_mfma_f32_16x16x32_bf16 v[144:147], v[84:87], v[64:67], v[144:147]
    v_mfma_f32_16x16x32_bf16 v[148:151], v[88:91], v[64:67], v[148:151]
    v_mfma_f32_16x16x32_bf16 v[152:155], v[72:75], v[68:71], v[152:155]
    v_mfma_f32_16x16x32_bf16 v[156:159], v[76:79], v[68:71], v[156:159]
    v_mfma_f32_16x16x32_bf16 v[160:163], v[80:83], v[68:71], v[160:163]
    v_mfma_f32_16x16x32_bf16 v[164:167], v[84:87], v[68:71], v[164:167]
    v_mfma_f32_16x16x32_bf16 v[168:171], v[88:91], v[68:71], v[168:171]
    s_lshl_b32 s38, s27, 2
    s_add_u32 s38, s38, s3
    s_xor_b32 s39, s38, 1
    s_and_b32 s40, s28, 3
    s_lshl_b32 s40, s40, 1
    s_add_u32 s40, s40, s30
    s_lshl_b32 s40, s40, 8
    s_add_u32 s41, s40, s39
    s_add_u32 s40, s40, s38
    s_movk_i32 s42, 2560
    s_mov_b32 s43, 16777216
    s_cmp_lt_u32 s28, 4
    s_cselect_b32 s42, 1280, s42
    s_cselect_b32 s43, 12582912, s43
    s_mul_i32 s40, s40, s42
    s_mul_i32 s41, s41, s42
    s_add_u32 s40, s40, s43
    s_add_u32 s41, s41, s43
    s_lshl_b32 s42, s42, 6
    v_mul_lo_u32 v3, v2, s42
    v_lshl_add_u32 v3, v1, 3, v3
    s_waitcnt lgkmcnt(0)
    v_pk_mul_f32 v[108:109], v[108:109], v[20:21] op_sel_hi:[1,0]
    v_pk_mul_f32 v[110:111], v[110:111], v[20:21] op_sel_hi:[1,0]
    v_cvt_pk_bf16_f32 v108, v108, v109
    v_cvt_pk_bf16_f32 v109, v110, v111
    buffer_store_dwordx2 v[108:109], v3, s[4:7], s40 offen offset:1024 sc1
    v_pk_mul_f32 v[128:129], v[128:129], v[24:25] op_sel_hi:[1,0]
    v_pk_mul_f32 v[130:131], v[130:131], v[24:25] op_sel_hi:[1,0]
    v_cvt_pk_bf16_f32 v128, v128, v129
    v_cvt_pk_bf16_f32 v129, v130, v131
    buffer_store_dwordx2 v[128:129], v3, s[4:7], s40 offen offset:1152 sc1
    v_pk_mul_f32 v[92:93], v[92:93], v[20:21] op_sel_hi:[1,0]
    v_pk_mul_f32 v[94:95], v[94:95], v[20:21] op_sel_hi:[1,0]
    v_pk_mul_f32 v[112:113], v[112:113], v[24:25] op_sel_hi:[1,0]
    v_pk_mul_f32 v[114:115], v[114:115], v[24:25] op_sel_hi:[1,0]
    v_cvt_pk_bf16_f32 v92, v92, v93
    v_cvt_pk_bf16_f32 v93, v94, v95
    v_cvt_pk_bf16_f32 v94, v112, v113
    v_cvt_pk_bf16_f32 v95, v114, v115
    s_nop 1
    v_permlane16_swap_b32 v92, v94
    v_permlane16_swap_b32 v93, v95
    buffer_store_dwordx4 v[92:95], v5, s[4:7], s40 offen offset:0 sc1
    s_add_u32 s40, s40, s42
    v_pk_mul_f32 v[96:97], v[96:97], v[20:21] op_sel_hi:[1,0]
    v_pk_mul_f32 v[98:99], v[98:99], v[20:21] op_sel_hi:[1,0]
    v_pk_mul_f32 v[116:117], v[116:117], v[24:25] op_sel_hi:[1,0]
    v_pk_mul_f32 v[118:119], v[118:119], v[24:25] op_sel_hi:[1,0]
    v_cvt_pk_bf16_f32 v96, v96, v97
    v_cvt_pk_bf16_f32 v97, v98, v99
    v_cvt_pk_bf16_f32 v98, v116, v117
    v_cvt_pk_bf16_f32 v99, v118, v119
    s_nop 1
    v_permlane16_swap_b32 v96, v98
    v_permlane16_swap_b32 v97, v99
    buffer_store_dwordx4 v[96:99], v5, s[4:7], s40 offen offset:0 sc1
    s_add_u32 s40, s40, s42
    v_pk_mul_f32 v[100:101], v[100:101], v[20:21] op_sel_hi:[1,0]
    v_pk_mul_f32 v[102:103], v[102:103], v[20:21] op_sel_hi:[1,0]
    v_pk_mul_f32 v[120:121], v[120:121], v[24:25] op_sel_hi:[1,0]
    v_pk_mul_f32 v[122:123], v[122:123], v[24:25] op_sel_hi:[1,0]
    v_cvt_pk_bf16_f32 v100, v100, v101
    v_cvt_pk_bf16_f32 v101, v102, v103
    v_cvt_pk_bf16_f32 v102, v120, v121
    v_cvt_pk_bf16_f32 v103, v122, v123
    s_nop 1
    v_permlane16_swap_b32 v100, v102
    v_permlane16_swap_b32 v101, v103
    buffer_store_dwordx4 v[100:103], v5, s[4:7], s40 offen offset:0 sc1
    s_add_u32 s40, s40, s42
    v_pk_mul_f32 v[104:105], v[104:105], v[20:21] op_sel_hi:[1,0]
    v_pk_mul_f32 v[106:107], v[106:107], v[20:21] op_sel_hi:[1,0]
    v_pk_mul_f32 v[124:125], v[124:125], v[24:25] op_sel_hi:[1,0]
    v_pk_mul_f32 v[126:127], v[126:127], v[24:25] op_sel_hi:[1,0]
    v_cvt_pk_bf16_f32 v104, v104, v105
    v_cvt_pk_bf16_f32 v105, v106, v107
    v_cvt_pk_bf16_f32 v106, v124, v125
    v_cvt_pk_bf16_f32 v107, v126, v127
    s_nop 1
    v_permlane16_swap_b32 v104, v106
    v_permlane16_swap_b32 v105, v107
    buffer_store_dwordx4 v[104:107], v5, s[4:7], s40 offen offset:0 sc1
    v_pk_mul_f32 v[148:149], v[148:149], v[28:29] op_sel_hi:[1,0]
    v_pk_mul_f32 v[150:151], v[150:151], v[28:29] op_sel_hi:[1,0]
    v_cvt_pk_bf16_f32 v148, v148, v149
    v_cvt_pk_bf16_f32 v149, v150, v151
    buffer_store_dwordx2 v[148:149], v3, s[4:7], s41 offen offset:1024 sc1
    v_pk_mul_f32 v[168:169], v[168:169], v[32:33] op_sel_hi:[1,0]
    v_pk_mul_f32 v[170:171], v[170:171], v[32:33] op_sel_hi:[1,0]
    v_cvt_pk_bf16_f32 v168, v168, v169
    v_cvt_pk_bf16_f32 v169, v170, v171
    buffer_store_dwordx2 v[168:169], v3, s[4:7], s41 offen offset:1152 sc1
    v_pk_mul_f32 v[132:133], v[132:133], v[28:29] op_sel_hi:[1,0]
    v_pk_mul_f32 v[134:135], v[134:135], v[28:29] op_sel_hi:[1,0]
    v_pk_mul_f32 v[152:153], v[152:153], v[32:33] op_sel_hi:[1,0]
    v_pk_mul_f32 v[154:155], v[154:155], v[32:33] op_sel_hi:[1,0]
    v_cvt_pk_bf16_f32 v132, v132, v133
    v_cvt_pk_bf16_f32 v133, v134, v135
    v_cvt_pk_bf16_f32 v134, v152, v153
    v_cvt_pk_bf16_f32 v135, v154, v155
    s_nop 1
    v_permlane16_swap_b32 v132, v134
    v_permlane16_swap_b32 v133, v135
    buffer_store_dwordx4 v[132:135], v5, s[4:7], s41 offen offset:0 sc1
    s_add_u32 s41, s41, s42
    v_pk_mul_f32 v[136:137], v[136:137], v[28:29] op_sel_hi:[1,0]
    v_pk_mul_f32 v[138:139], v[138:139], v[28:29] op_sel_hi:[1,0]
    v_pk_mul_f32 v[156:157], v[156:157], v[32:33] op_sel_hi:[1,0]
    v_pk_mul_f32 v[158:159], v[158:159], v[32:33] op_sel_hi:[1,0]
    v_cvt_pk_bf16_f32 v136, v136, v137
    v_cvt_pk_bf16_f32 v137, v138, v139
    v_cvt_pk_bf16_f32 v138, v156, v157
    v_cvt_pk_bf16_f32 v139, v158, v159
    s_nop 1
    v_permlane16_swap_b32 v136, v138
    v_permlane16_swap_b32 v137, v139
    buffer_store_dwordx4 v[136:139], v5, s[4:7], s41 offen offset:0 sc1
    s_add_u32 s41, s41, s42
    v_pk_mul_f32 v[140:141], v[140:141], v[28:29] op_sel_hi:[1,0]
    v_pk_mul_f32 v[142:143], v[142:143], v[28:29] op_sel_hi:[1,0]
    v_pk_mul_f32 v[160:161], v[160:161], v[32:33] op_sel_hi:[1,0]
    v_pk_mul_f32 v[162:163], v[162:163], v[32:33] op_sel_hi:[1,0]
    v_cvt_pk_bf16_f32 v140, v140, v141
    v_cvt_pk_bf16_f32 v141, v142, v143
    v_cvt_pk_bf16_f32 v142, v160, v161
    v_cvt_pk_bf16_f32 v143, v162, v163
    s_nop 1
    v_permlane16_swap_b32 v140, v142
    v_permlane16_swap_b32 v141, v143
    buffer_store_dwordx4 v[140:143], v5, s[4:7], s41 offen offset:0 sc1
    s_add_u32 s41, s41, s42
    v_pk_mul_f32 v[144:145], v[144:145], v[28:29] op_sel_hi:[1,0]
    v_pk_mul_f32 v[146:147], v[146:147], v[28:29] op_sel_hi:[1,0]
    v_pk_mul_f32 v[164:165], v[164:165], v[32:33] op_sel_hi:[1,0]
    v_pk_mul_f32 v[166:167], v[166:167], v[32:33] op_sel_hi:[1,0]
    v_cvt_pk_bf16_f32 v144, v144, v145
    v_cvt_pk_bf16_f32 v145, v146, v147
    v_cvt_pk_bf16_f32 v146, v164, v165
    v_cvt_pk_bf16_f32 v147, v166, v167
    s_nop 1
    v_permlane16_swap_b32 v144, v146
    v_permlane16_swap_b32 v145, v147
    buffer_store_dwordx4 v[144:147], v5, s[4:7], s41 offen offset:0 sc1
    s_endpgm
L_k3_kernel_6:
L_k3_kernel_10:
    s_waitcnt lgkmcnt(0)
    v_mfma_f32_16x16x32_bf16 v[172:175], v[20:23], v[20:23], v[172:175]
    ds_read_b64_tr_b16 v[56:57], v7 offset:1024
    v_mfma_f32_16x16x32_bf16 v[176:179], v[24:27], v[24:27], v[176:179]
    ds_read_b64_tr_b16 v[58:59], v8 offset:1024
    v_mfma_f32_16x16x32_bf16 v[92:95], v[20:23], v[36:39], v[92:95]
    ds_read_b128 v[72:75], v11 offset:10240
    v_mfma_f32_16x16x32_bf16 v[96:99], v[20:23], v[40:43], v[96:99]
    ds_read_b64_tr_b16 v[60:61], v7 offset:3072
    v_mfma_f32_16x16x32_bf16 v[100:103], v[20:23], v[44:47], v[100:103]
    ds_read_b64_tr_b16 v[62:63], v8 offset:3072
    v_mfma_f32_16x16x32_bf16 v[104:107], v[20:23], v[48:51], v[104:107]
    ds_read_b128 v[76:79], v11 offset:11264
    v_mfma_f32_16x16x32_bf16 v[108:111], v[20:23], v[52:55], v[108:111]
    ds_read_b64_tr_b16 v[64:65], v9 offset:1024
    v_mfma_f32_16x16x32_bf16 v[112:115], v[24:27], v[36:39], v[112:115]
    ds_read_b64_tr_b16 v[66:67], v10 offset:1024
    v_mfma_f32_16x16x32_bf16 v[116:119], v[24:27], v[40:43], v[116:119]
    ds_read_b128 v[80:83], v11 offset:12288
    v_mfma_f32_16x16x32_bf16 v[120:123], v[24:27], v[44:47], v[120:123]
    ds_read_b64_tr_b16 v[68:69], v9 offset:3072
    v_mfma_f32_16x16x32_bf16 v[124:127], v[24:27], v[48:51], v[124:127]
    ds_read_b64_tr_b16 v[70:71], v10 offset:3072
    v_mfma_f32_16x16x32_bf16 v[128:131], v[24:27], v[52:55], v[128:131]
    ds_read_b128 v[84:87], v11 offset:13312
    v_mfma_f32_16x16x32_bf16 v[132:135], v[28:31], v[36:39], v[132:135]
    ds_read_b128 v[88:91], v11 offset:14336
    v_mfma_f32_16x16x32_bf16 v[136:139], v[28:31], v[40:43], v[136:139]
    s_add_u32 s34, s34, 1
    s_add_u32 s35, s35, 36864
    v_mfma_f32_16x16x32_bf16 v[140:143], v[28:31], v[44:47], v[140:143]
    s_cmp_ge_u32 s35, 147456
    s_cselect_b32 s35, 0, s35
    v_mfma_f32_16x16x32_bf16 v[144:147], v[28:31], v[48:51], v[144:147]
    v_add_u32 v7, s35, v12
    v_mfma_f32_16x16x32_bf16 v[148:151], v[28:31], v[52:55], v[148:151]
    v_add_u32 v8, s35, v13
    v_mfma_f32_16x16x32_bf16 v[152:155], v[32:35], v[36:39], v[152:155]
    v_add_u32 v9, s35, v14
    v_mfma_f32_16x16x32_bf16 v[156:159], v[32:35], v[40:43], v[156:159]
    v_add_u32 v10, s35, v15
    v_mfma_f32_16x16x32_bf16 v[160:163], v[32:35], v[44:47], v[160:163]
    v_add_u32 v11, s35, v16
    v_mfma_f32_16x16x32_bf16 v[164:167], v[32:35], v[48:51], v[164:167]
    s_cmp_eq_u32 s34, 10
    v_mfma_f32_16x16x32_bf16 v[168:171], v[32:35], v[52:55], v[168:171]
    s_waitcnt lgkmcnt(0)
    s_cbranch_scc1 L_k3_kernel_11
    s_barrier
    v_mfma_f32_16x16x32_bf16 v[172:175], v[56:59], v[56:59], v[172:175]
    ds_read_b64_tr_b16 v[20:21], v7 offset:0
    v_mfma_f32_16x16x32_bf16 v[176:179], v[60:63], v[60:63], v[176:179]
    ds_read_b64_tr_b16 v[22:23], v8 offset:0
    v_mfma_f32_16x16x32_bf16 v[92:95], v[56:59], v[72:75], v[92:95]
    ds_read_b128 v[36:39], v11 offset:0
    v_mfma_f32_16x16x32_bf16 v[96:99], v[56:59], v[76:79], v[96:99]
    ds_read_b64_tr_b16 v[24:25], v7 offset:2048
    v_mfma_f32_16x16x32_bf16 v[100:103], v[56:59], v[80:83], v[100:103]
    ds_read_b64_tr_b16 v[26:27], v8 offset:2048
    v_mfma_f32_16x16x32_bf16 v[104:107], v[56:59], v[84:87], v[104:107]
    ds_read_b128 v[40:43], v11 offset:1024
    v_mfma_f32_16x16x32_bf16 v[108:111], v[56:59], v[88:91], v[108:111]
    ds_read_b64_tr_b16 v[28:29], v9 offset:0
    v_mfma_f32_16x16x32_bf16 v[112:115], v[60:63], v[72:75], v[112:115]
    ds_read_b64_tr_b16 v[30:31], v10 offset:0
    v_mfma_f32_16x16x32_bf16 v[116:119], v[60:63], v[76:79], v[116:119]
    ds_read_b128 v[44:47], v11 offset:2048
    v_mfma_f32_16x16x32_bf16 v[120:123], v[60:63], v[80:83], v[120:123]
    ds_read_b64_tr_b16 v[32:33], v9 offset:2048
    v_mfma_f32_16x16x32_bf16 v[124:127], v[60:63], v[84:87], v[124:127]
    ds_read_b64_tr_b16 v[34:35], v10 offset:2048
    v_mfma_f32_16x16x32_bf16 v[128:131], v[60:63], v[88:91], v[128:131]
    ds_read_b128 v[48:51], v11 offset:3072
    v_mfma_f32_16x16x32_bf16 v[132:135], v[64:67], v[72:75], v[132:135]
    ds_read_b128 v[52:55], v11 offset:4096
    v_mfma_f32_16x16x32_bf16 v[136:139], v[64:67], v[76:79], v[136:139]
    v_mfma_f32_16x16x32_bf16 v[140:143], v[64:67], v[80:83], v[140:143]
    v_mfma_f32_16x16x32_bf16 v[144:147], v[64:67], v[84:87], v[144:147]
    v_mfma_f32_16x16x32_bf16 v[148:151], v[64:67], v[88:91], v[148:151]
    v_mfma_f32_16x16x32_bf16 v[152:155], v[68:71], v[72:75], v[152:155]
    v_mfma_f32_16x16x32_bf16 v[156:159], v[68:71], v[76:79], v[156:159]
    v_mfma_f32_16x16x32_bf16 v[160:163], v[68:71], v[80:83], v[160:163]
    v_mfma_f32_16x16x32_bf16 v[164:167], v[68:71], v[84:87], v[164:167]
    v_mfma_f32_16x16x32_bf16 v[168:171], v[68:71], v[88:91], v[168:171]
    s_branch L_k3_kernel_10
L_k3_kernel_11:
    v_mfma_f32_16x16x32_bf16 v[172:175], v[56:59], v[56:59], v[172:175]
    s_lshl_b32 s38, s3, 7
    v_lshlrev_b32 v7, 2, v1
    v_mfma_f32_16x16x32_bf16 v[176:179], v[60:63], v[60:63], v[176:179]
    v_add_u32 v7, s38, v7
    v_lshrrev_b32 v10, 2, v1
    v_mfma_f32_16x16x32_bf16 v[92:95], v[56:59], v[72:75], v[92:95]
    v_cmp_eq_u32 s[44:45], v10, v2
    v_and_b32 v10, 3, v1
    v_mfma_f32_16x16x32_bf16 v[96:99], v[56:59], v[76:79], v[96:99]
    v_cmp_eq_u32 s[46:47], 1, v10
    v_cmp_eq_u32 s[48:49], 2, v10
    v_mfma_f32_16x16x32_bf16 v[100:103], v[56:59], v[80:83], v[100:103]
    v_cmp_eq_u32 s[50:51], 3, v10
    v_add_u32 v11, 512, v5
    v_mfma_f32_16x16x32_bf16 v[104:107], v[56:59], v[84:87], v[104:107]
    v_cndmask_b32 v6, v11, v7, s[44:45]
    v_mov_b32 v8, 0x3727c5ac
    s_mov_b32 s39, 0x3acccccd
    v_mfma_f32_16x16x32_bf16 v[108:111], v[56:59], v[88:91], v[108:111]
    v_cndmask_b32 v10, v172, v173, s[46:47]
    v_cndmask_b32 v11, v176, v177, s[46:47]
    v_mfma_f32_16x16x32_bf16 v[112:115], v[60:63], v[72:75], v[112:115]
    v_cndmask_b32 v10, v10, v174, s[48:49]
    v_cndmask_b32 v11, v11, v178, s[48:49]
    v_mfma_f32_16x16x32_bf16 v[116:119], v[60:63], v[76:79], v[116:119]
    v_cndmask_b32 v10, v10, v175, s[50:51]
    v_cndmask_b32 v11, v11, v179, s[50:51]
    v_mfma_f32_16x16x32_bf16 v[120:123], v[60:63], v[80:83], v[120:123]
    v_fma_f32 v10, v10, s39, v8
    v_fma_f32 v11, v11, s39, v8
    v_add_u32 v6, 147456, v6
    v_mfma_f32_16x16x32_bf16 v[124:127], v[60:63], v[84:87], v[124:127]
    v_rsq_f32 v10, v10
    v_rsq_f32 v11, v11
    s_add_u32 s38, s38, 147456
    v_mfma_f32_16x16x32_bf16 v[128:131], v[60:63], v[88:91], v[128:131]
    ds_write_b32 v6, v10
    ds_write_b32 v6, v11 offset:64
    v_lshlrev_b32 v7, 4, v2
    v_mfma_f32_16x16x32_bf16 v[132:135], v[64:67], v[72:75], v[132:135]
    v_add_u32 v7, s38, v7
    v_xor_b32 v8, 0x80, v7
    v_mfma_f32_16x16x32_bf16 v[136:139], v[64:67], v[76:79], v[136:139]
    s_waitcnt lgkmcnt(0)
    s_barrier
    v_mfma_f32_16x16x32_bf16 v[140:143], v[64:67], v[80:83], v[140:143]
    ds_read_b128 v[20:23], v7 offset:0
    ds_read_b128 v[24:27], v7 offset:64
    ds_read_b128 v[28:31], v8 offset:0
    ds_read_b128 v[32:35], v8 offset:64
    v_mfma_f32_16x16x32_bf16 v[144:147], v[64:67], v[84:87], v[144:147]
    v_mfma_f32_16x16x32_bf16 v[148:151], v[64:67], v[88:91], v[148:151]
    v_mfma_f32_16x16x32_bf16 v[152:155], v[68:71], v[72:75], v[152:155]
    v_mfma_f32_16x16x32_bf16 v[156:159], v[68:71], v[76:79], v[156:159]
    v_mfma_f32_16x16x32_bf16 v[160:163], v[68:71], v[80:83], v[160:163]
    v_mfma_f32_16x16x32_bf16 v[164:167], v[68:71], v[84:87], v[164:167]
    v_mfma_f32_16x16x32_bf16 v[168:171], v[68:71], v[88:91], v[168:171]
    s_lshl_b32 s38, s27, 2
    s_add_u32 s38, s38, s3
    s_xor_b32 s39, s38, 1
    s_and_b32 s40, s28, 3
    s_lshl_b32 s40, s40, 1
    s_add_u32 s40, s40, s30
    s_lshl_b32 s40, s40, 8
    s_add_u32 s41, s40, s39
    s_add_u32 s40, s40, s38
    s_movk_i32 s42, 2560
    s_mov_b32 s43, 16777216
    s_cmp_lt_u32 s28, 4
    s_cselect_b32 s42, 1280, s42
    s_cselect_b32 s43, 12582912, s43
    s_mul_i32 s40, s40, s42
    s_mul_i32 s41, s41, s42
    s_add_u32 s40, s40, s43
    s_add_u32 s41, s41, s43
    s_lshl_b32 s42, s42, 6
    v_lshrrev_b32 v3, 5, v0
    v_mul_u32_u24 v3, 640, v3
    v_and_b32 v4, 1, v2
    v_mul_u32_u24 v4, 320, v4
    v_add_u32 v3, v3, v4
    v_and_b32 v4, 3, v1
    v_lshl_add_u32 v4, v4, 4, v3
    v_lshl_add_u32 v3, v1, 4, v3
    v_lshrrev_b32 v6, 2, v1
    v_mul_u32_u24 v6, 163840, v6
    v_add_u32 v4, v4, v6
    s_waitcnt lgkmcnt(0)
    v_pk_mul_f32 v[108:109], v[108:109], v[20:21]
    v_pk_mul_f32 v[110:111], v[110:111], v[22:23]
    v_pk_mul_f32 v[128:129], v[128:129], v[24:25]
    v_pk_mul_f32 v[130:131], v[130:131], v[26:27]
    v_cvt_pk_bf16_f32 v108, v108, v109
    v_cvt_pk_bf16_f32 v109, v110, v111
    v_cvt_pk_bf16_f32 v110, v128, v129
    v_cvt_pk_bf16_f32 v111, v130, v131
    s_nop 1
    v_permlane32_swap_b32 v108, v110
    v_permlane32_swap_b32 v109, v111
    buffer_store_dwordx4 v[108:111], v4, s[4:7], s40 offen offset:1536 sc1
    v_pk_mul_f32 v[92:93], v[92:93], v[20:21]
    v_pk_mul_f32 v[94:95], v[94:95], v[22:23]
    v_pk_mul_f32 v[112:113], v[112:113], v[24:25]
    v_pk_mul_f32 v[114:115], v[114:115], v[26:27]
    v_cvt_pk_bf16_f32 v92, v92, v93
    v_cvt_pk_bf16_f32 v93, v94, v95
    v_cvt_pk_bf16_f32 v94, v112, v113
    v_cvt_pk_bf16_f32 v95, v114, v115
    s_nop 1
    v_permlane32_swap_b32 v92, v94
    v_permlane32_swap_b32 v93, v95
    buffer_store_dwordx4 v[92:95], v3, s[4:7], s40 offen offset:1280 sc1
    s_add_u32 s40, s40, s42
    v_pk_mul_f32 v[96:97], v[96:97], v[20:21]
    v_pk_mul_f32 v[98:99], v[98:99], v[22:23]
    v_pk_mul_f32 v[116:117], v[116:117], v[24:25]
    v_pk_mul_f32 v[118:119], v[118:119], v[26:27]
    v_cvt_pk_bf16_f32 v96, v96, v97
    v_cvt_pk_bf16_f32 v97, v98, v99
    v_cvt_pk_bf16_f32 v98, v116, v117
    v_cvt_pk_bf16_f32 v99, v118, v119
    s_nop 1
    v_permlane32_swap_b32 v96, v98
    v_permlane32_swap_b32 v97, v99
    buffer_store_dwordx4 v[96:99], v3, s[4:7], s40 offen offset:1280 sc1
    s_add_u32 s40, s40, s42
    v_pk_mul_f32 v[100:101], v[100:101], v[20:21]
    v_pk_mul_f32 v[102:103], v[102:103], v[22:23]
    v_pk_mul_f32 v[120:121], v[120:121], v[24:25]
    v_pk_mul_f32 v[122:123], v[122:123], v[26:27]
    v_cvt_pk_bf16_f32 v100, v100, v101
    v_cvt_pk_bf16_f32 v101, v102, v103
    v_cvt_pk_bf16_f32 v102, v120, v121
    v_cvt_pk_bf16_f32 v103, v122, v123
    s_nop 1
    v_permlane32_swap_b32 v100, v102
    v_permlane32_swap_b32 v101, v103
    buffer_store_dwordx4 v[100:103], v3, s[4:7], s40 offen offset:1280 sc1
    s_add_u32 s40, s40, s42
    v_pk_mul_f32 v[104:105], v[104:105], v[20:21]
    v_pk_mul_f32 v[106:107], v[106:107], v[22:23]
    v_pk_mul_f32 v[124:125], v[124:125], v[24:25]
    v_pk_mul_f32 v[126:127], v[126:127], v[26:27]
    v_cvt_pk_bf16_f32 v104, v104, v105
    v_cvt_pk_bf16_f32 v105, v106, v107
    v_cvt_pk_bf16_f32 v106, v124, v125
    v_cvt_pk_bf16_f32 v107, v126, v127
    s_nop 1
    v_permlane32_swap_b32 v104, v106
    v_permlane32_swap_b32 v105, v107
    buffer_store_dwordx4 v[104:107], v3, s[4:7], s40 offen offset:1280 sc1
    v_pk_mul_f32 v[148:149], v[148:149], v[28:29]
    v_pk_mul_f32 v[150:151], v[150:151], v[30:31]
    v_pk_mul_f32 v[168:169], v[168:169], v[32:33]
    v_pk_mul_f32 v[170:171], v[170:171], v[34:35]
    v_cvt_pk_bf16_f32 v148, v148, v149
    v_cvt_pk_bf16_f32 v149, v150, v151
    v_cvt_pk_bf16_f32 v150, v168, v169
    v_cvt_pk_bf16_f32 v151, v170, v171
    s_nop 1
    v_permlane32_swap_b32 v148, v150
    v_permlane32_swap_b32 v149, v151
    buffer_store_dwordx4 v[148:151], v4, s[4:7], s41 offen offset:1536 sc1
    v_pk_mul_f32 v[132:133], v[132:133], v[28:29]
    v_pk_mul_f32 v[134:135], v[134:135], v[30:31]
    v_pk_mul_f32 v[152:153], v[152:153], v[32:33]
    v_pk_mul_f32 v[154:155], v[154:155], v[34:35]
    v_cvt_pk_bf16_f32 v132, v132, v133
    v_cvt_pk_bf16_f32 v133, v134, v135
    v_cvt_pk_bf16_f32 v134, v152, v153
    v_cvt_pk_bf16_f32 v135, v154, v155
    s_nop 1
    v_permlane32_swap_b32 v132, v134
    v_permlane32_swap_b32 v133, v135
    buffer_store_dwordx4 v[132:135], v3, s[4:7], s41 offen offset:1280 sc1
    s_add_u32 s41, s41, s42
    v_pk_mul_f32 v[136:137], v[136:137], v[28:29]
    v_pk_mul_f32 v[138:139], v[138:139], v[30:31]
    v_pk_mul_f32 v[156:157], v[156:157], v[32:33]
    v_pk_mul_f32 v[158:159], v[158:159], v[34:35]
    v_cvt_pk_bf16_f32 v136, v136, v137
    v_cvt_pk_bf16_f32 v137, v138, v139
    v_cvt_pk_bf16_f32 v138, v156, v157
    v_cvt_pk_bf16_f32 v139, v158, v159
    s_nop 1
    v_permlane32_swap_b32 v136, v138
    v_permlane32_swap_b32 v137, v139
    buffer_store_dwordx4 v[136:139], v3, s[4:7], s41 offen offset:1280 sc1
    s_add_u32 s41, s41, s42
    v_pk_mul_f32 v[140:141], v[140:141], v[28:29]
    v_pk_mul_f32 v[142:143], v[142:143], v[30:31]
    v_pk_mul_f32 v[160:161], v[160:161], v[32:33]
    v_pk_mul_f32 v[162:163], v[162:163], v[34:35]
    v_cvt_pk_bf16_f32 v140, v140, v141
    v_cvt_pk_bf16_f32 v141, v142, v143
    v_cvt_pk_bf16_f32 v142, v160, v161
    v_cvt_pk_bf16_f32 v143, v162, v163
    s_nop 1
    v_permlane32_swap_b32 v140, v142
    v_permlane32_swap_b32 v141, v143
    buffer_store_dwordx4 v[140:143], v3, s[4:7], s41 offen offset:1280 sc1
    s_add_u32 s41, s41, s42
    v_pk_mul_f32 v[144:145], v[144:145], v[28:29]
    v_pk_mul_f32 v[146:147], v[146:147], v[30:31]
    v_pk_mul_f32 v[164:165], v[164:165], v[32:33]
    v_pk_mul_f32 v[166:167], v[166:167], v[34:35]
    v_cvt_pk_bf16_f32 v144, v144, v145
    v_cvt_pk_bf16_f32 v145, v146, v147
    v_cvt_pk_bf16_f32 v146, v164, v165
    v_cvt_pk_bf16_f32 v147, v166, v167
    s_nop 1
    v_permlane32_swap_b32 v144, v146
    v_permlane32_swap_b32 v145, v147
    buffer_store_dwordx4 v[144:147], v3, s[4:7], s41 offen offset:1280 sc1
    s_endpgm
L_k3_kernel_2:
    s_mov_b32 s28, s18
    s_and_b32 s29, s19, 0xffff
    s_mov_b32 s30, 819200
    s_mov_b32 s31, 0x00020000
    s_mul_i32 s27, s26, 86
    s_lshr_b32 s27, s27, 8
    s_mul_i32 s38, s27, 3
    s_sub_u32 s38, s26, s38
    s_mul_i32 s38, s38, 7
    s_add_u32 s38, s38, s3
    s_mul_i32 s33, s38, 52
    s_lshr_b32 s33, s33, 8
    v_and_b32 v1, 15, v0
    v_lshrrev_b32 v2, 4, v0
    s_cmp_ge_u32 s27, 16
    s_cbranch_scc1 L_k3_kernel_13
    v_mul_u32_u24 v3, 1280, v1
    s_mul_i32 s34, s27, 51200
    s_add_u32 s35, s34, 25600
    s_branch L_k3_kernel_14
L_k3_kernel_13:
    v_lshrrev_b32 v3, 2, v1
    v_mul_u32_u24 v3, 20, v3
    v_and_b32 v4, 3, v1
    v_add_u32 v3, v3, v4
    v_mul_u32_u24 v3, 1280, v3
    s_sub_u32 s34, s27, 16
    s_mul_i32 s34, s34, 204800
    s_add_u32 s34, s34, 20480
    s_add_u32 s35, s34, 102400
L_k3_kernel_14:
    v_lshl_add_u32 v3, v2, 4, v3
    s_cmp_lt_u32 s3, 4
    s_cselect_b32 s34, s34, s35
    s_and_b32 s36, s3, 3
    s_mul_i32 s36, s36, 320
    s_add_u32 s34, s34, s36
    s_mul_i32 s36, s3, 5120
    v_lshlrev_b32 v4, 4, v0
    s_add_u32 m0, s36, 0
    s_add_u32 s37, s34, 0
    buffer_load_dwordx4 v3, s[28:31], s37 offen lds
    s_add_u32 m0, s36, 1024
    s_add_u32 s37, s34, 64
    buffer_load_dwordx4 v3, s[28:31], s37 offen lds
    s_add_u32 m0, s36, 2048
    s_add_u32 s37, s34, 128
    buffer_load_dwordx4 v3, s[28:31], s37 offen lds
    s_add_u32 m0, s36, 3072
    s_add_u32 s37, s34, 192
    buffer_load_dwordx4 v3, s[28:31], s37 offen lds
    s_add_u32 m0, s36, 4096
    s_add_u32 s37, s34, 256
    buffer_load_dwordx4 v3, s[28:31], s37 offen lds
    s_cmp_lt_u32 s3, 7
    s_cselect_b32 s37, s38, 99
    s_cmp_lt_u32 s37, 20
    s_cbranch_scc1 L_k3_kernel_15
    s_waitcnt vmcnt(0)
    s_barrier
    s_endpgm
L_k3_kernel_15:
    s_mul_i32 s39, s38, 10240
    s_add_u32 s39, s39, 26279936
    s_add_u32 s41, s39, 4096
    s_add_u32 s42, s39, 8192
    buffer_load_dwordx4 v[8:11], v4, s[4:7], s39 offen offset:0
    buffer_load_dwordx4 v[12:15], v4, s[4:7], s39 offen offset:1024
    buffer_load_dwordx4 v[16:19], v4, s[4:7], s39 offen offset:2048
    buffer_load_dwordx4 v[20:23], v4, s[4:7], s39 offen offset:3072
    buffer_load_dwordx4 v[24:27], v4, s[4:7], s41 offen offset:0
    buffer_load_dwordx4 v[28:31], v4, s[4:7], s41 offen offset:1024
    buffer_load_dwordx4 v[32:35], v4, s[4:7], s41 offen offset:2048
    buffer_load_dwordx4 v[36:39], v4, s[4:7], s41 offen offset:3072
    buffer_load_dwordx4 v[40:43], v4, s[4:7], s42 offen offset:0
    buffer_load_dwordx4 v[44:47], v4, s[4:7], s42 offen offset:1024
    v_lshrrev_b32 v5, 3, v1
    v_mul_u32_u24 v5, 20480, v5
    v_and_b32 v6, 7, v1
    v_lshl_add_u32 v5, v6, 5, v5
    s_mul_i32 s34, s38, 40960
    s_lshl_b32 s35, s27, 10
    s_add_u32 s34, s34, s35
    s_add_u32 s34, s34, 9568256
    s_cmp_ge_u32 s27, 16
    s_cbranch_scc1 L_k3_kernel_16
    v_and_b32 v6, 1, v2
    v_lshl_add_u32 v5, v6, 8, v5
    v_lshrrev_b32 v6, 1, v2
    v_lshl_add_u32 v5, v6, 3, v5
    s_add_u32 s35, s34, 512
    s_branch L_k3_kernel_17
L_k3_kernel_16:
    v_lshl_add_u32 v5, v2, 8, v5
    s_add_u32 s35, s34, 8
L_k3_kernel_17:
    v_add_u32 v6, 16, v5
    s_waitcnt vmcnt(0)
    s_barrier
    s_cmp_eq_u32 s33, 1
    s_cbranch_scc1 L_k3_kernel_19
    s_cmp_eq_u32 s33, 2
    s_cbranch_scc1 L_k3_kernel_20
    s_cmp_eq_u32 s33, 3
    s_cbranch_scc1 L_k3_kernel_21
L_k3_kernel_18:
    ds_read_b128 v[48:51], v4 offset:0
    ds_read_b128 v[52:55], v4 offset:1024
    ds_read_b128 v[56:59], v4 offset:2048
    ds_read_b128 v[60:63], v4 offset:3072
    ds_read_b128 v[64:67], v4 offset:4096
    ds_read_b128 v[68:71], v4 offset:5120
    ds_read_b128 v[72:75], v4 offset:6144
    ds_read_b128 v[76:79], v4 offset:7168
    ds_read_b128 v[80:83], v4 offset:8192
    ds_read_b128 v[84:87], v4 offset:9216
    s_waitcnt lgkmcnt(5)
    v_mfma_f32_16x16x32_bf16 v[88:91], v[48:51], v[8:11], 0
    v_mfma_f32_16x16x32_bf16 v[96:99], v[48:51], v[28:31], 0
    v_mfma_f32_16x16x32_bf16 v[88:91], v[52:55], v[12:15], v[88:91]
    v_mfma_f32_16x16x32_bf16 v[96:99], v[52:55], v[32:35], v[96:99]
    v_mfma_f32_16x16x32_bf16 v[88:91], v[56:59], v[16:19], v[88:91]
    v_mfma_f32_16x16x32_bf16 v[96:99], v[56:59], v[36:39], v[96:99]
    v_mfma_f32_16x16x32_bf16 v[88:91], v[60:63], v[20:23], v[88:91]
    v_mfma_f32_16x16x32_bf16 v[96:99], v[60:63], v[40:43], v[96:99]
    v_mfma_f32_16x16x32_bf16 v[88:91], v[64:67], v[24:27], v[88:91]
    v_mfma_f32_16x16x32_bf16 v[96:99], v[64:67], v[44:47], v[96:99]
    ds_read_b128 v[48:51], v4 offset:10240
    ds_read_b128 v[52:55], v4 offset:11264
    ds_read_b128 v[56:59], v4 offset:12288
    ds_read_b128 v[60:63], v4 offset:13312
    ds_read_b128 v[64:67], v4 offset:14336
    s_waitcnt lgkmcnt(5)
    v_mfma_f32_16x16x32_bf16 v[88:91], v[68:71], v[8:11], v[88:91]
    v_mfma_f32_16x16x32_bf16 v[96:99], v[68:71], v[28:31], v[96:99]
    v_mfma_f32_16x16x32_bf16 v[88:91], v[72:75], v[12:15], v[88:91]
    v_mfma_f32_16x16x32_bf16 v[96:99], v[72:75], v[32:35], v[96:99]
    v_mfma_f32_16x16x32_bf16 v[88:91], v[76:79], v[16:19], v[88:91]
    v_mfma_f32_16x16x32_bf16 v[96:99], v[76:79], v[36:39], v[96:99]
    v_mfma_f32_16x16x32_bf16 v[88:91], v[80:83], v[20:23], v[88:91]
    v_mfma_f32_16x16x32_bf16 v[96:99], v[80:83], v[40:43], v[96:99]
    v_mfma_f32_16x16x32_bf16 v[88:91], v[84:87], v[24:27], v[88:91]
    v_mfma_f32_16x16x32_bf16 v[96:99], v[84:87], v[44:47], v[96:99]
    ds_read_b128 v[68:71], v4 offset:15360
    ds_read_b128 v[72:75], v4 offset:16384
    ds_read_b128 v[76:79], v4 offset:17408
    ds_read_b128 v[80:83], v4 offset:18432
    ds_read_b128 v[84:87], v4 offset:19456
    s_waitcnt lgkmcnt(5)
    v_mfma_f32_16x16x32_bf16 v[88:91], v[48:51], v[8:11], v[88:91]
    v_mfma_f32_16x16x32_bf16 v[96:99], v[48:51], v[28:31], v[96:99]
    v_mfma_f32_16x16x32_bf16 v[88:91], v[52:55], v[12:15], v[88:91]
    v_mfma_f32_16x16x32_bf16 v[96:99], v[52:55], v[32:35], v[96:99]
    v_mfma_f32_16x16x32_bf16 v[88:91], v[56:59], v[16:19], v[88:91]
    v_mfma_f32_16x16x32_bf16 v[96:99], v[56:59], v[36:39], v[96:99]
    v_mfma_f32_16x16x32_bf16 v[88:91], v[60:63], v[20:23], v[88:91]
    v_mfma_f32_16x16x32_bf16 v[96:99], v[60:63], v[40:43], v[96:99]
    v_mfma_f32_16x16x32_bf16 v[88:91], v[64:67], v[24:27], v[88:91]
    v_mfma_f32_16x16x32_bf16 v[96:99], v[64:67], v[44:47], v[96:99]
    ds_read_b128 v[48:51], v4 offset:20480
    ds_read_b128 v[52:55], v4 offset:21504
    ds_read_b128 v[56:59], v4 offset:22528
    ds_read_b128 v[60:63], v4 offset:23552
    ds_read_b128 v[64:67], v4 offset:24576
    s_waitcnt lgkmcnt(5)
    v_mfma_f32_16x16x32_bf16 v[88:91], v[68:71], v[8:11], v[88:91]
    v_mfma_f32_16x16x32_bf16 v[96:99], v[68:71], v[28:31], v[96:99]
    v_mfma_f32_16x16x32_bf16 v[88:91], v[72:75], v[12:15], v[88:91]
    v_mfma_f32_16x16x32_bf16 v[96:99], v[72:75], v[32:35], v[96:99]
    v_mfma_f32_16x16x32_bf16 v[88:91], v[76:79], v[16:19], v[88:91]
    v_mfma_f32_16x16x32_bf16 v[96:99], v[76:79], v[36:39], v[96:99]
    v_mfma_f32_16x16x32_bf16 v[88:91], v[80:83], v[20:23], v[88:91]
    v_mfma_f32_16x16x32_bf16 v[96:99], v[80:83], v[40:43], v[96:99]
    v_mfma_f32_16x16x32_bf16 v[88:91], v[84:87], v[24:27], v[88:91]
    v_mfma_f32_16x16x32_bf16 v[96:99], v[84:87], v[44:47], v[96:99]
    ds_read_b128 v[68:71], v4 offset:25600
    ds_read_b128 v[72:75], v4 offset:26624
    ds_read_b128 v[76:79], v4 offset:27648
    ds_read_b128 v[80:83], v4 offset:28672
    ds_read_b128 v[84:87], v4 offset:29696
    s_waitcnt lgkmcnt(5)
    v_mfma_f32_16x16x32_bf16 v[104:107], v[48:51], v[8:11], 0
    v_mfma_f32_16x16x32_bf16 v[112:115], v[48:51], v[28:31], 0
    v_mfma_f32_16x16x32_bf16 v[104:107], v[52:55], v[12:15], v[104:107]
    v_mfma_f32_16x16x32_bf16 v[112:115], v[52:55], v[32:35], v[112:115]
    v_mfma_f32_16x16x32_bf16 v[104:107], v[56:59], v[16:19], v[104:107]
    v_mfma_f32_16x16x32_bf16 v[112:115], v[56:59], v[36:39], v[112:115]
    v_mfma_f32_16x16x32_bf16 v[104:107], v[60:63], v[20:23], v[104:107]
    v_mfma_f32_16x16x32_bf16 v[112:115], v[60:63], v[40:43], v[112:115]
    v_mfma_f32_16x16x32_bf16 v[104:107], v[64:67], v[24:27], v[104:107]
    v_mfma_f32_16x16x32_bf16 v[112:115], v[64:67], v[44:47], v[112:115]
    ds_read_b128 v[48:51], v4 offset:30720
    ds_read_b128 v[52:55], v4 offset:31744
    ds_read_b128 v[56:59], v4 offset:32768
    ds_read_b128 v[60:63], v4 offset:33792
    ds_read_b128 v[64:67], v4 offset:34816
    s_waitcnt lgkmcnt(5)
    v_mfma_f32_16x16x32_bf16 v[104:107], v[68:71], v[8:11], v[104:107]
    v_mfma_f32_16x16x32_bf16 v[112:115], v[68:71], v[28:31], v[112:115]
    v_mfma_f32_16x16x32_bf16 v[104:107], v[72:75], v[12:15], v[104:107]
    v_mfma_f32_16x16x32_bf16 v[112:115], v[72:75], v[32:35], v[112:115]
    v_mfma_f32_16x16x32_bf16 v[104:107], v[76:79], v[16:19], v[104:107]
    v_mfma_f32_16x16x32_bf16 v[112:115], v[76:79], v[36:39], v[112:115]
    v_mfma_f32_16x16x32_bf16 v[104:107], v[80:83], v[20:23], v[104:107]
    v_mfma_f32_16x16x32_bf16 v[112:115], v[80:83], v[40:43], v[112:115]
    v_mfma_f32_16x16x32_bf16 v[104:107], v[84:87], v[24:27], v[104:107]
    v_mfma_f32_16x16x32_bf16 v[112:115], v[84:87], v[44:47], v[112:115]
    ds_read_b128 v[68:71], v4 offset:35840
    ds_read_b128 v[72:75], v4 offset:36864
    ds_read_b128 v[76:79], v4 offset:37888
    ds_read_b128 v[80:83], v4 offset:38912
    ds_read_b128 v[84:87], v4 offset:39936
    s_waitcnt lgkmcnt(5)
    v_mfma_f32_16x16x32_bf16 v[104:107], v[48:51], v[8:11], v[104:107]
    v_mfma_f32_16x16x32_bf16 v[112:115], v[48:51], v[28:31], v[112:115]
    v_mfma_f32_16x16x32_bf16 v[104:107], v[52:55], v[12:15], v[104:107]
    v_mfma_f32_16x16x32_bf16 v[112:115], v[52:55], v[32:35], v[112:115]
    v_mfma_f32_16x16x32_bf16 v[104:107], v[56:59], v[16:19], v[104:107]
    v_mfma_f32_16x16x32_bf16 v[112:115], v[56:59], v[36:39], v[112:115]
    v_mfma_f32_16x16x32_bf16 v[104:107], v[60:63], v[20:23], v[104:107]
    v_mfma_f32_16x16x32_bf16 v[112:115], v[60:63], v[40:43], v[112:115]
    v_mfma_f32_16x16x32_bf16 v[104:107], v[64:67], v[24:27], v[104:107]
    v_mfma_f32_16x16x32_bf16 v[112:115], v[64:67], v[44:47], v[112:115]
    s_waitcnt lgkmcnt(0)
    v_mfma_f32_16x16x32_bf16 v[104:107], v[68:71], v[8:11], v[104:107]
    v_mfma_f32_16x16x32_bf16 v[112:115], v[68:71], v[28:31], v[112:115]
    v_mfma_f32_16x16x32_bf16 v[104:107], v[72:75], v[12:15], v[104:107]
    v_mfma_f32_16x16x32_bf16 v[112:115], v[72:75], v[32:35], v[112:115]
    v_mfma_f32_16x16x32_bf16 v[104:107], v[76:79], v[16:19], v[104:107]
    v_mfma_f32_16x16x32_bf16 v[112:115], v[76:79], v[36:39], v[112:115]
    v_mfma_f32_16x16x32_bf16 v[104:107], v[80:83], v[20:23], v[104:107]
    v_mfma_f32_16x16x32_bf16 v[112:115], v[80:83], v[40:43], v[112:115]
    v_mfma_f32_16x16x32_bf16 v[104:107], v[84:87], v[24:27], v[104:107]
    v_mfma_f32_16x16x32_bf16 v[112:115], v[84:87], v[44:47], v[112:115]
    s_nop 7
    s_branch L_k3_kernel_22
L_k3_kernel_19:
    ds_read_b128 v[48:51], v4 offset:0
    ds_read_b128 v[52:55], v4 offset:1024
    ds_read_b128 v[56:59], v4 offset:2048
    ds_read_b128 v[60:63], v4 offset:3072
    ds_read_b128 v[64:67], v4 offset:4096
    ds_read_b128 v[68:71], v4 offset:5120
    ds_read_b128 v[72:75], v4 offset:6144
    ds_read_b128 v[76:79], v4 offset:7168
    ds_read_b128 v[80:83], v4 offset:8192
    ds_read_b128 v[84:87], v4 offset:9216
    s_waitcnt lgkmcnt(5)
    v_mfma_f32_16x16x32_bf16 v[88:91], v[48:51], v[8:11], 0
    v_mfma_f32_16x16x32_bf16 v[96:99], v[48:51], v[28:31], 0
    v_mfma_f32_16x16x32_bf16 v[88:91], v[52:55], v[12:15], v[88:91]
    v_mfma_f32_16x16x32_bf16 v[96:99], v[52:55], v[32:35], v[96:99]
    v_mfma_f32_16x16x32_bf16 v[88:91], v[56:59], v[16:19], v[88:91]
    v_mfma_f32_16x16x32_bf16 v[96:99], v[56:59], v[36:39], v[96:99]
    v_mfma_f32_16x16x32_bf16 v[88:91], v[60:63], v[20:23], v[88:91]
    v_mfma_f32_16x16x32_bf16 v[96:99], v[60:63], v[40:43], v[96:99]
    v_mfma_f32_16x16x32_bf16 v[88:91], v[64:67], v[24:27], v[88:91]
    v_mfma_f32_16x16x32_bf16 v[96:99], v[64:67], v[44:47], v[96:99]
    ds_read_b128 v[48:51], v4 offset:10240
    ds_read_b128 v[52:55], v4 offset:11264
    ds_read_b128 v[56:59], v4 offset:12288
    ds_read_b128 v[60:63], v4 offset:13312
    ds_read_b128 v[64:67], v4 offset:14336
    s_waitcnt lgkmcnt(5)
    v_mfma_f32_16x16x32_bf16 v[88:91], v[68:71], v[28:31], v[88:91]
    v_mfma_f32_16x16x32_bf16 v[100:103], v[68:71], v[8:11], 0
    v_mfma_f32_16x16x32_bf16 v[88:91], v[72:75], v[32:35], v[88:91]
    v_mfma_f32_16x16x32_bf16 v[100:103], v[72:75], v[12:15], v[100:103]
    v_mfma_f32_16x16x32_bf16 v[88:91], v[76:79], v[36:39], v[88:91]
    v_mfma_f32_16x16x32_bf16 v[100:103], v[76:79], v[16:19], v[100:103]
    v_mfma_f32_16x16x32_bf16 v[88:91], v[80:83], v[40:43], v[88:91]
    v_mfma_f32_16x16x32_bf16 v[100:103], v[80:83], v[20:23], v[100:103]
    v_mfma_f32_16x16x32_bf16 v[88:91], v[84:87], v[44:47], v[88:91]
    v_mfma_f32_16x16x32_bf16 v[100:103], v[84:87], v[24:27], v[100:103]
    ds_read_b128 v[68:71], v4 offset:15360
    ds_read_b128 v[72:75], v4 offset:16384
    ds_read_b128 v[76:79], v4 offset:17408
    ds_read_b128 v[80:83], v4 offset:18432
    ds_read_b128 v[84:87], v4 offset:19456
    s_waitcnt lgkmcnt(5)
    v_mfma_f32_16x16x32_bf16 v[92:95], v[48:51], v[8:11], 0
    v_mfma_f32_16x16x32_bf16 v[100:103], v[48:51], v[28:31], v[100:103]
    v_mfma_f32_16x16x32_bf16 v[92:95], v[52:55], v[12:15], v[92:95]
    v_mfma_f32_16x16x32_bf16 v[100:103], v[52:55], v[32:35], v[100:103]
    v_mfma_f32_16x16x32_bf16 v[92:95], v[56:59], v[16:19], v[92:95]
    v_mfma_f32_16x16x32_bf16 v[100:103], v[56:59], v[36:39], v[100:103]
    v_mfma_f32_16x16x32_bf16 v[92:95], v[60:63], v[20:23], v[92:95]
    v_mfma_f32_16x16x32_bf16 v[100:103], v[60:63], v[40:43], v[100:103]
    v_mfma_f32_16x16x32_bf16 v[92:95], v[64:67], v[24:27], v[92:95]
    v_mfma_f32_16x16x32_bf16 v[100:103], v[64:67], v[44:47], v[100:103]
    ds_read_b128 v[48:51], v4 offset:20480
    ds_read_b128 v[52:55], v4 offset:21504
    ds_read_b128 v[56:59], v4 offset:22528
    ds_read_b128 v[60:63], v4 offset:23552
    ds_read_b128 v[64:67], v4 offset:24576
    s_waitcnt lgkmcnt(5)
    v_mfma_f32_16x16x32_bf16 v[92:95], v[68:71], v[28:31], v[92:95]
    v_mfma_f32_16x16x32_bf16 v[96:99], v[68:71], v[8:11], v[96:99]
    v_mfma_f32_16x16x32_bf16 v[92:95], v[72:75], v[32:35], v[92:95]
    v_mfma_f32_16x16x32_bf16 v[96:99], v[72:75], v[12:15], v[96:99]
    v_mfma_f32_16x16x32_bf16 v[92:95], v[76:79], v[36:39], v[92:95]
    v_mfma_f32_16x16x32_bf16 v[96:99], v[76:79], v[16:19], v[96:99]
    v_mfma_f32_16x16x32_bf16 v[92:95], v[80:83], v[40:43], v[92:95]
    v_mfma_f32_16x16x32_bf16 v[96:99], v[80:83], v[20:23], v[96:99]
    v_mfma_f32_16x16x32_bf16 v[92:95], v[84:87], v[44:47], v[92:95]
    v_mfma_f32_16x16x32_bf16 v[96:99], v[84:87], v[24:27], v[96:99]
    ds_read_b128 v[68:71], v4 offset:25600
    ds_read_b128 v[72:75], v4 offset:26624
    ds_read_b128 v[76:79], v4 offset:27648
    ds_read_b128 v[80:83], v4 offset:28672
    ds_read_b128 v[84:87], v4 offset:29696
    s_waitcnt lgkmcnt(5)
    v_mfma_f32_16x16x32_bf16 v[104:107], v[48:51], v[8:11], 0
    v_mfma_f32_16x16x32_bf16 v[112:115], v[48:51], v[28:31], 0
    v_mfma_f32_16x16x32_bf16 v[104:107], v[52:55], v[12:15], v[104:107]
    v_mfma_f32_16x16x32_bf16 v[112:115], v[52:55], v[32:35], v[112:115]
    v_mfma_f32_16x16x32_bf16 v[104:107], v[56:59], v[16:19], v[104:107]
    v_mfma_f32_16x16x32_bf16 v[112:115], v[56:59], v[36:39], v[112:115]
    v_mfma_f32_16x16x32_bf16 v[104:107], v[60:63], v[20:23], v[104:107]
    v_mfma_f32_16x16x32_bf16 v[112:115], v[60:63], v[40:43], v[112:115]
    v_mfma_f32_16x16x32_bf16 v[104:107], v[64:67], v[24:27], v[104:107]
    v_mfma_f32_16x16x32_bf16 v[112:115], v[64:67], v[44:47], v[112:115]
    ds_read_b128 v[48:51], v4 offset:30720
    ds_read_b128 v[52:55], v4 offset:31744
    ds_read_b128 v[56:59], v4 offset:32768
    ds_read_b128 v[60:63], v4 offset:33792
    ds_read_b128 v[64:67], v4 offset:34816
    s_waitcnt lgkmcnt(5)
    v_mfma_f32_16x16x32_bf16 v[104:107], v[68:71], v[28:31], v[104:107]
    v_mfma_f32_16x16x32_bf16 v[116:119], v[68:71], v[8:11], 0
    v_mfma_f32_16x16x32_bf16 v[104:107], v[72:75], v[32:35], v[104:107]
    v_mfma_f32_16x16x32_bf16 v[116:119], v[72:75], v[12:15], v[116:119]
    v_mfma_f32_16x16x32_bf16 v[104:107], v[76:79], v[36:39], v[104:107]
    v_mfma_f32_16x16x32_bf16 v[116:119], v[76:79], v[16:19], v[116:119]
    v_mfma_f32_16x16x32_bf16 v[104:107], v[80:83], v[40:43], v[104:107]
    v_mfma_f32_16x16x32_bf16 v[116:119], v[80:83], v[20:23], v[116:119]
    v_mfma_f32_16x16x32_bf16 v[104:107], v[84:87], v[44:47], v[104:107]
    v_mfma_f32_16x16x32_bf16 v[116:119], v[84:87], v[24:27], v[116:119]
    ds_read_b128 v[68:71], v4 offset:35840
    ds_read_b128 v[72:75], v4 offset:36864
    ds_read_b128 v[76:79], v4 offset:37888
    ds_read_b128 v[80:83], v4 offset:38912
    ds_read_b128 v[84:87], v4 offset:39936
    s_waitcnt lgkmcnt(5)
    v_mfma_f32_16x16x32_bf16 v[108:111], v[48:51], v[8:11], 0
    v_mfma_f32_16x16x32_bf16 v[116:119], v[48:51], v[28:31], v[116:119]
    v_mfma_f32_16x16x32_bf16 v[108:111], v[52:55], v[12:15], v[108:111]
    v_mfma_f32_16x16x32_bf16 v[116:119], v[52:55], v[32:35], v[116:119]
    v_mfma_f32_16x16x32_bf16 v[108:111], v[56:59], v[16:19], v[108:111]
    v_mfma_f32_16x16x32_bf16 v[116:119], v[56:59], v[36:39], v[116:119]
    v_mfma_f32_16x16x32_bf16 v[108:111], v[60:63], v[20:23], v[108:111]
    v_mfma_f32_16x16x32_bf16 v[116:119], v[60:63], v[40:43], v[116:119]
    v_mfma_f32_16x16x32_bf16 v[108:111], v[64:67], v[24:27], v[108:111]
    v_mfma_f32_16x16x32_bf16 v[116:119], v[64:67], v[44:47], v[116:119]
    s_waitcnt lgkmcnt(0)
    v_mfma_f32_16x16x32_bf16 v[108:111], v[68:71], v[28:31], v[108:111]
    v_mfma_f32_16x16x32_bf16 v[112:115], v[68:71], v[8:11], v[112:115]
    v_mfma_f32_16x16x32_bf16 v[108:111], v[72:75], v[32:35], v[108:111]
    v_mfma_f32_16x16x32_bf16 v[112:115], v[72:75], v[12:15], v[112:115]
    v_mfma_f32_16x16x32_bf16 v[108:111], v[76:79], v[36:39], v[108:111]
    v_mfma_f32_16x16x32_bf16 v[112:115], v[76:79], v[16:19], v[112:115]
    v_mfma_f32_16x16x32_bf16 v[108:111], v[80:83], v[40:43], v[108:111]
    v_mfma_f32_16x16x32_bf16 v[112:115], v[80:83], v[20:23], v[112:115]
    v_mfma_f32_16x16x32_bf16 v[108:111], v[84:87], v[44:47], v[108:111]
    v_mfma_f32_16x16x32_bf16 v[112:115], v[84:87], v[24:27], v[112:115]
    s_nop 7
    v_sub_f32 v88, v88, v92
    v_sub_f32 v89, v89, v93
    v_sub_f32 v90, v90, v94
    v_sub_f32 v91, v91, v95
    v_sub_f32 v96, v96, v100
    v_sub_f32 v97, v97, v101
    v_sub_f32 v98, v98, v102
    v_sub_f32 v99, v99, v103
    v_sub_f32 v104, v104, v108
    v_sub_f32 v105, v105, v109
    v_sub_f32 v106, v106, v110
    v_sub_f32 v107, v107, v111
    v_sub_f32 v112, v112, v116
    v_sub_f32 v113, v113, v117
    v_sub_f32 v114, v114, v118
    v_sub_f32 v115, v115, v119
    s_branch L_k3_kernel_22
L_k3_kernel_20:
    ds_read_b128 v[48:51], v4 offset:0
    ds_read_b128 v[52:55], v4 offset:1024
    ds_read_b128 v[56:59], v4 offset:2048
    ds_read_b128 v[60:63], v4 offset:3072
    ds_read_b128 v[64:67], v4 offset:4096
    ds_read_b128 v[68:71], v4 offset:5120
    ds_read_b128 v[72:75], v4 offset:6144
    ds_read_b128 v[76:79], v4 offset:7168
    ds_read_b128 v[80:83], v4 offset:8192
    ds_read_b128 v[84:87], v4 offset:9216
    s_waitcnt lgkmcnt(5)
    v_mfma_f32_16x16x32_bf16 v[88:91], v[48:51], v[8:11], 0
    v_mfma_f32_16x16x32_bf16 v[96:99], v[48:51], v[28:31], 0
    v_mfma_f32_16x16x32_bf16 v[88:91], v[52:55], v[12:15], v[88:91]
    v_mfma_f32_16x16x32_bf16 v[96:99], v[52:55], v[32:35], v[96:99]
    v_mfma_f32_16x16x32_bf16 v[88:91], v[56:59], v[16:19], v[88:91]
    v_mfma_f32_16x16x32_bf16 v[96:99], v[56:59], v[36:39], v[96:99]
    v_mfma_f32_16x16x32_bf16 v[88:91], v[60:63], v[20:23], v[88:91]
    v_mfma_f32_16x16x32_bf16 v[96:99], v[60:63], v[40:43], v[96:99]
    v_mfma_f32_16x16x32_bf16 v[88:91], v[64:67], v[24:27], v[88:91]
    v_mfma_f32_16x16x32_bf16 v[96:99], v[64:67], v[44:47], v[96:99]
    ds_read_b128 v[48:51], v4 offset:10240
    ds_read_b128 v[52:55], v4 offset:11264
    ds_read_b128 v[56:59], v4 offset:12288
    ds_read_b128 v[60:63], v4 offset:13312
    ds_read_b128 v[64:67], v4 offset:14336
    s_waitcnt lgkmcnt(5)
    v_mfma_f32_16x16x32_bf16 v[92:95], v[68:71], v[8:11], 0
    v_mfma_f32_16x16x32_bf16 v[100:103], v[68:71], v[28:31], 0
    v_mfma_f32_16x16x32_bf16 v[92:95], v[72:75], v[12:15], v[92:95]
    v_mfma_f32_16x16x32_bf16 v[100:103], v[72:75], v[32:35], v[100:103]
    v_mfma_f32_16x16x32_bf16 v[92:95], v[76:79], v[16:19], v[92:95]
    v_mfma_f32_16x16x32_bf16 v[100:103], v[76:79], v[36:39], v[100:103]
    v_mfma_f32_16x16x32_bf16 v[92:95], v[80:83], v[20:23], v[92:95]
    v_mfma_f32_16x16x32_bf16 v[100:103], v[80:83], v[40:43], v[100:103]
    v_mfma_f32_16x16x32_bf16 v[92:95], v[84:87], v[24:27], v[92:95]
    v_mfma_f32_16x16x32_bf16 v[100:103], v[84:87], v[44:47], v[100:103]
    ds_read_b128 v[68:71], v4 offset:15360
    ds_read_b128 v[72:75], v4 offset:16384
    ds_read_b128 v[76:79], v4 offset:17408
    ds_read_b128 v[80:83], v4 offset:18432
    ds_read_b128 v[84:87], v4 offset:19456
    s_waitcnt lgkmcnt(5)
    v_mfma_f32_16x16x32_bf16 v[88:91], v[48:51], v[8:11], v[88:91]
    v_mfma_f32_16x16x32_bf16 v[96:99], v[48:51], v[28:31], v[96:99]
    v_mfma_f32_16x16x32_bf16 v[88:91], v[52:55], v[12:15], v[88:91]
    v_mfma_f32_16x16x32_bf16 v[96:99], v[52:55], v[32:35], v[96:99]
    v_mfma_f32_16x16x32_bf16 v[88:91], v[56:59], v[16:19], v[88:91]
    v_mfma_f32_16x16x32_bf16 v[96:99], v[56:59], v[36:39], v[96:99]
    v_mfma_f32_16x16x32_bf16 v[88:91], v[60:63], v[20:23], v[88:91]
    v_mfma_f32_16x16x32_bf16 v[96:99], v[60:63], v[40:43], v[96:99]
    v_mfma_f32_16x16x32_bf16 v[88:91], v[64:67], v[24:27], v[88:91]
    v_mfma_f32_16x16x32_bf16 v[96:99], v[64:67], v[44:47], v[96:99]
    ds_read_b128 v[48:51], v4 offset:20480
    ds_read_b128 v[52:55], v4 offset:21504
    ds_read_b128 v[56:59], v4 offset:22528
    ds_read_b128 v[60:63], v4 offset:23552
    ds_read_b128 v[64:67], v4 offset:24576
    s_waitcnt lgkmcnt(5)
    v_mfma_f32_16x16x32_bf16 v[92:95], v[68:71], v[8:11], v[92:95]
    v_mfma_f32_16x16x32_bf16 v[100:103], v[68:71], v[28:31], v[100:103]
    v_mfma_f32_16x16x32_bf16 v[92:95], v[72:75], v[12:15], v[92:95]
    v_mfma_f32_16x16x32_bf16 v[100:103], v[72:75], v[32:35], v[100:103]
    v_mfma_f32_16x16x32_bf16 v[92:95], v[76:79], v[16:19], v[92:95]
    v_mfma_f32_16x16x32_bf16 v[100:103], v[76:79], v[36:39], v[100:103]
    v_mfma_f32_16x16x32_bf16 v[92:95], v[80:83], v[20:23], v[92:95]
    v_mfma_f32_16x16x32_bf16 v[100:103], v[80:83], v[40:43], v[100:103]
    v_mfma_f32_16x16x32_bf16 v[92:95], v[84:87], v[24:27], v[92:95]
    v_mfma_f32_16x16x32_bf16 v[100:103], v[84:87], v[44:47], v[100:103]
    ds_read_b128 v[68:71], v4 offset:25600
    ds_read_b128 v[72:75], v4 offset:26624
    ds_read_b128 v[76:79], v4 offset:27648
    ds_read_b128 v[80:83], v4 offset:28672
    ds_read_b128 v[84:87], v4 offset:29696
    s_waitcnt lgkmcnt(5)
    v_mfma_f32_16x16x32_bf16 v[104:107], v[48:51], v[8:11], 0
    v_mfma_f32_16x16x32_bf16 v[112:115], v[48:51], v[28:31], 0
    v_mfma_f32_16x16x32_bf16 v[104:107], v[52:55], v[12:15], v[104:107]
    v_mfma_f32_16x16x32_bf16 v[112:115], v[52:55], v[32:35], v[112:115]
    v_mfma_f32_16x16x32_bf16 v[104:107], v[56:59], v[16:19], v[104:107]
    v_mfma_f32_16x16x32_bf16 v[112:115], v[56:59], v[36:39], v[112:115]
    v_mfma_f32_16x16x32_bf16 v[104:107], v[60:63], v[20:23], v[104:107]
    v_mfma_f32_16x16x32_bf16 v[112:115], v[60:63], v[40:43], v[112:115]
    v_mfma_f32_16x16x32_bf16 v[104:107], v[64:67], v[24:27], v[104:107]
    v_mfma_f32_16x16x32_bf16 v[112:115], v[64:67], v[44:47], v[112:115]
    ds_read_b128 v[48:51], v4 offset:30720
    ds_read_b128 v[52:55], v4 offset:31744
    ds_read_b128 v[56:59], v4 offset:32768
    ds_read_b128 v[60:63], v4 offset:33792
    ds_read_b128 v[64:67], v4 offset:34816
    s_waitcnt lgkmcnt(5)
    v_mfma_f32_16x16x32_bf16 v[108:111], v[68:71], v[8:11], 0
    v_mfma_f32_16x16x32_bf16 v[116:119], v[68:71], v[28:31], 0
    v_mfma_f32_16x16x32_bf16 v[108:111], v[72:75], v[12:15], v[108:111]
    v_mfma_f32_16x16x32_bf16 v[116:119], v[72:75], v[32:35], v[116:119]
    v_mfma_f32_16x16x32_bf16 v[108:111], v[76:79], v[16:19], v[108:111]
    v_mfma_f32_16x16x32_bf16 v[116:119], v[76:79], v[36:39], v[116:119]
    v_mfma_f32_16x16x32_bf16 v[108:111], v[80:83], v[20:23], v[108:111]
    v_mfma_f32_16x16x32_bf16 v[116:119], v[80:83], v[40:43], v[116:119]
    v_mfma_f32_16x16x32_bf16 v[108:111], v[84:87], v[24:27], v[108:111]
    v_mfma_f32_16x16x32_bf16 v[116:119], v[84:87], v[44:47], v[116:119]
    ds_read_b128 v[68:71], v4 offset:35840
    ds_read_b128 v[72:75], v4 offset:36864
    ds_read_b128 v[76:79], v4 offset:37888
    ds_read_b128 v[80:83], v4 offset:38912
    ds_read_b128 v[84:87], v4 offset:39936
    s_waitcnt lgkmcnt(5)
    v_mfma_f32_16x16x32_bf16 v[104:107], v[48:51], v[8:11], v[104:107]
    v_mfma_f32_16x16x32_bf16 v[112:115], v[48:51], v[28:31], v[112:115]
    v_mfma_f32_16x16x32_bf16 v[104:107], v[52:55], v[12:15], v[104:107]
    v_mfma_f32_16x16x32_bf16 v[112:115], v[52:55], v[32:35], v[112:115]
    v_mfma_f32_16x16x32_bf16 v[104:107], v[56:59], v[16:19], v[104:107]
    v_mfma_f32_16x16x32_bf16 v[112:115], v[56:59], v[36:39], v[112:115]
    v_mfma_f32_16x16x32_bf16 v[104:107], v[60:63], v[20:23], v[104:107]
    v_mfma_f32_16x16x32_bf16 v[112:115], v[60:63], v[40:43], v[112:115]
    v_mfma_f32_16x16x32_bf16 v[104:107], v[64:67], v[24:27], v[104:107]
    v_mfma_f32_16x16x32_bf16 v[112:115], v[64:67], v[44:47], v[112:115]
    s_waitcnt lgkmcnt(0)
    v_mfma_f32_16x16x32_bf16 v[108:111], v[68:71], v[8:11], v[108:111]
    v_mfma_f32_16x16x32_bf16 v[116:119], v[68:71], v[28:31], v[116:119]
    v_mfma_f32_16x16x32_bf16 v[108:111], v[72:75], v[12:15], v[108:111]
    v_mfma_f32_16x16x32_bf16 v[116:119], v[72:75], v[32:35], v[116:119]
    v_mfma_f32_16x16x32_bf16 v[108:111], v[76:79], v[16:19], v[108:111]
    v_mfma_f32_16x16x32_bf16 v[116:119], v[76:79], v[36:39], v[116:119]
    v_mfma_f32_16x16x32_bf16 v[108:111], v[80:83], v[20:23], v[108:111]
    v_mfma_f32_16x16x32_bf16 v[116:119], v[80:83], v[40:43], v[116:119]
    v_mfma_f32_16x16x32_bf16 v[108:111], v[84:87], v[24:27], v[108:111]
    v_mfma_f32_16x16x32_bf16 v[116:119], v[84:87], v[44:47], v[116:119]
    s_nop 7
    v_sub_f32 v88, v88, v92
    v_sub_f32 v89, v89, v93
    v_sub_f32 v90, v90, v94
    v_sub_f32 v91, v91, v95
    v_sub_f32 v96, v96, v100
    v_sub_f32 v97, v97, v101
    v_sub_f32 v98, v98, v102
    v_sub_f32 v99, v99, v103
    v_sub_f32 v104, v104, v108
    v_sub_f32 v105, v105, v109
    v_sub_f32 v106, v106, v110
    v_sub_f32 v107, v107, v111
    v_sub_f32 v112, v112, v116
    v_sub_f32 v113, v113, v117
    v_sub_f32 v114, v114, v118
    v_sub_f32 v115, v115, v119
    s_branch L_k3_kernel_22
L_k3_kernel_21:
    ds_read_b128 v[48:51], v4 offset:0
    ds_read_b128 v[52:55], v4 offset:1024
    ds_read_b128 v[56:59], v4 offset:2048
    ds_read_b128 v[60:63], v4 offset:3072
    ds_read_b128 v[64:67], v4 offset:4096
    ds_read_b128 v[68:71], v4 offset:5120
    ds_read_b128 v[72:75], v4 offset:6144
    ds_read_b128 v[76:79], v4 offset:7168
    ds_read_b128 v[80:83], v4 offset:8192
    ds_read_b128 v[84:87], v4 offset:9216
    s_waitcnt lgkmcnt(5)
    v_mfma_f32_16x16x32_bf16 v[88:91], v[48:51], v[8:11], 0
    v_mfma_f32_16x16x32_bf16 v[96:99], v[48:51], v[28:31], 0
    v_mfma_f32_16x16x32_bf16 v[88:91], v[52:55], v[12:15], v[88:91]
    v_mfma_f32_16x16x32_bf16 v[96:99], v[52:55], v[32:35], v[96:99]
    v_mfma_f32_16x16x32_bf16 v[88:91], v[56:59], v[16:19], v[88:91]
    v_mfma_f32_16x16x32_bf16 v[96:99], v[56:59], v[36:39], v[96:99]
    v_mfma_f32_16x16x32_bf16 v[88:91], v[60:63], v[20:23], v[88:91]
    v_mfma_f32_16x16x32_bf16 v[96:99], v[60:63], v[40:43], v[96:99]
    v_mfma_f32_16x16x32_bf16 v[88:91], v[64:67], v[24:27], v[88:91]
    v_mfma_f32_16x16x32_bf16 v[96:99], v[64:67], v[44:47], v[96:99]
    ds_read_b128 v[48:51], v4 offset:10240
    ds_read_b128 v[52:55], v4 offset:11264
    ds_read_b128 v[56:59], v4 offset:12288
    ds_read_b128 v[60:63], v4 offset:13312
    ds_read_b128 v[64:67], v4 offset:14336
    s_waitcnt lgkmcnt(5)
    v_mfma_f32_16x16x32_bf16 v[92:95], v[68:71], v[28:31], 0
    v_mfma_f32_16x16x32_bf16 v[96:99], v[68:71], v[8:11], v[96:99]
    v_mfma_f32_16x16x32_bf16 v[92:95], v[72:75], v[32:35], v[92:95]
    v_mfma_f32_16x16x32_bf16 v[96:99], v[72:75], v[12:15], v[96:99]
    v_mfma_f32_16x16x32_bf16 v[92:95], v[76:79], v[36:39], v[92:95]
    v_mfma_f32_16x16x32_bf16 v[96:99], v[76:79], v[16:19], v[96:99]
    v_mfma_f32_16x16x32_bf16 v[92:95], v[80:83], v[40:43], v[92:95]
    v_mfma_f32_16x16x32_bf16 v[96:99], v[80:83], v[20:23], v[96:99]
    v_mfma_f32_16x16x32_bf16 v[92:95], v[84:87], v[44:47], v[92:95]
    v_mfma_f32_16x16x32_bf16 v[96:99], v[84:87], v[24:27], v[96:99]
    ds_read_b128 v[68:71], v4 offset:15360
    ds_read_b128 v[72:75], v4 offset:16384
    ds_read_b128 v[76:79], v4 offset:17408
    ds_read_b128 v[80:83], v4 offset:18432
    ds_read_b128 v[84:87], v4 offset:19456
    s_waitcnt lgkmcnt(5)
    v_mfma_f32_16x16x32_bf16 v[92:95], v[48:51], v[8:11], v[92:95]
    v_mfma_f32_16x16x32_bf16 v[100:103], v[48:51], v[28:31], 0
    v_mfma_f32_16x16x32_bf16 v[92:95], v[52:55], v[12:15], v[92:95]
    v_mfma_f32_16x16x32_bf16 v[100:103], v[52:55], v[32:35], v[100:103]
    v_mfma_f32_16x16x32_bf16 v[92:95], v[56:59], v[16:19], v[92:95]
    v_mfma_f32_16x16x32_bf16 v[100:103], v[56:59], v[36:39], v[100:103]
    v_mfma_f32_16x16x32_bf16 v[92:95], v[60:63], v[20:23], v[92:95]
    v_mfma_f32_16x16x32_bf16 v[100:103], v[60:63], v[40:43], v[100:103]
    v_mfma_f32_16x16x32_bf16 v[92:95], v[64:67], v[24:27], v[92:95]
    v_mfma_f32_16x16x32_bf16 v[100:103], v[64:67], v[44:47], v[100:103]
    ds_read_b128 v[48:51], v4 offset:20480
    ds_read_b128 v[52:55], v4 offset:21504
    ds_read_b128 v[56:59], v4 offset:22528
    ds_read_b128 v[60:63], v4 offset:23552
    ds_read_b128 v[64:67], v4 offset:24576
    s_waitcnt lgkmcnt(5)
    v_mfma_f32_16x16x32_bf16 v[88:91], v[68:71], v[28:31], v[88:91]
    v_mfma_f32_16x16x32_bf16 v[100:103], v[68:71], v[8:11], v[100:103]
    v_mfma_f32_16x16x32_bf16 v[88:91], v[72:75], v[32:35], v[88:91]
    v_mfma_f32_16x16x32_bf16 v[100:103], v[72:75], v[12:15], v[100:103]
    v_mfma_f32_16x16x32_bf16 v[88:91], v[76:79], v[36:39], v[88:91]
    v_mfma_f32_16x16x32_bf16 v[100:103], v[76:79], v[16:19], v[100:103]
    v_mfma_f32_16x16x32_bf16 v[88:91], v[80:83], v[40:43], v[88:91]
    v_mfma_f32_16x16x32_bf16 v[100:103], v[80:83], v[20:23], v[100:103]
    v_mfma_f32_16x16x32_bf16 v[88:91], v[84:87], v[44:47], v[88:91]
    v_mfma_f32_16x16x32_bf16 v[100:103], v[84:87], v[24:27], v[100:103]
    ds_read_b128 v[68:71], v4 offset:25600
    ds_read_b128 v[72:75], v4 offset:26624
    ds_read_b128 v[76:79], v4 offset:27648
    ds_read_b128 v[80:83], v4 offset:28672
    ds_read_b128 v[84:87], v4 offset:29696
    s_waitcnt lgkmcnt(5)
    v_mfma_f32_16x16x32_bf16 v[104:107], v[48:51], v[8:11], 0
    v_mfma_f32_16x16x32_bf16 v[112:115], v[48:51], v[28:31], 0
    v_mfma_f32_16x16x32_bf16 v[104:107], v[52:55], v[12:15], v[104:107]
    v_mfma_f32_16x16x32_bf16 v[112:115], v[52:55], v[32:35], v[112:115]
    v_mfma_f32_16x16x32_bf16 v[104:107], v[56:59], v[16:19], v[104:107]
    v_mfma_f32_16x16x32_bf16 v[112:115], v[56:59], v[36:39], v[112:115]
    v_mfma_f32_16x16x32_bf16 v[104:107], v[60:63], v[20:23], v[104:107]
    v_mfma_f32_16x16x32_bf16 v[112:115], v[60:63], v[40:43], v[112:115]
    v_mfma_f32_16x16x32_bf16 v[104:107], v[64:67], v[24:27], v[104:107]
    v_mfma_f32_16x16x32_bf16 v[112:115], v[64:67], v[44:47], v[112:115]
    ds_read_b128 v[48:51], v4 offset:30720
    ds_read_b128 v[52:55], v4 offset:31744
    ds_read_b128 v[56:59], v4 offset:32768
    ds_read_b128 v[60:63], v4 offset:33792
    ds_read_b128 v[64:67], v4 offset:34816
    s_waitcnt lgkmcnt(5)
    v_mfma_f32_16x16x32_bf16 v[108:111], v[68:71], v[28:31], 0
    v_mfma_f32_16x16x32_bf16 v[112:115], v[68:71], v[8:11], v[112:115]
    v_mfma_f32_16x16x32_bf16 v[108:111], v[72:75], v[32:35], v[108:111]
    v_mfma_f32_16x16x32_bf16 v[112:115], v[72:75], v[12:15], v[112:115]
    v_mfma_f32_16x16x32_bf16 v[108:111], v[76:79], v[36:39], v[108:111]
    v_mfma_f32_16x16x32_bf16 v[112:115], v[76:79], v[16:19], v[112:115]
    v_mfma_f32_16x16x32_bf16 v[108:111], v[80:83], v[40:43], v[108:111]
    v_mfma_f32_16x16x32_bf16 v[112:115], v[80:83], v[20:23], v[112:115]
    v_mfma_f32_16x16x32_bf16 v[108:111], v[84:87], v[44:47], v[108:111]
    v_mfma_f32_16x16x32_bf16 v[112:115], v[84:87], v[24:27], v[112:115]
    ds_read_b128 v[68:71], v4 offset:35840
    ds_read_b128 v[72:75], v4 offset:36864
    ds_read_b128 v[76:79], v4 offset:37888
    ds_read_b128 v[80:83], v4 offset:38912
    ds_read_b128 v[84:87], v4 offset:39936
    s_waitcnt lgkmcnt(5)
    v_mfma_f32_16x16x32_bf16 v[108:111], v[48:51], v[8:11], v[108:111]
    v_mfma_f32_16x16x32_bf16 v[116:119], v[48:51], v[28:31], 0
    v_mfma_f32_16x16x32_bf16 v[108:111], v[52:55], v[12:15], v[108:111]
    v_mfma_f32_16x16x32_bf16 v[116:119], v[52:55], v[32:35], v[116:119]
    v_mfma_f32_16x16x32_bf16 v[108:111], v[56:59], v[16:19], v[108:111]
    v_mfma_f32_16x16x32_bf16 v[116:119], v[56:59], v[36:39], v[116:119]
    v_mfma_f32_16x16x32_bf16 v[108:111], v[60:63], v[20:23], v[108:111]
    v_mfma_f32_16x16x32_bf16 v[116:119], v[60:63], v[40:43], v[116:119]
    v_mfma_f32_16x16x32_bf16 v[108:111], v[64:67], v[24:27], v[108:111]
    v_mfma_f32_16x16x32_bf16 v[116:119], v[64:67], v[44:47], v[116:119]
    s_waitcnt lgkmcnt(0)
    v_mfma_f32_16x16x32_bf16 v[104:107], v[68:71], v[28:31], v[104:107]
    v_mfma_f32_16x16x32_bf16 v[116:119], v[68:71], v[8:11], v[116:119]
    v_mfma_f32_16x16x32_bf16 v[104:107], v[72:75], v[32:35], v[104:107]
    v_mfma_f32_16x16x32_bf16 v[116:119], v[72:75], v[12:15], v[116:119]
    v_mfma_f32_16x16x32_bf16 v[104:107], v[76:79], v[36:39], v[104:107]
    v_mfma_f32_16x16x32_bf16 v[116:119], v[76:79], v[16:19], v[116:119]
    v_mfma_f32_16x16x32_bf16 v[104:107], v[80:83], v[40:43], v[104:107]
    v_mfma_f32_16x16x32_bf16 v[116:119], v[80:83], v[20:23], v[116:119]
    v_mfma_f32_16x16x32_bf16 v[104:107], v[84:87], v[44:47], v[104:107]
    v_mfma_f32_16x16x32_bf16 v[116:119], v[84:87], v[24:27], v[116:119]
    s_nop 7
    v_sub_f32 v88, v88, v92
    v_sub_f32 v89, v89, v93
    v_sub_f32 v90, v90, v94
    v_sub_f32 v91, v91, v95
    v_sub_f32 v96, v96, v100
    v_sub_f32 v97, v97, v101
    v_sub_f32 v98, v98, v102
    v_sub_f32 v99, v99, v103
    v_sub_f32 v104, v104, v108
    v_sub_f32 v105, v105, v109
    v_sub_f32 v106, v106, v110
    v_sub_f32 v107, v107, v111
    v_sub_f32 v112, v112, v116
    v_sub_f32 v113, v113, v117
    v_sub_f32 v114, v114, v118
    v_sub_f32 v115, v115, v119
L_k3_kernel_22:
    s_mov_b32 s40, 0x3d64f92e
    v_mul_f32 v88, s40, v88
    v_mul_f32 v89, s40, v89
    v_mul_f32 v90, s40, v90
    v_mul_f32 v91, s40, v91
    v_cvt_pk_bf16_f32 v88, v88, v89
    v_cvt_pk_bf16_f32 v89, v90, v91
    buffer_store_dwordx2 v[88:89], v5, s[4:7], s34 offen
    v_mul_f32 v96, s40, v96
    v_mul_f32 v97, s40, v97
    v_mul_f32 v98, s40, v98
    v_mul_f32 v99, s40, v99
    v_cvt_pk_bf16_f32 v96, v96, v97
    v_cvt_pk_bf16_f32 v97, v98, v99
    buffer_store_dwordx2 v[96:97], v6, s[4:7], s34 offen
    v_mul_f32 v104, s40, v104
    v_mul_f32 v105, s40, v105
    v_mul_f32 v106, s40, v106
    v_mul_f32 v107, s40, v107
    v_cvt_pk_bf16_f32 v104, v104, v105
    v_cvt_pk_bf16_f32 v105, v106, v107
    buffer_store_dwordx2 v[104:105], v5, s[4:7], s35 offen
    v_mul_f32 v112, s40, v112
    v_mul_f32 v113, s40, v113
    v_mul_f32 v114, s40, v114
    v_mul_f32 v115, s40, v115
    v_cvt_pk_bf16_f32 v112, v112, v113
    v_cvt_pk_bf16_f32 v113, v114, v115
    buffer_store_dwordx2 v[112:113], v6, s[4:7], s35 offen
    s_endpgm

.globl k4_kernel
.p2align 8
.type k4_kernel,@function
k4_kernel:
    s_cmp_lt_u32 s2, 256
    s_cbranch_scc1 L_k4_kernel_1
    s_endpgm
L_k4_kernel_1:
    s_load_dwordx16 s[8:23], s[0:1], 0
    s_load_dwordx2 s[24:25], s[0:1], 64
    v_lshrrev_b32 v1, 6, v0
    v_and_b32 v0, 63, v0
    s_nop 0
    v_readfirstlane_b32 s3, v1
    s_waitcnt lgkmcnt(0)
    s_mov_b32 s4, s24
    s_and_b32 s5, s25, 0xffff
    s_mov_b32 s6, 30408704
    s_mov_b32 s7, 0x00020000
    s_load_dword s46, s[24:25], 20576
    s_and_b32 s27, s2, 7
    s_lshl_b32 s27, s27, 2
    s_bfe_u32 s28, s2, 0x20003
    s_or_b32 s27, s27, s28
    s_lshr_b32 s28, s2, 5
    s_lshl_b32 s28, s28, 3
    s_add_u32 s28, s28, s3
    v_lshlrev_b32 v6, 4, v0
    s_mul_i32 s31, s27, 163840
    s_lshl_b32 s32, s3, 10
    s_add_u32 s31, s31, s32
    s_add_u32 s31, s31, 16777216
    s_mov_b32 m0, s32
    s_lshl_b32 s29, s27, 6
    s_add_u32 s29, s29, s28
    s_mul_i32 s29, s29, 1280
    s_add_u32 s29, s29, 12582912
    buffer_load_dwordx4 v6, s[4:7], s31 offen lds
    v_and_b32 v1, 31, v0
    v_lshrrev_b32 v2, 5, v0
    v_lshlrev_b32 v7, 3, v0
    v_cmp_gt_u32 vcc, 32, v0
    v_mov_b32 v16, 2147483632
    buffer_load_dwordx4 v[8:11], v6, s[4:7], s29 offen
    v_cndmask_b32 v7, v16, v7, vcc
    buffer_load_dwordx2 v[12:13], v7, s[4:7], s29 offen offset:1024
    s_add_u32 m0, m0, 8192
    s_add_u32 s31, s31, 8192
    buffer_load_dwordx4 v6, s[4:7], s31 offen lds
    s_add_u32 m0, m0, 8192
    s_add_u32 s31, s31, 8192
    buffer_load_dwordx4 v6, s[4:7], s31 offen lds
    s_add_u32 m0, m0, 8192
    s_add_u32 s31, s31, 8192
    buffer_load_dwordx4 v6, s[4:7], s31 offen lds
    v_cmp_gt_u32 s[40:41], 20, v1
    s_mov_b32 s35, 3
    s_mov_b32 s36, 0
    v_mov_b32 v138, 2147483632
    v_mov_b32 v139, 2147483632
    s_mov_b64 s[44:45], 0
    s_mov_b32 s47, 0
    s_mov_b64 s[48:49], 0
    s_mov_b32 s50, 0
    s_mov_b32 s54, 0
    v_mov_b32 v16, 0
    v_mov_b32 v17, 0
    v_mov_b32 v18, 0
    v_mov_b32 v19, 0
    v_mov_b32 v20, 0
    v_mov_b32 v21, 0
    v_mov_b32 v22, 0
    v_mov_b32 v23, 0
    v_mov_b32 v24, 0
    v_mov_b32 v25, 0
    v_mov_b32 v26, 0
    v_mov_b32 v27, 0
    v_mov_b32 v28, 0
    v_mov_b32 v29, 0
    v_mov_b32 v30, 0
    v_mov_b32 v31, 0
    v_and_b32 v64, 27, v0
    v_cmp_eq_u32 vcc, 24, v64
    v_mov_b32 v64, 0x3f803f80
    s_nop 0
    v_cndmask_b32 v104, 0, v64, vcc
    v_mov_b32 v105, v104
    v_mov_b32 v106, v104
    v_mov_b32 v107, v104
    v_mov_b32 v108, v104
    v_mov_b32 v109, v104
    v_mov_b32 v110, v104
    v_mov_b32 v111, v104
    v_mov_b32 v112, v104
    v_mov_b32 v113, v104
    v_mov_b32 v114, v104
    v_mov_b32 v115, v104
    v_mov_b32 v116, v104
    v_mov_b32 v117, v104
    v_mov_b32 v118, v104
    v_mov_b32 v119, v104
    s_waitcnt vmcnt(1) lgkmcnt(0)
    s_barrier
L_k4_kernel_2:
    v_mov_b32 v3, v6
    v_lshlrev_b32 v4, 3, v1
    v_mul_u32_u24 v5, 320, v2
    v_lshl_add_u32 v5, v1, 4, v5
    s_mov_b32 s34, 0
    ds_read_b128 v[88:91], v3 offset:0
    ds_read_b64 v[92:93], v4 offset:1024
    ds_read_b128 v[96:99], v3 offset:2560
    ds_read_b64 v[100:101], v4 offset:3584
    s_mov_b64 exec, s[40:41]
    ds_read_b128 v[104:107], v5 offset:1280
    ds_read_b128 v[108:111], v5 offset:1920
    s_mov_b64 exec, -1
    v_mov_b32 v72, 0
    v_mov_b32 v73, 0
    v_mov_b32 v74, 0
    v_mov_b32 v75, 0
    v_mov_b32 v76, 0
    v_mov_b32 v77, 0
    v_mov_b32 v78, 0
    v_mov_b32 v79, 0
    v_mov_b32 v80, 0
    v_mov_b32 v81, 0
    v_mov_b32 v82, 0
    v_mov_b32 v83, 0
    v_mov_b32 v84, 0
    v_mov_b32 v85, 0
    v_mov_b32 v86, 0
    v_mov_b32 v87, 0
    v_mov_b32 v68, 0
    v_mov_b32 v69, 0
    v_mov_b32 v70, 0
    v_mov_b32 v71, 0
    s_waitcnt lgkmcnt(4)
    v_mfma_f32_32x32x16_bf16 v[32:47], v[88:91], v[8:11], v[16:31]
    v_mfma_f32_32x32x8_bf16 v[32:47], v[92:93], v[12:13], v[32:47]
    s_nop 7
    s_nop 3
    s_cmp_lg_u32 s36, 0
    s_cbranch_scc1 L_k4_kernel_4
L_k4_kernel_3:
    s_setprio 3
    s_waitcnt lgkmcnt(2)
    v_mfma_f32_32x32x16_bf16 v[48:63], v[96:99], v[8:11], v[16:31]
    ds_read_b128 v[88:91], v3 offset:5120
    ds_read_b64 v[92:93], v4 offset:6144
    v_exp_f32 v32, v32
    v_exp_f32 v33, v33
    v_exp_f32 v34, v34
    v_exp_f32 v35, v35
    v_cvt_pk_bf16_f32 v64, v32, v33
    v_mfma_f32_32x32x16_bf16 v[72:87], v[116:119], v[68:71], v[72:87]
    s_mov_b64 exec, s[40:41]
    ds_read_b128 v[112:115], v5 offset:3840
    ds_read_b128 v[116:119], v5 offset:4480
    s_mov_b64 exec, -1
    v_cvt_pk_bf16_f32 v65, v34, v35
    v_exp_f32 v36, v36
    v_exp_f32 v37, v37
    v_exp_f32 v38, v38
    v_exp_f32 v39, v39
    v_cvt_pk_bf16_f32 v66, v36, v37
    v_mfma_f32_32x32x8_bf16 v[48:63], v[100:101], v[12:13], v[48:63]
    v_cvt_pk_bf16_f32 v67, v38, v39
    v_exp_f32 v40, v40
    v_exp_f32 v41, v41
    v_exp_f32 v42, v42
    v_exp_f32 v43, v43
    v_cvt_pk_bf16_f32 v68, v40, v41
    s_waitcnt lgkmcnt(4)
    v_mfma_f32_32x32x16_bf16 v[72:87], v[104:107], v[64:67], v[72:87]
    s_add_u32 m0, m0, 8192
    s_add_u32 s31, s31, 8192
    buffer_load_dwordx4 v6, s[4:7], s31 offen lds
    v_cvt_pk_bf16_f32 v69, v42, v43
    v_exp_f32 v44, v44
    v_exp_f32 v45, v45
    v_exp_f32 v46, v46
    v_exp_f32 v47, v47
    v_cvt_pk_bf16_f32 v70, v44, v45
    v_cvt_pk_bf16_f32 v71, v46, v47
    s_waitcnt lgkmcnt(2)
    v_mfma_f32_32x32x16_bf16 v[32:47], v[88:91], v[8:11], v[16:31]
    ds_read_b128 v[96:99], v3 offset:7680
    ds_read_b64 v[100:101], v4 offset:8704
    v_exp_f32 v48, v48
    v_exp_f32 v49, v49
    v_exp_f32 v50, v50
    v_exp_f32 v51, v51
    v_cvt_pk_bf16_f32 v64, v48, v49
    v_mfma_f32_32x32x16_bf16 v[72:87], v[108:111], v[68:71], v[72:87]
    s_mov_b64 exec, s[40:41]
    ds_read_b128 v[104:107], v5 offset:6400
    ds_read_b128 v[108:111], v5 offset:7040
    s_mov_b64 exec, -1
    v_cvt_pk_bf16_f32 v65, v50, v51
    v_exp_f32 v52, v52
    v_exp_f32 v53, v53
    v_exp_f32 v54, v54
    v_exp_f32 v55, v55
    v_cvt_pk_bf16_f32 v66, v52, v53
    v_mfma_f32_32x32x8_bf16 v[32:47], v[92:93], v[12:13], v[32:47]
    v_cvt_pk_bf16_f32 v67, v54, v55
    v_exp_f32 v56, v56
    v_exp_f32 v57, v57
    v_exp_f32 v58, v58
    v_exp_f32 v59, v59
    v_cvt_pk_bf16_f32 v68, v56, v57
    s_waitcnt lgkmcnt(4)
    v_mfma_f32_32x32x16_bf16 v[72:87], v[112:115], v[64:67], v[72:87]
    s_add_u32 m0, m0, 8192
    s_add_u32 s31, s31, 8192
    buffer_load_dwordx4 v6, s[4:7], s31 offen lds
    v_cvt_pk_bf16_f32 v69, v58, v59
    v_exp_f32 v60, v60
    v_exp_f32 v61, v61
    v_exp_f32 v62, v62
    v_exp_f32 v63, v63
    v_cvt_pk_bf16_f32 v70, v60, v61
    v_cvt_pk_bf16_f32 v71, v62, v63
    s_waitcnt lgkmcnt(2)
    v_mfma_f32_32x32x16_bf16 v[48:63], v[96:99], v[8:11], v[16:31]
    ds_read_b128 v[88:91], v3 offset:10240
    ds_read_b64 v[92:93], v4 offset:11264
    v_exp_f32 v32, v32
    v_exp_f32 v33, v33
    v_exp_f32 v34, v34
    v_exp_f32 v35, v35
    v_cvt_pk_bf16_f32 v64, v32, v33
    v_mfma_f32_32x32x16_bf16 v[72:87], v[116:119], v[68:71], v[72:87]
    s_mov_b64 exec, s[40:41]
    ds_read_b128 v[112:115], v5 offset:8960
    ds_read_b128 v[116:119], v5 offset:9600
    s_mov_b64 exec, -1
    v_cvt_pk_bf16_f32 v65, v34, v35
    v_exp_f32 v36, v36
    v_exp_f32 v37, v37
    v_exp_f32 v38, v38
    v_exp_f32 v39, v39
    v_cvt_pk_bf16_f32 v66, v36, v37
    v_mfma_f32_32x32x8_bf16 v[48:63], v[100:101], v[12:13], v[48:63]
    v_cvt_pk_bf16_f32 v67, v38, v39
    v_exp_f32 v40, v40
    v_exp_f32 v41, v41
    v_exp_f32 v42, v42
    v_exp_f32 v43, v43
    v_cvt_pk_bf16_f32 v68, v40, v41
    s_waitcnt lgkmcnt(4)
    v_mfma_f32_32x32x16_bf16 v[72:87], v[104:107], v[64:67], v[72:87]
    s_add_u32 m0, m0, 8192
    s_add_u32 s31, s31, 8192
    buffer_load_dwordx4 v6, s[4:7], s31 offen lds
    v_cvt_pk_bf16_f32 v69, v42, v43
    v_exp_f32 v44, v44
    v_exp_f32 v45, v45
    v_exp_f32 v46, v46
    v_exp_f32 v47, v47
    v_cvt_pk_bf16_f32 v70, v44, v45
    v_cvt_pk_bf16_f32 v71, v46, v47
    s_waitcnt lgkmcnt(2)
    v_mfma_f32_32x32x16_bf16 v[32:47], v[88:91], v[8:11], v[16:31]
    ds_read_b128 v[96:99], v3 offset:12800
    ds_read_b64 v[100:101], v4 offset:13824
    v_exp_f32 v48, v48
    v_exp_f32 v49, v49
    v_exp_f32 v50, v50
    v_exp_f32 v51, v51
    v_cvt_pk_bf16_f32 v64, v48, v49
    v_mfma_f32_32x32x16_bf16 v[72:87], v[108:111], v[68:71], v[72:87]
    s_mov_b64 exec, s[40:41]
    ds_read_b128 v[104:107], v5 offset:11520
    ds_read_b128 v[108:111], v5 offset:12160
    s_mov_b64 exec, -1
    v_cvt_pk_bf16_f32 v65, v50, v51
    v_exp_f32 v52, v52
    v_exp_f32 v53, v53
    v_exp_f32 v54, v54
    v_exp_f32 v55, v55
    v_cvt_pk_bf16_f32 v66, v52, v53
    v_mfma_f32_32x32x8_bf16 v[32:47], v[92:93], v[12:13], v[32:47]
    v_cvt_pk_bf16_f32 v67, v54, v55
    v_exp_f32 v56, v56
    v_exp_f32 v57, v57
    v_exp_f32 v58, v58
    v_exp_f32 v59, v59
    v_cvt_pk_bf16_f32 v68, v56, v57
    s_waitcnt lgkmcnt(4)
    v_mfma_f32_32x32x16_bf16 v[72:87], v[112:115], v[64:67], v[72:87]
    s_add_u32 m0, m0, 8192
    s_add_u32 s31, s31, 8192
    buffer_load_dwordx4 v6, s[4:7], s31 offen lds
    v_cvt_pk_bf16_f32 v69, v58, v59
    v_exp_f32 v60, v60
    v_exp_f32 v61, v61
    v_exp_f32 v62, v62
    v_exp_f32 v63, v63
    v_cvt_pk_bf16_f32 v70, v60, v61
    v_cvt_pk_bf16_f32 v71, v62, v63
    s_setprio 2
    s_waitcnt lgkmcnt(2)
    v_mfma_f32_32x32x16_bf16 v[48:63], v[96:99], v[8:11], v[16:31]
    ds_read_b128 v[88:91], v3 offset:15360
    ds_read_b64 v[92:93], v4 offset:16384
    v_exp_f32 v32, v32
    v_exp_f32 v33, v33
    v_exp_f32 v34, v34
    v_exp_f32 v35, v35
    v_cvt_pk_bf16_f32 v64, v32, v33
    v_mfma_f32_32x32x16_bf16 v[72:87], v[116:119], v[68:71], v[72:87]
    s_mov_b64 exec, s[40:41]
    ds_read_b128 v[112:115], v5 offset:14080
    ds_read_b128 v[116:119], v5 offset:14720
    s_mov_b64 exec, -1
    v_cvt_pk_bf16_f32 v65, v34, v35
    v_exp_f32 v36, v36
    v_exp_f32 v37, v37
    v_exp_f32 v38, v38
    v_exp_f32 v39, v39
    v_cvt_pk_bf16_f32 v66, v36, v37
    v_mfma_f32_32x32x8_bf16 v[48:63], v[100:101], v[12:13], v[48:63]
    v_cvt_pk_bf16_f32 v67, v38, v39
    v_exp_f32 v40, v40
    v_exp_f32 v41, v41
    v_exp_f32 v42, v42
    v_exp_f32 v43, v43
    v_cvt_pk_bf16_f32 v68, v40, v41
    s_waitcnt lgkmcnt(4)
    v_mfma_f32_32x32x16_bf16 v[72:87], v[104:107], v[64:67], v[72:87]
    s_add_u32 m0, m0, 8192
    s_add_u32 s31, s31, 8192
    buffer_load_dwordx4 v6, s[4:7], s31 offen lds
    v_cvt_pk_bf16_f32 v69, v42, v43
    v_exp_f32 v44, v44
    v_exp_f32 v45, v45
    v_exp_f32 v46, v46
    v_exp_f32 v47, v47
    v_cvt_pk_bf16_f32 v70, v44, v45
    v_cvt_pk_bf16_f32 v71, v46, v47
    s_waitcnt lgkmcnt(2)
    v_mfma_f32_32x32x16_bf16 v[32:47], v[88:91], v[8:11], v[16:31]
    ds_read_b128 v[96:99], v3 offset:17920
    ds_read_b64 v[100:101], v4 offset:18944
    v_exp_f32 v48, v48
    v_exp_f32 v49, v49
    v_exp_f32 v50, v50
    v_exp_f32 v51, v51
    v_cvt_pk_bf16_f32 v64, v48, v49
    v_mfma_f32_32x32x16_bf16 v[72:87], v[108:111], v[68:71], v[72:87]
    s_mov_b64 exec, s[40:41]
    ds_read_b128 v[104:107], v5 offset:16640
    ds_read_b128 v[108:111], v5 offset:17280
    s_mov_b64 exec, -1
    v_cvt_pk_bf16_f32 v65, v50, v51
    v_exp_f32 v52, v52
    v_exp_f32 v53, v53
    v_exp_f32 v54, v54
    v_exp_f32 v55, v55
    v_cvt_pk_bf16_f32 v66, v52, v53
    v_mfma_f32_32x32x8_bf16 v[32:47], v[92:93], v[12:13], v[32:47]
    v_cvt_pk_bf16_f32 v67, v54, v55
    v_exp_f32 v56, v56
    v_exp_f32 v57, v57
    v_exp_f32 v58, v58
    v_exp_f32 v59, v59
    v_cvt_pk_bf16_f32 v68, v56, v57
    s_waitcnt lgkmcnt(4)
    v_mfma_f32_32x32x16_bf16 v[72:87], v[112:115], v[64:67], v[72:87]
    s_add_u32 m0, m0, 8192
    s_add_u32 s31, s31, 8192
    buffer_load_dwordx4 v6, s[4:7], s31 offen lds
    v_cvt_pk_bf16_f32 v69, v58, v59
    v_exp_f32 v60, v60
    v_exp_f32 v61, v61
    v_exp_f32 v62, v62
    v_exp_f32 v63, v63
    v_cvt_pk_bf16_f32 v70, v60, v61
    v_cvt_pk_bf16_f32 v71, v62, v63
    s_waitcnt lgkmcnt(2)
    v_mfma_f32_32x32x16_bf16 v[48:63], v[96:99], v[8:11], v[16:31]
    ds_read_b128 v[88:91], v3 offset:20480
    ds_read_b64 v[92:93], v4 offset:21504
    v_exp_f32 v32, v32
    v_exp_f32 v33, v33
    v_exp_f32 v34, v34
    v_exp_f32 v35, v35
    v_cvt_pk_bf16_f32 v64, v32, v33
    v_mfma_f32_32x32x16_bf16 v[72:87], v[116:119], v[68:71], v[72:87]
    s_mov_b64 exec, s[40:41]
    ds_read_b128 v[112:115], v5 offset:19200
    ds_read_b128 v[116:119], v5 offset:19840
    s_mov_b64 exec, -1
    v_cvt_pk_bf16_f32 v65, v34, v35
    v_exp_f32 v36, v36
    v_exp_f32 v37, v37
    v_exp_f32 v38, v38
    v_exp_f32 v39, v39
    v_cvt_pk_bf16_f32 v66, v36, v37
    s_setprio 1
    v_mfma_f32_32x32x8_bf16 v[48:63], v[100:101], v[12:13], v[48:63]
    v_cvt_pk_bf16_f32 v67, v38, v39
    v_exp_f32 v40, v40
    v_exp_f32 v41, v41
    v_exp_f32 v42, v42
    v_exp_f32 v43, v43
    v_cvt_pk_bf16_f32 v68, v40, v41
    s_waitcnt lgkmcnt(4)
    v_mfma_f32_32x32x16_bf16 v[72:87], v[104:107], v[64:67], v[72:87]
    s_add_u32 m0, m0, 8192
    s_add_u32 s31, s31, 8192
    buffer_load_dwordx4 v6, s[4:7], s31 offen lds
    v_cvt_pk_bf16_f32 v69, v42, v43
    v_exp_f32 v44, v44
    v_exp_f32 v45, v45
    v_exp_f32 v46, v46
    v_exp_f32 v47, v47
    v_cvt_pk_bf16_f32 v70, v44, v45
    v_cvt_pk_bf16_f32 v71, v46, v47
    s_waitcnt lgkmcnt(2)
    v_mfma_f32_32x32x16_bf16 v[32:47], v[88:91], v[8:11], v[16:31]
    ds_read_b128 v[96:99], v3 offset:23040
    ds_read_b64 v[100:101], v4 offset:24064
    v_exp_f32 v48, v48
    v_exp_f32 v49, v49
    v_exp_f32 v50, v50
    v_exp_f32 v51, v51
    v_cvt_pk_bf16_f32 v64, v48, v49
    v_mfma_f32_32x32x16_bf16 v[72:87], v[108:111], v[68:71], v[72:87]
    s_mov_b64 exec, s[40:41]
    ds_read_b128 v[104:107], v5 offset:21760
    ds_read_b128 v[108:111], v5 offset:22400
    s_mov_b64 exec, -1
    v_cvt_pk_bf16_f32 v65, v50, v51
    v_exp_f32 v52, v52
    v_exp_f32 v53, v53
    v_exp_f32 v54, v54
    v_exp_f32 v55, v55
    v_cvt_pk_bf16_f32 v66, v52, v53
    s_setprio 0
    v_mfma_f32_32x32x8_bf16 v[32:47], v[92:93], v[12:13], v[32:47]
    v_cvt_pk_bf16_f32 v67, v54, v55
    v_exp_f32 v56, v56
    v_exp_f32 v57, v57
    v_exp_f32 v58, v58
    v_exp_f32 v59, v59
    v_cvt_pk_bf16_f32 v68, v56, v57
    s_waitcnt lgkmcnt(4)
    v_mfma_f32_32x32x16_bf16 v[72:87], v[112:115], v[64:67], v[72:87]
    s_add_u32 m0, m0, 8192
    s_add_u32 s31, s31, 8192
    buffer_load_dwordx4 v6, s[4:7], s31 offen lds
    v_cvt_pk_bf16_f32 v69, v58, v59
    v_exp_f32 v60, v60
    v_exp_f32 v61, v61
    v_exp_f32 v62, v62
    v_exp_f32 v63, v63
    v_cvt_pk_bf16_f32 v70, v60, v61
    v_cvt_pk_bf16_f32 v71, v62, v63
    v_add_u32 v3, 20480, v3
    v_add_u32 v4, 20480, v4
    v_add_u32 v5, 20480, v5
    s_add_u32 s34, s34, 1
    s_cmp_lg_u32 s34, 1
    s_cbranch_scc1 L_k4_kernel_4
    s_waitcnt vmcnt(2)
    s_barrier
    s_branch L_k4_kernel_3
L_k4_kernel_4:
    s_setprio 3
    s_waitcnt lgkmcnt(2)
    v_mfma_f32_32x32x16_bf16 v[48:63], v[96:99], v[8:11], v[16:31]
    ds_read_b128 v[88:91], v3 offset:5120
    ds_read_b64 v[92:93], v4 offset:6144
    v_exp_f32 v32, v32
    v_exp_f32 v33, v33
    v_exp_f32 v34, v34
    v_exp_f32 v35, v35
    v_cvt_pk_bf16_f32 v64, v32, v33
    v_mfma_f32_32x32x16_bf16 v[72:87], v[116:119], v[68:71], v[72:87]
    s_mov_b64 exec, s[40:41]
    ds_read_b128 v[112:115], v5 offset:3840
    ds_read_b128 v[116:119], v5 offset:4480
    s_mov_b64 exec, -1
    v_cvt_pk_bf16_f32 v65, v34, v35
    v_exp_f32 v36, v36
    v_exp_f32 v37, v37
    v_exp_f32 v38, v38
    v_exp_f32 v39, v39
    v_cvt_pk_bf16_f32 v66, v36, v37
    v_mfma_f32_32x32x8_bf16 v[48:63], v[100:101], v[12:13], v[48:63]
    v_cvt_pk_bf16_f32 v67, v38, v39
    v_exp_f32 v40, v40
    v_exp_f32 v41, v41
    v_exp_f32 v42, v42
    v_exp_f32 v43, v43
    v_cvt_pk_bf16_f32 v68, v40, v41
    s_waitcnt lgkmcnt(4)
    v_mfma_f32_32x32x16_bf16 v[72:87], v[104:107], v[64:67], v[72:87]
    v_cvt_pk_bf16_f32 v69, v42, v43
    v_exp_f32 v44, v44
    v_exp_f32 v45, v45
    v_exp_f32 v46, v46
    v_exp_f32 v47, v47
    v_cvt_pk_bf16_f32 v70, v44, v45
    v_cvt_pk_bf16_f32 v71, v46, v47
    s_waitcnt lgkmcnt(2)
    v_mfma_f32_32x32x16_bf16 v[32:47], v[88:91], v[8:11], v[16:31]
    ds_read_b128 v[96:99], v3 offset:7680
    ds_read_b64 v[100:101], v4 offset:8704
    v_exp_f32 v48, v48
    v_exp_f32 v49, v49
    v_exp_f32 v50, v50
    v_exp_f32 v51, v51
    v_cvt_pk_bf16_f32 v64, v48, v49
    v_mfma_f32_32x32x16_bf16 v[72:87], v[108:111], v[68:71], v[72:87]
    s_mov_b64 exec, s[40:41]
    ds_read_b128 v[104:107], v5 offset:6400
    ds_read_b128 v[108:111], v5 offset:7040
    s_mov_b64 exec, -1
    v_cvt_pk_bf16_f32 v65, v50, v51
    v_exp_f32 v52, v52
    v_exp_f32 v53, v53
    v_exp_f32 v54, v54
    v_exp_f32 v55, v55
    v_cvt_pk_bf16_f32 v66, v52, v53
    v_mfma_f32_32x32x8_bf16 v[32:47], v[92:93], v[12:13], v[32:47]
    v_cvt_pk_bf16_f32 v67, v54, v55
    v_exp_f32 v56, v56
    v_exp_f32 v57, v57
    v_exp_f32 v58, v58
    v_exp_f32 v59, v59
    v_cvt_pk_bf16_f32 v68, v56, v57
    s_waitcnt lgkmcnt(4)
    v_mfma_f32_32x32x16_bf16 v[72:87], v[112:115], v[64:67], v[72:87]
    v_cvt_pk_bf16_f32 v69, v58, v59
    v_exp_f32 v60, v60
    v_exp_f32 v61, v61
    v_exp_f32 v62, v62
    v_exp_f32 v63, v63
    v_cvt_pk_bf16_f32 v70, v60, v61
    v_cvt_pk_bf16_f32 v71, v62, v63
    s_waitcnt lgkmcnt(2)
    v_mfma_f32_32x32x16_bf16 v[48:63], v[96:99], v[8:11], v[16:31]
    ds_read_b128 v[88:91], v3 offset:10240
    ds_read_b64 v[92:93], v4 offset:11264
    v_exp_f32 v32, v32
    v_exp_f32 v33, v33
    v_exp_f32 v34, v34
    v_exp_f32 v35, v35
    v_cvt_pk_bf16_f32 v64, v32, v33
    v_mfma_f32_32x32x16_bf16 v[72:87], v[116:119], v[68:71], v[72:87]
    s_mov_b64 exec, s[40:41]
    ds_read_b128 v[112:115], v5 offset:8960
    ds_read_b128 v[116:119], v5 offset:9600
    s_mov_b64 exec, -1
    v_cvt_pk_bf16_f32 v65, v34, v35
    v_exp_f32 v36, v36
    v_exp_f32 v37, v37
    v_exp_f32 v38, v38
    v_exp_f32 v39, v39
    v_cvt_pk_bf16_f32 v66, v36, v37
    v_mfma_f32_32x32x8_bf16 v[48:63], v[100:101], v[12:13], v[48:63]
    v_cvt_pk_bf16_f32 v67, v38, v39
    v_exp_f32 v40, v40
    v_exp_f32 v41, v41
    v_exp_f32 v42, v42
    v_exp_f32 v43, v43
    v_cvt_pk_bf16_f32 v68, v40, v41
    s_waitcnt lgkmcnt(4)
    v_mfma_f32_32x32x16_bf16 v[72:87], v[104:107], v[64:67], v[72:87]
    v_cvt_pk_bf16_f32 v69, v42, v43
    v_exp_f32 v44, v44
    v_exp_f32 v45, v45
    v_exp_f32 v46, v46
    v_exp_f32 v47, v47
    v_cvt_pk_bf16_f32 v70, v44, v45
    v_cvt_pk_bf16_f32 v71, v46, v47
    s_waitcnt lgkmcnt(2)
    v_mfma_f32_32x32x16_bf16 v[32:47], v[88:91], v[8:11], v[16:31]
    ds_read_b128 v[96:99], v3 offset:12800
    ds_read_b64 v[100:101], v4 offset:13824
    v_exp_f32 v48, v48
    v_exp_f32 v49, v49
    v_exp_f32 v50, v50
    v_exp_f32 v51, v51
    v_cvt_pk_bf16_f32 v64, v48, v49
    v_mfma_f32_32x32x16_bf16 v[72:87], v[108:111], v[68:71], v[72:87]
    s_mov_b64 exec, s[40:41]
    ds_read_b128 v[104:107], v5 offset:11520
    ds_read_b128 v[108:111], v5 offset:12160
    s_mov_b64 exec, -1
    v_cvt_pk_bf16_f32 v65, v50, v51
    v_exp_f32 v52, v52
    v_exp_f32 v53, v53
    v_exp_f32 v54, v54
    v_exp_f32 v55, v55
    v_cvt_pk_bf16_f32 v66, v52, v53
    v_mfma_f32_32x32x8_bf16 v[32:47], v[92:93], v[12:13], v[32:47]
    v_cvt_pk_bf16_f32 v67, v54, v55
    v_exp_f32 v56, v56
    v_exp_f32 v57, v57
    v_exp_f32 v58, v58
    v_exp_f32 v59, v59
    v_cvt_pk_bf16_f32 v68, v56, v57
    s_waitcnt lgkmcnt(4)
    v_mfma_f32_32x32x16_bf16 v[72:87], v[112:115], v[64:67], v[72:87]
    v_cvt_pk_bf16_f32 v69, v58, v59
    v_exp_f32 v60, v60
    v_exp_f32 v61, v61
    v_exp_f32 v62, v62
    v_exp_f32 v63, v63
    v_cvt_pk_bf16_f32 v70, v60, v61
    v_cvt_pk_bf16_f32 v71, v62, v63
    s_setprio 2
    s_waitcnt lgkmcnt(2)
    v_mfma_f32_32x32x16_bf16 v[48:63], v[96:99], v[8:11], v[16:31]
    ds_read_b128 v[88:91], v3 offset:15360
    ds_read_b64 v[92:93], v4 offset:16384
    v_exp_f32 v32, v32
    v_exp_f32 v33, v33
    v_exp_f32 v34, v34
    v_exp_f32 v35, v35
    v_cvt_pk_bf16_f32 v64, v32, v33
    v_mfma_f32_32x32x16_bf16 v[72:87], v[116:119], v[68:71], v[72:87]
    s_mov_b64 exec, s[40:41]
    ds_read_b128 v[112:115], v5 offset:14080
    ds_read_b128 v[116:119], v5 offset:14720
    s_mov_b64 exec, -1
    v_cvt_pk_bf16_f32 v65, v34, v35
    v_exp_f32 v36, v36
    v_exp_f32 v37, v37
    v_exp_f32 v38, v38
    v_exp_f32 v39, v39
    v_cvt_pk_bf16_f32 v66, v36, v37
    v_mfma_f32_32x32x8_bf16 v[48:63], v[100:101], v[12:13], v[48:63]
    v_cvt_pk_bf16_f32 v67, v38, v39
    v_exp_f32 v40, v40
    v_exp_f32 v41, v41
    v_exp_f32 v42, v42
    v_exp_f32 v43, v43
    v_cvt_pk_bf16_f32 v68, v40, v41
    s_waitcnt lgkmcnt(4)
    v_mfma_f32_32x32x16_bf16 v[72:87], v[104:107], v[64:67], v[72:87]
    v_cvt_pk_bf16_f32 v69, v42, v43
    v_exp_f32 v44, v44
    v_exp_f32 v45, v45
    v_exp_f32 v46, v46
    v_exp_f32 v47, v47
    v_cvt_pk_bf16_f32 v70, v44, v45
    v_cvt_pk_bf16_f32 v71, v46, v47
    s_waitcnt lgkmcnt(2)
    v_mfma_f32_32x32x16_bf16 v[32:47], v[88:91], v[8:11], v[16:31]
    ds_read_b128 v[96:99], v3 offset:17920
    ds_read_b64 v[100:101], v4 offset:18944
    v_exp_f32 v48, v48
    v_exp_f32 v49, v49
    v_exp_f32 v50, v50
    v_exp_f32 v51, v51
    v_cvt_pk_bf16_f32 v64, v48, v49
    v_mfma_f32_32x32x16_bf16 v[72:87], v[108:111], v[68:71], v[72:87]
    s_mov_b64 exec, s[40:41]
    ds_read_b128 v[104:107], v5 offset:16640
    ds_read_b128 v[108:111], v5 offset:17280
    s_mov_b64 exec, -1
    v_cvt_pk_bf16_f32 v65, v50, v51
    v_exp_f32 v52, v52
    v_exp_f32 v53, v53
    v_exp_f32 v54, v54
    v_exp_f32 v55, v55
    v_cvt_pk_bf16_f32 v66, v52, v53
    v_mfma_f32_32x32x8_bf16 v[32:47], v[92:93], v[12:13], v[32:47]
    v_cvt_pk_bf16_f32 v67, v54, v55
    v_exp_f32 v56, v56
    v_exp_f32 v57, v57
    v_exp_f32 v58, v58
    v_exp_f32 v59, v59
    v_cvt_pk_bf16_f32 v68, v56, v57
    s_waitcnt lgkmcnt(4)
    v_mfma_f32_32x32x16_bf16 v[72:87], v[112:115], v[64:67], v[72:87]
    v_cvt_pk_bf16_f32 v69, v58, v59
    v_exp_f32 v60, v60
    v_exp_f32 v61, v61
    v_exp_f32 v62, v62
    v_exp_f32 v63, v63
    v_cvt_pk_bf16_f32 v70, v60, v61
    v_cvt_pk_bf16_f32 v71, v62, v63
    s_waitcnt lgkmcnt(2)
    v_mfma_f32_32x32x16_bf16 v[48:63], v[96:99], v[8:11], v[16:31]
    ds_read_b128 v[88:91], v3 offset:20480
    ds_read_b64 v[92:93], v4 offset:21504
    v_exp_f32 v32, v32
    v_exp_f32 v33, v33
    v_exp_f32 v34, v34
    v_exp_f32 v35, v35
    v_cvt_pk_bf16_f32 v64, v32, v33
    v_mfma_f32_32x32x16_bf16 v[72:87], v[116:119], v[68:71], v[72:87]
    s_mov_b64 exec, s[40:41]
    ds_read_b128 v[112:115], v5 offset:19200
    ds_read_b128 v[116:119], v5 offset:19840
    s_mov_b64 exec, -1
    v_cvt_pk_bf16_f32 v65, v34, v35
    v_exp_f32 v36, v36
    v_exp_f32 v37, v37
    v_exp_f32 v38, v38
    v_exp_f32 v39, v39
    v_cvt_pk_bf16_f32 v66, v36, v37
    s_setprio 1
    v_mfma_f32_32x32x8_bf16 v[48:63], v[100:101], v[12:13], v[48:63]
    v_cvt_pk_bf16_f32 v67, v38, v39
    v_exp_f32 v40, v40
    v_exp_f32 v41, v41
    v_exp_f32 v42, v42
    v_exp_f32 v43, v43
    v_cvt_pk_bf16_f32 v68, v40, v41
    s_waitcnt lgkmcnt(4)
    v_mfma_f32_32x32x16_bf16 v[72:87], v[104:107], v[64:67], v[72:87]
    v_cvt_pk_bf16_f32 v69, v42, v43
    v_exp_f32 v44, v44
    v_exp_f32 v45, v45
    v_exp_f32 v46, v46
    v_exp_f32 v47, v47
    v_cvt_pk_bf16_f32 v70, v44, v45
    v_cvt_pk_bf16_f32 v71, v46, v47
    s_waitcnt lgkmcnt(2)
    v_mfma_f32_32x32x16_bf16 v[32:47], v[88:91], v[8:11], v[16:31]
    ds_read_b128 v[96:99], v3 offset:23040
    ds_read_b64 v[100:101], v4 offset:24064
    v_exp_f32 v48, v48
    v_exp_f32 v49, v49
    v_exp_f32 v50, v50
    v_exp_f32 v51, v51
    v_cvt_pk_bf16_f32 v64, v48, v49
    v_mfma_f32_32x32x16_bf16 v[72:87], v[108:111], v[68:71], v[72:87]
    s_mov_b64 exec, s[40:41]
    ds_read_b128 v[104:107], v5 offset:21760
    ds_read_b128 v[108:111], v5 offset:22400
    s_mov_b64 exec, -1
    v_cvt_pk_bf16_f32 v65, v50, v51
    v_exp_f32 v52, v52
    v_exp_f32 v53, v53
    v_exp_f32 v54, v54
    v_exp_f32 v55, v55
    v_cvt_pk_bf16_f32 v66, v52, v53
    s_setprio 0
    v_mfma_f32_32x32x8_bf16 v[32:47], v[92:93], v[12:13], v[32:47]
    v_cvt_pk_bf16_f32 v67, v54, v55
    v_exp_f32 v56, v56
    v_exp_f32 v57, v57
    v_exp_f32 v58, v58
    v_exp_f32 v59, v59
    v_cvt_pk_bf16_f32 v68, v56, v57
    s_waitcnt lgkmcnt(4)
    v_mfma_f32_32x32x16_bf16 v[72:87], v[112:115], v[64:67], v[72:87]
    v_cvt_pk_bf16_f32 v69, v58, v59
    v_exp_f32 v60, v60
    v_exp_f32 v61, v61
    v_exp_f32 v62, v62
    v_exp_f32 v63, v63
    v_cvt_pk_bf16_f32 v70, v60, v61
    v_cvt_pk_bf16_f32 v71, v62, v63
    v_add_u32 v3, 20480, v3
    v_add_u32 v4, 20480, v4
    v_add_u32 v5, 20480, v5
    s_add_u32 s34, s34, 1
    s_cmp_lg_u32 s34, s35
    s_cbranch_scc1 L_k4_kernel_5
    s_waitcnt vmcnt(0)
    s_barrier
    s_lshr_b32 s47, s2, 5
    s_lshl_b32 s47, s47, 2
    s_lshr_b32 s48, s27, 3
    s_add_u32 s47, s47, s48
    s_and_b32 s48, s27, 3
    s_lshr_b32 s49, s3, 2
    s_lshl1_add_u32 s48, s48, s49
    s_and_b32 s50, s3, 3
    s_bfe_u32 s49, s27, 0x10002
    s_lshl_b32 s49, s49, 1
    s_and_b32 s51, s3, 1
    s_add_u32 s49, s49, s51
    s_cmp_lt_u32 s50, 2
    s_cselect_b32 s51, 0, 2147483632
    s_mov_b32 s52, 9568256
    s_cmp_eq_u32 s46, 0
    s_cselect_b32 s52, s52, 10485760
    s_cbranch_scc1 L_k4_kernel_8
    s_lshl_b32 s54, s47, 3
    s_add_u32 s54, s54, s48
    s_mul_i32 s54, s54, 10240
    s_lshr_b32 s55, s49, 1
    s_mul_i32 s55, s55, 5120
    s_add_u32 s54, s54, s55
    s_and_b32 s55, s49, 1
    s_lshl_b32 s55, s55, 3
    s_add_u32 s54, s54, s55
    s_add_u32 s54, s54, 27262976
    s_add_u32 s55, s54, 4096
    v_or_b32 v138, s51, v6
    v_mov_b32 v139, 0
    s_mov_b64 s[44:45], 0
    buffer_load_dwordx2 v[128:129], v138, s[4:7], s54 offen offset:0
    buffer_load_dwordx2 v[130:131], v138, s[4:7], s54 offen offset:1024
    buffer_load_dwordx2 v[132:133], v138, s[4:7], s54 offen offset:2048
    buffer_load_dwordx2 v[134:135], v138, s[4:7], s54 offen offset:3072
    buffer_load_dwordx2 v[136:137], v138, s[4:7], s55 offen offset:0
    s_branch L_k4_kernel_9
L_k4_kernel_8:
    s_lshl_b32 s54, s47, 2
    s_add_u32 s54, s54, s49
    s_mul_i32 s54, s54, 20608
    s_mul_i32 s55, s48, 2560
    s_add_u32 s54, s54, s55
    s_add_u32 s54, s54, 0
    v_and_b32 v121, 15, v0
    v_lshrrev_b32 v122, 4, v0
    v_lshlrev_b32 v138, 5, v121
    v_lshl_add_u32 v138, v122, 3, v138
    v_cmp_eq_u32 vcc, 1, v121
    s_cmp_eq_u32 s48, 0
    s_cselect_b64 s[44:45], vcc, 0
    v_add_u32 v139, 20448, v138
    v_cndmask_b32 v139, v138, v139, s[44:45]
    v_or_b32 v138, s51, v138
    v_or_b32 v139, s51, v139
    buffer_load_dwordx2 v[128:129], v139, s[4:7], s54 offen offset:0
    buffer_load_dwordx2 v[130:131], v138, s[4:7], s54 offen offset:512
    buffer_load_dwordx2 v[132:133], v138, s[4:7], s54 offen offset:1024
    buffer_load_dwordx2 v[134:135], v138, s[4:7], s54 offen offset:1536
    buffer_load_dwordx2 v[136:137], v138, s[4:7], s54 offen offset:2048
L_k4_kernel_9:
    s_mul_i32 s55, s48, 102400
    s_add_u32 s52, s52, s55
    s_lshl_b32 s55, s50, 12
    s_add_u32 s52, s52, s55
    s_mul_i32 s55, s50, 3072
    s_sub_u32 s55, 16384, s55
    v_add_u32 v121, s55, v6
    buffer_load_dwordx4 a[0:3], v6, s[4:7], s52 offen offset:0
    buffer_load_dwordx4 a[20:23], v6, s[4:7], s52 offen offset:1024
    buffer_load_dwordx4 a[40:43], v6, s[4:7], s52 offen offset:2048
    buffer_load_dwordx4 a[60:63], v6, s[4:7], s52 offen offset:3072
    buffer_load_dwordx4 a[80:83], v121, s[4:7], s52 offen offset:0
    s_add_u32 s52, s52, 20480
    buffer_load_dwordx4 a[4:7], v6, s[4:7], s52 offen offset:0
    buffer_load_dwordx4 a[24:27], v6, s[4:7], s52 offen offset:1024
    buffer_load_dwordx4 a[44:47], v6, s[4:7], s52 offen offset:2048
    buffer_load_dwordx4 a[64:67], v6, s[4:7], s52 offen offset:3072
    buffer_load_dwordx4 a[84:87], v121, s[4:7], s52 offen offset:0
    s_add_u32 s52, s52, 20480
    buffer_load_dwordx4 a[8:11], v6, s[4:7], s52 offen offset:0
    buffer_load_dwordx4 a[28:31], v6, s[4:7], s52 offen offset:1024
    buffer_load_dwordx4 a[48:51], v6, s[4:7], s52 offen offset:2048
    buffer_load_dwordx4 a[68:71], v6, s[4:7], s52 offen offset:3072
    buffer_load_dwordx4 a[88:91], v121, s[4:7], s52 offen offset:0
    s_add_u32 s52, s52, 20480
    buffer_load_dwordx4 a[12:15], v6, s[4:7], s52 offen offset:0
    buffer_load_dwordx4 a[32:35], v6, s[4:7], s52 offen offset:1024
    buffer_load_dwordx4 a[52:55], v6, s[4:7], s52 offen offset:2048
    buffer_load_dwordx4 a[72:75], v6, s[4:7], s52 offen offset:3072
    buffer_load_dwordx4 a[92:95], v121, s[4:7], s52 offen offset:0
    s_add_u32 s52, s52, 20480
    buffer_load_dwordx4 a[16:19], v6, s[4:7], s52 offen offset:0
    buffer_load_dwordx4 a[36:39], v6, s[4:7], s52 offen offset:1024
    buffer_load_dwordx4 a[56:59], v6, s[4:7], s52 offen offset:2048
    buffer_load_dwordx4 a[76:79], v6, s[4:7], s52 offen offset:3072
    buffer_load_dwordx4 a[96:99], v121, s[4:7], s52 offen offset:0
L_k4_kernel_5:
    s_cmp_lt_u32 s34, 8
    s_cbranch_scc1 L_k4_kernel_4
    v_mfma_f32_32x32x16_bf16 v[72:87], v[116:119], v[68:71], v[72:87]
    s_lshl_b32 s29, s28, 1
    s_mul_i32 s29, s29, 20480
    s_mul_i32 s30, s27, 640
    s_add_u32 s29, s29, s30
    s_add_u32 s29, s29, 23068672
    v_bfe_u32 v64, v0, 4, 1
    v_mul_u32_u24 v64, 20480, v64
    v_and_b32 v65, 15, v0
    v_lshl_add_u32 v66, v65, 3, v64
    v_lshl_add_u32 v64, v65, 4, v64
    v_lshl_add_u32 v64, v2, 8, v64
    v_mov_b32 v65, 2147483632
    v_cmp_gt_u32 vcc, 32, v0
    s_mov_b32 s38, 0x1f800000
    s_mov_b32 s39, 0x5f800000
    v_cndmask_b32 v66, v65, v66, vcc
    s_waitcnt lgkmcnt(0)
    v_cmp_le_f32 vcc, s38, v84
    v_cmp_ge_f32 s[42:43], s39, v84
    v_rcp_f32 v67, v84
    s_nop 0
    s_and_b64 vcc, vcc, s[42:43]
    s_cmp_lg_u32 s36, 0
    s_cbranch_scc1 L_k4_kernel_7
    s_cmp_eq_u64 vcc, -1
    s_cbranch_scc0 L_k4_kernel_6
L_k4_kernel_7:
    v_mul_f32 v72, v72, v67
    v_mul_f32 v73, v73, v67
    v_mul_f32 v74, v74, v67
    v_mul_f32 v75, v75, v67
    v_mul_f32 v76, v76, v67
    v_mul_f32 v77, v77, v67
    v_mul_f32 v78, v78, v67
    v_mul_f32 v79, v79, v67
    v_mul_f32 v80, v80, v67
    v_mul_f32 v81, v81, v67
    v_mul_f32 v82, v82, v67
    v_mul_f32 v83, v83, v67
    v_cvt_pk_bf16_f32 v72, v72, v73
    v_cvt_pk_bf16_f32 v73, v74, v75
    v_cvt_pk_bf16_f32 v74, v76, v77
    v_cvt_pk_bf16_f32 v75, v78, v79
    v_cvt_pk_bf16_f32 v76, v80, v81
    v_cvt_pk_bf16_f32 v77, v82, v83
    buffer_store_dwordx4 v[72:75], v64, s[4:7], s29 offen sc1
    buffer_store_dwordx2 v[76:77], v66, s[4:7], s29 offen offset:512 sc1
    v_and_b32 v1, 15, v0
    v_lshrrev_b32 v2, 4, v0
    v_lshrrev_b32 v3, 1, v2
    v_mul_u32_u24 v3, 640, v3
    v_and_b32 v4, 1, v2
    v_lshl_add_u32 v3, v4, 8, v3
    v_lshl_add_u32 v3, v1, 4, v3
    v_mul_u32_u24 v4, 640, v2
    v_lshl_add_u32 v4, v1, 3, v4
    s_mul_i32 s41, s50, 5120
    s_add_u32 s41, s41, 23068672
    s_lshl_b32 s42, s47, 2
    s_add_u32 s42, s42, s49
    s_xor_b32 s43, s42, 1
    s_mul_i32 s32, s42, 20480
    s_mul_i32 s33, s43, 20480
    s_add_u32 s32, s32, s41
    s_add_u32 s33, s33, s41
    s_max_u32 s41, s50, 1
    s_sub_u32 s41, s41, 1
    s_mul_i32 s41, s41, 5120
    s_lshr_b32 s42, s3, 2
    s_and_b32 s43, s3, 1
    s_lshl1_add_u32 s43, s42, s43
    s_mul_i32 s42, s43, 15360
    s_xor_b32 s43, s43, 1
    s_mul_i32 s43, s43, 15360
    v_add_u32 v12, s42, v6
    s_add_u32 s42, s42, s41
    s_add_u32 s43, s43, s41
    v_add_u32 v13, s42, v6
    v_add_u32 v14, s43, v6
    v_cmp_eq_u32 vcc, 0, v0
    v_mov_b32 v8, 2147483632
    v_mov_b32 v9, 1
    s_lshr_b32 s55, s2, 5
    s_lshl_b32 s55, s55, 12
    s_add_u32 s55, s55, 26230784
    s_lshl_b32 s34, s3, 7
    s_add_u32 s34, s34, s55
    s_lshr_b32 s35, s27, 2
    s_lshl_b32 s35, s35, 7
    s_add_u32 s55, s55, s35
    v_cmp_gt_u32 s[38:39], 8, v0
    v_lshlrev_b32 v10, 7, v0
    s_nop 0
    v_cndmask_b32 v10, v8, v10, s[38:39]
    v_cndmask_b32 v8, v8, 0, vcc
    s_mov_b32 s36, 0xffff0000
    s_mov_b32 s35, 0
    s_waitcnt vmcnt(0)
    buffer_atomic_add v9, v8, s[4:7], s34 offen sc1
    s_barrier
    s_cmp_lg_u32 s3, 0
    s_cbranch_scc1 L_k4_kernel_10
    buffer_load_dword v16, v8, s[4:7], s55 offen sc0 sc1
    s_sleep 3
    buffer_load_dword v17, v8, s[4:7], s55 offen sc0 sc1
    s_sleep 3
L_k4_kernel_11:
    buffer_load_dword v18, v8, s[4:7], s55 offen sc0 sc1
    s_waitcnt vmcnt(2)
    v_readfirstlane_b32 s34, v16
    s_cmp_ge_u32 s34, 32
    s_cbranch_scc1 L_k4_kernel_10
    s_sleep 3
    buffer_load_dword v16, v8, s[4:7], s55 offen sc0 sc1
    s_waitcnt vmcnt(2)
    v_readfirstlane_b32 s34, v17
    s_cmp_ge_u32 s34, 32
    s_cbranch_scc1 L_k4_kernel_10
    s_sleep 3
    buffer_load_dword v17, v8, s[4:7], s55 offen sc0 sc1
    s_waitcnt vmcnt(2)
    v_readfirstlane_b32 s34, v18
    s_cmp_ge_u32 s34, 32
    s_cbranch_scc1 L_k4_kernel_10
    s_sleep 3
    s_add_u32 s35, s35, 1
    s_cmp_lt_u32 s35, 0x20000
    s_cbranch_scc1 L_k4_kernel_11
L_k4_kernel_10:
    s_barrier
    buffer_load_dwordx4 v[24:27], v3, s[4:7], s32 offen offset:0
    buffer_load_dwordx4 v[28:31], v3, s[4:7], s33 offen offset:0
    buffer_load_dwordx4 v[32:35], v3, s[4:7], s32 offen offset:1280
    buffer_load_dwordx4 v[36:39], v3, s[4:7], s33 offen offset:1280
    buffer_load_dwordx4 v[40:43], v3, s[4:7], s32 offen offset:2560
    buffer_load_dwordx4 v[44:47], v3, s[4:7], s33 offen offset:2560
    buffer_load_dwordx4 v[48:51], v3, s[4:7], s32 offen offset:3840
    buffer_load_dwordx4 v[52:55], v3, s[4:7], s33 offen offset:3840
    buffer_load_dwordx2 v[56:57], v4, s[4:7], s32 offen offset:512
    buffer_load_dwordx2 v[58:59], v4, s[4:7], s32 offen offset:3072
    buffer_load_dwordx2 v[60:61], v4, s[4:7], s33 offen offset:512
    buffer_load_dwordx2 v[62:63], v4, s[4:7], s33 offen offset:3072
    v_lshlrev_b32 v104, 16, v128
    v_and_b32 v105, s36, v128
    v_lshlrev_b32 v106, 16, v129
    v_and_b32 v107, s36, v129
    v_lshlrev_b32 v108, 16, v130
    v_and_b32 v109, s36, v130
    v_lshlrev_b32 v110, 16, v131
    v_and_b32 v111, s36, v131
    v_lshlrev_b32 v112, 16, v132
    v_and_b32 v113, s36, v132
    v_lshlrev_b32 v114, 16, v133
    v_and_b32 v115, s36, v133
    v_lshlrev_b32 v116, 16, v134
    v_and_b32 v117, s36, v134
    v_lshlrev_b32 v118, 16, v135
    v_and_b32 v119, s36, v135
    v_lshlrev_b32 v120, 16, v136
    v_and_b32 v121, s36, v136
    v_lshlrev_b32 v122, 16, v137
    v_and_b32 v123, s36, v137
    s_cmp_lg_u32 s46, 0
    s_cbranch_scc1 L_k4_kernel_12
    s_waitcnt vmcnt(10)
    v_mfma_f32_16x16x32_bf16 v[104:107], v[24:27], a[0:3], v[104:107]
    v_mfma_f32_16x16x32_bf16 v[108:111], v[24:27], a[4:7], v[108:111]
    v_mfma_f32_16x16x32_bf16 v[112:115], v[24:27], a[8:11], v[112:115]
    v_mfma_f32_16x16x32_bf16 v[116:119], v[24:27], a[12:15], v[116:119]
    v_mfma_f32_16x16x32_bf16 v[120:123], v[24:27], a[16:19], v[120:123]
    v_mfma_f32_16x16x32_bf16 v[84:87], v[28:31], a[0:3], 0
    v_mfma_f32_16x16x32_bf16 v[88:91], v[28:31], a[4:7], 0
    v_mfma_f32_16x16x32_bf16 v[92:95], v[28:31], a[8:11], 0
    v_mfma_f32_16x16x32_bf16 v[96:99], v[28:31], a[12:15], 0
    v_mfma_f32_16x16x32_bf16 v[100:103], v[28:31], a[16:19], 0
    s_waitcnt vmcnt(8)
    v_mfma_f32_16x16x32_bf16 v[104:107], v[32:35], a[20:23], v[104:107]
    v_mfma_f32_16x16x32_bf16 v[108:111], v[32:35], a[24:27], v[108:111]
    v_mfma_f32_16x16x32_bf16 v[112:115], v[32:35], a[28:31], v[112:115]
    v_mfma_f32_16x16x32_bf16 v[116:119], v[32:35], a[32:35], v[116:119]
    v_mfma_f32_16x16x32_bf16 v[120:123], v[32:35], a[36:39], v[120:123]
    v_mfma_f32_16x16x32_bf16 v[84:87], v[36:39], a[20:23], v[84:87]
    v_mfma_f32_16x16x32_bf16 v[88:91], v[36:39], a[24:27], v[88:91]
    v_mfma_f32_16x16x32_bf16 v[92:95], v[36:39], a[28:31], v[92:95]
    v_mfma_f32_16x16x32_bf16 v[96:99], v[36:39], a[32:35], v[96:99]
    v_mfma_f32_16x16x32_bf16 v[100:103], v[36:39], a[36:39], v[100:103]
    s_waitcnt vmcnt(6)
    v_mfma_f32_16x16x32_bf16 v[104:107], v[40:43], a[40:43], v[104:107]
    v_mfma_f32_16x16x32_bf16 v[108:111], v[40:43], a[44:47], v[108:111]
    v_mfma_f32_16x16x32_bf16 v[112:115], v[40:43], a[48:51], v[112:115]
    v_mfma_f32_16x16x32_bf16 v[116:119], v[40:43], a[52:55], v[116:119]
    v_mfma_f32_16x16x32_bf16 v[120:123], v[40:43], a[56:59], v[120:123]
    v_mfma_f32_16x16x32_bf16 v[84:87], v[44:47], a[40:43], v[84:87]
    v_mfma_f32_16x16x32_bf16 v[88:91], v[44:47], a[44:47], v[88:91]
    v_mfma_f32_16x16x32_bf16 v[92:95], v[44:47], a[48:51], v[92:95]
    v_mfma_f32_16x16x32_bf16 v[96:99], v[44:47], a[52:55], v[96:99]
    v_mfma_f32_16x16x32_bf16 v[100:103], v[44:47], a[56:59], v[100:103]
    s_waitcnt vmcnt(4)
    v_mfma_f32_16x16x32_bf16 v[104:107], v[48:51], a[60:63], v[104:107]
    v_mfma_f32_16x16x32_bf16 v[108:111], v[48:51], a[64:67], v[108:111]
    v_mfma_f32_16x16x32_bf16 v[112:115], v[48:51], a[68:71], v[112:115]
    v_mfma_f32_16x16x32_bf16 v[116:119], v[48:51], a[72:75], v[116:119]
    v_mfma_f32_16x16x32_bf16 v[120:123], v[48:51], a[76:79], v[120:123]
    v_mfma_f32_16x16x32_bf16 v[84:87], v[52:55], a[60:63], v[84:87]
    v_mfma_f32_16x16x32_bf16 v[88:91], v[52:55], a[64:67], v[88:91]
    v_mfma_f32_16x16x32_bf16 v[92:95], v[52:55], a[68:71], v[92:95]
    v_mfma_f32_16x16x32_bf16 v[96:99], v[52:55], a[72:75], v[96:99]
    v_mfma_f32_16x16x32_bf16 v[100:103], v[52:55], a[76:79], v[100:103]
    s_waitcnt vmcnt(0)
    v_mfma_f32_16x16x32_bf16 v[84:87], v[60:63], a[80:83], v[84:87]
    v_mfma_f32_16x16x32_bf16 v[88:91], v[60:63], a[84:87], v[88:91]
    v_mfma_f32_16x16x32_bf16 v[92:95], v[60:63], a[88:91], v[92:95]
    v_mfma_f32_16x16x32_bf16 v[96:99], v[60:63], a[92:95], v[96:99]
    v_mfma_f32_16x16x32_bf16 v[100:103], v[60:63], a[96:99], v[100:103]
    v_mfma_f32_16x16x32_bf16 v[104:107], v[56:59], a[80:83], v[104:107]
    v_mfma_f32_16x16x32_bf16 v[108:111], v[56:59], a[84:87], v[108:111]
    v_mfma_f32_16x16x32_bf16 v[112:115], v[56:59], a[88:91], v[112:115]
    v_mfma_f32_16x16x32_bf16 v[116:119], v[56:59], a[92:95], v[116:119]
    v_mfma_f32_16x16x32_bf16 v[120:123], v[56:59], a[96:99], v[120:123]
    s_cmp_lt_u32 s50, 2
    s_nop 1
    ds_write_b128 v14, v[84:87] offset:0
    ds_write_b128 v14, v[88:91] offset:1024
    ds_write_b128 v14, v[92:95] offset:2048
    ds_write_b128 v14, v[96:99] offset:3072
    ds_write_b128 v14, v[100:103] offset:4096
    s_cbranch_scc1 L_k4_kernel_14
    s_nop 3
    ds_write_b128 v13, v[104:107] offset:0
    ds_write_b128 v13, v[108:111] offset:1024
    ds_write_b128 v13, v[112:115] offset:2048
    ds_write_b128 v13, v[116:119] offset:3072
    ds_write_b128 v13, v[120:123] offset:4096
    s_waitcnt lgkmcnt(0)
    s_endpgm
L_k4_kernel_14:
    s_waitcnt lgkmcnt(0)
    s_barrier
    ds_read_b128 v[24:27], v12 offset:0
    ds_read_b128 v[28:31], v12 offset:1024
    ds_read_b128 v[32:35], v12 offset:2048
    ds_read_b128 v[36:39], v12 offset:3072
    ds_read_b128 v[40:43], v12 offset:4096
    ds_read_b128 v[44:47], v12 offset:5120
    ds_read_b128 v[48:51], v12 offset:6144
    ds_read_b128 v[52:55], v12 offset:7168
    ds_read_b128 v[56:59], v12 offset:8192
    ds_read_b128 v[60:63], v12 offset:9216
    ds_read_b128 v[64:67], v12 offset:10240
    ds_read_b128 v[68:71], v12 offset:11264
    ds_read_b128 v[72:75], v12 offset:12288
    ds_read_b128 v[76:79], v12 offset:13312
    ds_read_b128 v[80:83], v12 offset:14336
    s_waitcnt lgkmcnt(10)
    v_pk_add_f32 v[104:105], v[104:105], v[24:25]
    v_pk_add_f32 v[106:107], v[106:107], v[26:27]
    v_pk_add_f32 v[108:109], v[108:109], v[28:29]
    v_pk_add_f32 v[110:111], v[110:111], v[30:31]
    v_pk_add_f32 v[112:113], v[112:113], v[32:33]
    v_pk_add_f32 v[114:115], v[114:115], v[34:35]
    v_pk_add_f32 v[116:117], v[116:117], v[36:37]
    v_pk_add_f32 v[118:119], v[118:119], v[38:39]
    v_pk_add_f32 v[120:121], v[120:121], v[40:41]
    v_pk_add_f32 v[122:123], v[122:123], v[42:43]
    s_waitcnt lgkmcnt(5)
    v_pk_add_f32 v[104:105], v[104:105], v[44:45]
    v_pk_add_f32 v[106:107], v[106:107], v[46:47]
    v_pk_add_f32 v[108:109], v[108:109], v[48:49]
    v_pk_add_f32 v[110:111], v[110:111], v[50:51]
    v_pk_add_f32 v[112:113], v[112:113], v[52:53]
    v_pk_add_f32 v[114:115], v[114:115], v[54:55]
    v_pk_add_f32 v[116:117], v[116:117], v[56:57]
    v_pk_add_f32 v[118:119], v[118:119], v[58:59]
    v_pk_add_f32 v[120:121], v[120:121], v[60:61]
    v_pk_add_f32 v[122:123], v[122:123], v[62:63]
    s_waitcnt lgkmcnt(0)
    v_pk_add_f32 v[104:105], v[104:105], v[64:65]
    v_pk_add_f32 v[106:107], v[106:107], v[66:67]
    v_pk_add_f32 v[108:109], v[108:109], v[68:69]
    v_pk_add_f32 v[110:111], v[110:111], v[70:71]
    v_pk_add_f32 v[112:113], v[112:113], v[72:73]
    v_pk_add_f32 v[114:115], v[114:115], v[74:75]
    v_pk_add_f32 v[116:117], v[116:117], v[76:77]
    v_pk_add_f32 v[118:119], v[118:119], v[78:79]
    v_pk_add_f32 v[120:121], v[120:121], v[80:81]
    v_pk_add_f32 v[122:123], v[122:123], v[82:83]
    v_cvt_pk_bf16_f32 v84, v104, v105
    v_cvt_pk_bf16_f32 v85, v106, v107
    v_cvt_pk_bf16_f32 v86, v108, v109
    v_cvt_pk_bf16_f32 v87, v110, v111
    v_cvt_pk_bf16_f32 v88, v112, v113
    v_cvt_pk_bf16_f32 v89, v114, v115
    v_cvt_pk_bf16_f32 v90, v116, v117
    v_cvt_pk_bf16_f32 v91, v118, v119
    v_cvt_pk_bf16_f32 v92, v120, v121
    v_cvt_pk_bf16_f32 v93, v122, v123
    buffer_store_dwordx2 v[84:85], v139, s[4:7], s54 offen offset:0 sc1
    buffer_store_dwordx2 v[86:87], v138, s[4:7], s54 offen offset:512 sc1
    buffer_store_dwordx2 v[88:89], v138, s[4:7], s54 offen offset:1024 sc1
    buffer_store_dwordx2 v[90:91], v138, s[4:7], s54 offen offset:1536 sc1
    buffer_store_dwordx2 v[92:93], v138, s[4:7], s54 offen offset:2048 sc1
    v_cndmask_b32 v104, v104, 0, s[44:45]
    v_cndmask_b32 v105, v105, 0, s[44:45]
    v_cndmask_b32 v106, v106, 0, s[44:45]
    v_cndmask_b32 v107, v107, 0, s[44:45]
    v_mul_f32 v24, v104, v104
    v_mul_f32 v25, v105, v105
    v_mul_f32 v26, v106, v106
    v_mul_f32 v27, v107, v107
    v_fmac_f32 v24, v108, v108
    v_fmac_f32 v25, v109, v109
    v_fmac_f32 v26, v110, v110
    v_fmac_f32 v27, v111, v111
    v_fmac_f32 v24, v112, v112
    v_fmac_f32 v25, v113, v113
    v_fmac_f32 v26, v114, v114
    v_fmac_f32 v27, v115, v115
    v_fmac_f32 v24, v116, v116
    v_fmac_f32 v25, v117, v117
    v_fmac_f32 v26, v118, v118
    v_fmac_f32 v27, v119, v119
    v_fmac_f32 v24, v120, v120
    v_fmac_f32 v25, v121, v121
    v_fmac_f32 v26, v122, v122
    v_fmac_f32 v27, v123, v123
    v_add_f32_dpp v24, v24, v24 row_ror:8 row_mask:0xf bank_mask:0xf
    v_add_f32_dpp v25, v25, v25 row_ror:8 row_mask:0xf bank_mask:0xf
    v_add_f32_dpp v26, v26, v26 row_ror:8 row_mask:0xf bank_mask:0xf
    v_add_f32_dpp v27, v27, v27 row_ror:8 row_mask:0xf bank_mask:0xf
    v_add_f32_dpp v24, v24, v24 row_ror:4 row_mask:0xf bank_mask:0xf
    v_add_f32_dpp v25, v25, v25 row_ror:4 row_mask:0xf bank_mask:0xf
    v_add_f32_dpp v26, v26, v26 row_ror:4 row_mask:0xf bank_mask:0xf
    v_add_f32_dpp v27, v27, v27 row_ror:4 row_mask:0xf bank_mask:0xf
    v_add_f32_dpp v24, v24, v24 row_ror:2 row_mask:0xf bank_mask:0xf
    v_add_f32_dpp v25, v25, v25 row_ror:2 row_mask:0xf bank_mask:0xf
    v_add_f32_dpp v26, v26, v26 row_ror:2 row_mask:0xf bank_mask:0xf
    v_add_f32_dpp v27, v27, v27 row_ror:2 row_mask:0xf bank_mask:0xf
    v_add_f32_dpp v24, v24, v24 row_ror:1 row_mask:0xf bank_mask:0xf
    v_add_f32_dpp v25, v25, v25 row_ror:1 row_mask:0xf bank_mask:0xf
    v_add_f32_dpp v26, v26, v26 row_ror:1 row_mask:0xf bank_mask:0xf
    v_add_f32_dpp v27, v27, v27 row_ror:1 row_mask:0xf bank_mask:0xf
    v_cmp_eq_u32 vcc, 1, v1
    v_cmp_eq_u32 s[42:43], 2, v1
    v_cmp_eq_u32 s[38:39], 3, v1
    v_cndmask_b32 v24, v24, v25, vcc
    v_cmp_gt_u32 vcc, 4, v1
    v_cndmask_b32 v24, v24, v26, s[42:43]
    v_cndmask_b32 v24, v24, v27, s[38:39]
    v_lshlrev_b32 v3, 2, v1
    v_lshl_add_u32 v3, v2, 4, v3
    v_mov_b32 v4, 2147483632
    v_cndmask_b32 v3, v4, v3, vcc
    s_lshl_b32 s30, s47, 8
    s_lshl_b32 s31, s49, 6
    s_add_u32 s30, s30, s31
    s_add_u32 s30, s30, 26222592
    buffer_atomic_add_f32 v24, v3, s[4:7], s30 offen
    s_endpgm
L_k4_kernel_12:
    s_waitcnt vmcnt(10)
    v_mfma_f32_16x16x32_bf16 v[104:107], a[0:3], v[24:27], v[104:107]
    v_mfma_f32_16x16x32_bf16 v[108:111], a[4:7], v[24:27], v[108:111]
    v_mfma_f32_16x16x32_bf16 v[112:115], a[8:11], v[24:27], v[112:115]
    v_mfma_f32_16x16x32_bf16 v[116:119], a[12:15], v[24:27], v[116:119]
    v_mfma_f32_16x16x32_bf16 v[120:123], a[16:19], v[24:27], v[120:123]
    v_mfma_f32_16x16x32_bf16 v[84:87], a[0:3], v[28:31], 0
    v_mfma_f32_16x16x32_bf16 v[88:91], a[4:7], v[28:31], 0
    v_mfma_f32_16x16x32_bf16 v[92:95], a[8:11], v[28:31], 0
    v_mfma_f32_16x16x32_bf16 v[96:99], a[12:15], v[28:31], 0
    v_mfma_f32_16x16x32_bf16 v[100:103], a[16:19], v[28:31], 0
    s_waitcnt vmcnt(8)
    v_mfma_f32_16x16x32_bf16 v[104:107], a[20:23], v[32:35], v[104:107]
    v_mfma_f32_16x16x32_bf16 v[108:111], a[24:27], v[32:35], v[108:111]
    v_mfma_f32_16x16x32_bf16 v[112:115], a[28:31], v[32:35], v[112:115]
    v_mfma_f32_16x16x32_bf16 v[116:119], a[32:35], v[32:35], v[116:119]
    v_mfma_f32_16x16x32_bf16 v[120:123], a[36:39], v[32:35], v[120:123]
    v_mfma_f32_16x16x32_bf16 v[84:87], a[20:23], v[36:39], v[84:87]
    v_mfma_f32_16x16x32_bf16 v[88:91], a[24:27], v[36:39], v[88:91]
    v_mfma_f32_16x16x32_bf16 v[92:95], a[28:31], v[36:39], v[92:95]
    v_mfma_f32_16x16x32_bf16 v[96:99], a[32:35], v[36:39], v[96:99]
    v_mfma_f32_16x16x32_bf16 v[100:103], a[36:39], v[36:39], v[100:103]
    s_waitcnt vmcnt(6)
    v_mfma_f32_16x16x32_bf16 v[104:107], a[40:43], v[40:43], v[104:107]
    v_mfma_f32_16x16x32_bf16 v[108:111], a[44:47], v[40:43], v[108:111]
    v_mfma_f32_16x16x32_bf16 v[112:115], a[48:51], v[40:43], v[112:115]
    v_mfma_f32_16x16x32_bf16 v[116:119], a[52:55], v[40:43], v[116:119]
    v_mfma_f32_16x16x32_bf16 v[120:123], a[56:59], v[40:43], v[120:123]
    v_mfma_f32_16x16x32_bf16 v[84:87], a[40:43], v[44:47], v[84:87]
    v_mfma_f32_16x16x32_bf16 v[88:91], a[44:47], v[44:47], v[88:91]
    v_mfma_f32_16x16x32_bf16 v[92:95], a[48:51], v[44:47], v[92:95]
    v_mfma_f32_16x16x32_bf16 v[96:99], a[52:55], v[44:47], v[96:99]
    v_mfma_f32_16x16x32_bf16 v[100:103], a[56:59], v[44:47], v[100:103]
    s_waitcnt vmcnt(4)
    v_mfma_f32_16x16x32_bf16 v[104:107], a[60:63], v[48:51], v[104:107]
    v_mfma_f32_16x16x32_bf16 v[108:111], a[64:67], v[48:51], v[108:111]
    v_mfma_f32_16x16x32_bf16 v[112:115], a[68:71], v[48:51], v[112:115]
    v_mfma_f32_16x16x32_bf16 v[116:119], a[72:75], v[48:51], v[116:119]
    v_mfma_f32_16x16x32_bf16 v[120:123], a[76:79], v[48:51], v[120:123]
    v_mfma_f32_16x16x32_bf16 v[84:87], a[60:63], v[52:55], v[84:87]
    v_mfma_f32_16x16x32_bf16 v[88:91], a[64:67], v[52:55], v[88:91]
    v_mfma_f32_16x16x32_bf16 v[92:95], a[68:71], v[52:55], v[92:95]
    v_mfma_f32_16x16x32_bf16 v[96:99], a[72:75], v[52:55], v[96:99]
    v_mfma_f32_16x16x32_bf16 v[100:103], a[76:79], v[52:55], v[100:103]
    s_waitcnt vmcnt(0)
    v_mfma_f32_16x16x32_bf16 v[84:87], a[80:83], v[60:63], v[84:87]
    v_mfma_f32_16x16x32_bf16 v[88:91], a[84:87], v[60:63], v[88:91]
    v_mfma_f32_16x16x32_bf16 v[92:95], a[88:91], v[60:63], v[92:95]
    v_mfma_f32_16x16x32_bf16 v[96:99], a[92:95], v[60:63], v[96:99]
    v_mfma_f32_16x16x32_bf16 v[100:103], a[96:99], v[60:63], v[100:103]
    v_mfma_f32_16x16x32_bf16 v[104:107], a[80:83], v[56:59], v[104:107]
    v_mfma_f32_16x16x32_bf16 v[108:111], a[84:87], v[56:59], v[108:111]
    v_mfma_f32_16x16x32_bf16 v[112:115], a[88:91], v[56:59], v[112:115]
    v_mfma_f32_16x16x32_bf16 v[116:119], a[92:95], v[56:59], v[116:119]
    v_mfma_f32_16x16x32_bf16 v[120:123], a[96:99], v[56:59], v[120:123]
    s_cmp_lt_u32 s50, 2
    s_nop 1
    ds_write_b128 v14, v[84:87] offset:0
    ds_write_b128 v14, v[88:91] offset:1024
    ds_write_b128 v14, v[92:95] offset:2048
    ds_write_b128 v14, v[96:99] offset:3072
    ds_write_b128 v14, v[100:103] offset:4096
    s_cbranch_scc1 L_k4_kernel_15
    s_nop 3
    ds_write_b128 v13, v[104:107] offset:0
    ds_write_b128 v13, v[108:111] offset:1024
    ds_write_b128 v13, v[112:115] offset:2048
    ds_write_b128 v13, v[116:119] offset:3072
    ds_write_b128 v13, v[120:123] offset:4096
    s_waitcnt lgkmcnt(0)
    s_endpgm
L_k4_kernel_15:
    s_waitcnt lgkmcnt(0)
    s_barrier
    ds_read_b128 v[24:27], v12 offset:0
    ds_read_b128 v[28:31], v12 offset:1024
    ds_read_b128 v[32:35], v12 offset:2048
    ds_read_b128 v[36:39], v12 offset:3072
    ds_read_b128 v[40:43], v12 offset:4096
    ds_read_b128 v[44:47], v12 offset:5120
    ds_read_b128 v[48:51], v12 offset:6144
    ds_read_b128 v[52:55], v12 offset:7168
    ds_read_b128 v[56:59], v12 offset:8192
    ds_read_b128 v[60:63], v12 offset:9216
    ds_read_b128 v[64:67], v12 offset:10240
    ds_read_b128 v[68:71], v12 offset:11264
    ds_read_b128 v[72:75], v12 offset:12288
    ds_read_b128 v[76:79], v12 offset:13312
    ds_read_b128 v[80:83], v12 offset:14336
    s_mov_b32 s52, s20
    s_and_b32 s53, s21, 0xffff
    s_mov_b32 s54, 2621440
    s_mov_b32 s55, 0x00020000
    s_lshl_b32 s29, s49, 9
    s_add_u32 s29, s29, s47
    s_mul_i32 s29, s29, 1280
    s_mul_i32 s30, s48, 160
    s_add_u32 s29, s29, s30
    v_mul_u32_u24 v8, 40960, v1
    v_lshl_add_u32 v9, v2, 3, v8
    v_and_b32 v3, 1, v2
    v_lshl_add_u32 v8, v3, 5, v8
    v_lshrrev_b32 v3, 1, v2
    v_lshl_add_u32 v8, v3, 4, v8
    s_waitcnt lgkmcnt(10)
    v_pk_add_f32 v[104:105], v[104:105], v[24:25]
    v_pk_add_f32 v[106:107], v[106:107], v[26:27]
    v_pk_add_f32 v[108:109], v[108:109], v[28:29]
    v_pk_add_f32 v[110:111], v[110:111], v[30:31]
    v_pk_add_f32 v[112:113], v[112:113], v[32:33]
    v_pk_add_f32 v[114:115], v[114:115], v[34:35]
    v_pk_add_f32 v[116:117], v[116:117], v[36:37]
    v_pk_add_f32 v[118:119], v[118:119], v[38:39]
    v_pk_add_f32 v[120:121], v[120:121], v[40:41]
    v_pk_add_f32 v[122:123], v[122:123], v[42:43]
    s_waitcnt lgkmcnt(5)
    v_pk_add_f32 v[104:105], v[104:105], v[44:45]
    v_pk_add_f32 v[106:107], v[106:107], v[46:47]
    v_pk_add_f32 v[108:109], v[108:109], v[48:49]
    v_pk_add_f32 v[110:111], v[110:111], v[50:51]
    v_pk_add_f32 v[112:113], v[112:113], v[52:53]
    v_pk_add_f32 v[114:115], v[114:115], v[54:55]
    v_pk_add_f32 v[116:117], v[116:117], v[56:57]
    v_pk_add_f32 v[118:119], v[118:119], v[58:59]
    v_pk_add_f32 v[120:121], v[120:121], v[60:61]
    v_pk_add_f32 v[122:123], v[122:123], v[62:63]
    s_waitcnt lgkmcnt(0)
    v_pk_add_f32 v[104:105], v[104:105], v[64:65]
    v_pk_add_f32 v[106:107], v[106:107], v[66:67]
    v_pk_add_f32 v[108:109], v[108:109], v[68:69]
    v_pk_add_f32 v[110:111], v[110:111], v[70:71]
    v_pk_add_f32 v[112:113], v[112:113], v[72:73]
    v_pk_add_f32 v[114:115], v[114:115], v[74:75]
    v_pk_add_f32 v[116:117], v[116:117], v[76:77]
    v_pk_add_f32 v[118:119], v[118:119], v[78:79]
    v_pk_add_f32 v[120:121], v[120:121], v[80:81]
    v_pk_add_f32 v[122:123], v[122:123], v[82:83]
    v_cvt_pk_bf16_f32 v84, v104, v105
    v_cvt_pk_bf16_f32 v85, v106, v107
    v_cvt_pk_bf16_f32 v86, v108, v109
    v_cvt_pk_bf16_f32 v87, v110, v111
    v_cvt_pk_bf16_f32 v88, v112, v113
    v_cvt_pk_bf16_f32 v89, v114, v115
    v_cvt_pk_bf16_f32 v90, v116, v117
    v_cvt_pk_bf16_f32 v91, v118, v119
    v_cvt_pk_bf16_f32 v92, v120, v121
    v_cvt_pk_bf16_f32 v93, v122, v123
    v_permlane16_swap_b32 v84, v86
    v_permlane16_swap_b32 v85, v87
    buffer_store_dwordx4 v[84:87], v8, s[52:55], s29 offen offset:0
    v_permlane16_swap_b32 v88, v90
    v_permlane16_swap_b32 v89, v91
    buffer_store_dwordx4 v[88:91], v8, s[52:55], s29 offen offset:64
    buffer_store_dwordx2 v[92:93], v9, s[52:55], s29 offen offset:128
    s_endpgm
L_k4_kernel_6:
    v_mov_b32 v3, v6
    v_lshlrev_b32 v4, 3, v1
    v_mul_u32_u24 v5, 320, v2
    v_lshl_add_u32 v5, v1, 4, v5
    s_mov_b32 s34, 0
    v_mov_b32 v64, 0xff800000
L_k4_kernel_16:
    ds_read_b128 v[88:91], v3 offset:0
    ds_read_b64 v[92:93], v4 offset:1024
    s_waitcnt lgkmcnt(0)
    v_mfma_f32_32x32x16_bf16 v[32:47], v[88:91], v[8:11], 0
    v_mfma_f32_32x32x8_bf16 v[32:47], v[92:93], v[12:13], v[32:47]
    v_add_u32 v3, 2560, v3
    v_add_u32 v4, 2560, v4
    s_nop 7
    s_nop 3
    v_max3_f32 v64, v32, v33, v64
    v_max3_f32 v64, v34, v35, v64
    v_max3_f32 v64, v36, v37, v64
    v_max3_f32 v64, v38, v39, v64
    v_max3_f32 v64, v40, v41, v64
    v_max3_f32 v64, v42, v43, v64
    v_max3_f32 v64, v44, v45, v64
    v_max3_f32 v64, v46, v47, v64
    s_add_u32 s34, s34, 1
    s_cmp_lt_u32 s34, 64
    s_cbranch_scc1 L_k4_kernel_16
    v_mov_b32 v65, v64
    s_nop 1
    v_permlane32_swap_b32 v64, v65
    v_max_f32 v64, v64, v65
    v_mul_f32 v16, -1.0, v64
    v_mul_f32 v17, -1.0, v64
    v_mul_f32 v18, -1.0, v64
    v_mul_f32 v19, -1.0, v64
    v_mul_f32 v20, -1.0, v64
    v_mul_f32 v21, -1.0, v64
    v_mul_f32 v22, -1.0, v64
    v_mul_f32 v23, -1.0, v64
    v_mul_f32 v24, -1.0, v64
    v_mul_f32 v25, -1.0, v64
    v_mul_f32 v26, -1.0, v64
    v_mul_f32 v27, -1.0, v64
    v_mul_f32 v28, -1.0, v64
    v_mul_f32 v29, -1.0, v64
    v_mul_f32 v30, -1.0, v64
    v_mul_f32 v31, -1.0, v64
    s_mov_b32 s36, 1
    s_mov_b32 s35, 99
    s_branch L_k4_kernel_2

.globl k6_kernel
.p2align 8
.type k6_kernel,@function
k6_kernel:
    s_load_dwordx16 s[8:23], s[0:1], 0
    s_load_dwordx2 s[24:25], s[0:1], 64
    v_lshrrev_b32 v1, 6, v0
    v_and_b32 v0, 63, v0
    s_nop 0
    v_readfirstlane_b32 s3, v1
    s_waitcnt lgkmcnt(0)
    s_mov_b32 s4, s24
    s_and_b32 s5, s25, 0xffff
    s_mov_b32 s6, 30408704
    s_mov_b32 s7, 0x00020000
    s_sub_u32 s26, s2, 0
    s_cmp_lt_u32 s2, 320
    s_cbranch_scc1 J_k6_kernel_1
    s_sub_u32 s26, s2, 320
    s_cmp_lt_u32 s2, 370
    s_cbranch_scc1 J_k6_kernel_2
    s_sub_u32 s26, s2, 370
    s_cmp_lt_u32 s2, 420
    s_cbranch_scc1 J_k6_kernel_3
    s_endpgm
J_k6_kernel_1:
    s_setprio 3
    s_and_b32 s27, s26, 7
    s_lshl_b32 s27, s27, 1
    s_bfe_u32 s28, s26, 0x10003
    s_or_b32 s27, s27, s28
    s_andn2_b32 s28, s26, 15
    s_or_b32 s27, s27, s28
    v_and_b32 v1, 15, v0
    v_lshrrev_b32 v2, 4, v0
    v_mul_u32_u24 v3, 82432, v1
    v_lshl_add_u32 v3, v2, 3, v3
    s_mul_i32 s28, s3, 20608
    s_lshl_b32 s29, s27, 6
    s_add_u32 s28, s28, s29
    s_add_u32 s28, s28, 0
    s_add_u32 s29, s28, 1318912
    v_lshlrev_b32 v4, 8, v1
    v_lshl_add_u32 v4, v2, 4, v4
    s_lshl_b32 s30, s3, 6
    s_add_u32 s30, s30, 26222592
    s_add_u32 s31, s30, 4096
    v_lshlrev_b32 v5, 5, v0
    s_lshl_b32 s32, s27, 13
    s_lshl_b32 s33, s3, 11
    s_add_u32 s32, s32, s33
    s_add_u32 s32, s32, 3145728
    buffer_load_dwordx4 v[136:139], v4, s[4:7], s30 offen
    buffer_load_dwordx2 v[88:89], v3, s[4:7], s28 offen offset:0
    buffer_load_dwordx2 v[90:91], v3, s[4:7], s28 offen offset:32
    buffer_load_dwordx4 v[140:143], v4, s[4:7], s31 offen
    buffer_load_dwordx2 v[92:93], v3, s[4:7], s29 offen offset:0
    buffer_load_dwordx2 v[94:95], v3, s[4:7], s29 offen offset:32
    buffer_load_dwordx4 v[96:99], v5, s[4:7], s32 offen offset:0
    buffer_load_dwordx4 v[100:103], v5, s[4:7], s32 offen offset:16
    s_lshl_b32 s33, s3, 4
    v_add_u32 v6, s33, v1
    v_cvt_f32_u32 v6, v6
    v_cvt_f32_u32 v7, v1
    v_lshlrev_b32 v4, 2, v2
    v_cvt_f32_u32 v4, v4
    v_bfe_i32 v104, v0, 0, 1
    v_and_b32 v104, 0x80008000, v104
    v_xor_b32 v106, 0x80000000, v104
    v_mul_f32 v164, 0x3c800000, v6
    v_add_f32 v165, v4, v4
    v_mul_f32 v165, v165, v164
    v_fmamk_f32 v152, v164, 0x00000000, v165
    v_fmamk_f32 v153, v164, 0x3f800000, v165
    v_fmamk_f32 v154, v164, 0x40000000, v165
    v_fmamk_f32 v155, v164, 0x40400000, v165
    v_cos_f32 v156, v152
    v_cos_f32 v157, v153
    v_cos_f32 v158, v154
    v_cos_f32 v159, v155
    v_sin_f32 v160, v152
    v_sin_f32 v161, v153
    v_sin_f32 v162, v154
    v_sin_f32 v163, v155
    v_cvt_pk_bf16_f32 v8, v156, v157
    v_cvt_pk_bf16_f32 v9, v158, v159
    v_cvt_pk_bf16_f32 v24, v160, v161
    v_cvt_pk_bf16_f32 v25, v162, v163
    v_xor_b32 v16, 0x80008000, v24
    v_xor_b32 v17, 0x80008000, v25
    v_fmamk_f32 v152, v164, 0x40800000, v165
    v_fmamk_f32 v153, v164, 0x40a00000, v165
    v_fmamk_f32 v154, v164, 0x40c00000, v165
    v_fmamk_f32 v155, v164, 0x40e00000, v165
    v_cos_f32 v156, v152
    v_cos_f32 v157, v153
    v_cos_f32 v158, v154
    v_cos_f32 v159, v155
    v_sin_f32 v160, v152
    v_sin_f32 v161, v153
    v_sin_f32 v162, v154
    v_sin_f32 v163, v155
    v_cvt_pk_bf16_f32 v10, v156, v157
    v_cvt_pk_bf16_f32 v11, v158, v159
    v_cvt_pk_bf16_f32 v26, v160, v161
    v_cvt_pk_bf16_f32 v27, v162, v163
    v_xor_b32 v18, 0x80008000, v26
    v_xor_b32 v19, 0x80008000, v27
    v_xor_b32 v12, v104, v8
    v_xor_b32 v13, v104, v9
    v_xor_b32 v14, v104, v10
    v_xor_b32 v15, v104, v11
    v_xor_b32 v20, v104, v16
    v_xor_b32 v21, v104, v17
    v_xor_b32 v22, v104, v18
    v_xor_b32 v23, v104, v19
    v_xor_b32 v28, v104, v24
    v_xor_b32 v29, v104, v25
    v_xor_b32 v30, v104, v26
    v_xor_b32 v31, v104, v27
    v_mul_f32 v164, 0x3a000000, v6
    v_mul_f32 v165, v4, v164
    v_fmamk_f32 v152, v164, 0x00000000, v165
    v_fmamk_f32 v153, v164, 0x3f800000, v165
    v_fmamk_f32 v154, v164, 0x40000000, v165
    v_fmamk_f32 v155, v164, 0x40400000, v165
    v_cos_f32 v56, v152
    v_cos_f32 v57, v153
    v_cos_f32 v58, v154
    v_cos_f32 v59, v155
    v_sin_f32_e64 v64, -v152
    v_sin_f32_e64 v65, -v153
    v_sin_f32_e64 v66, -v154
    v_sin_f32_e64 v67, -v155
    v_fmamk_f32 v152, v164, 0x41800000, v165
    v_fmamk_f32 v153, v164, 0x41880000, v165
    v_fmamk_f32 v154, v164, 0x41900000, v165
    v_fmamk_f32 v155, v164, 0x41980000, v165
    v_cos_f32 v60, v152
    v_cos_f32 v61, v153
    v_cos_f32 v62, v154
    v_cos_f32 v63, v155
    v_sin_f32_e64 v68, -v152
    v_sin_f32_e64 v69, -v153
    v_sin_f32_e64 v70, -v154
    v_sin_f32_e64 v71, -v155
    v_mul_f32 v164, 0x3d000000, v7
    v_mul_f32 v165, v4, v164
    v_fmamk_f32 v152, v164, 0x00000000, v165
    v_fmamk_f32 v153, v164, 0x3f800000, v165
    v_fmamk_f32 v154, v164, 0x40000000, v165
    v_fmamk_f32 v155, v164, 0x40400000, v165
    v_cos_f32 v156, v152
    v_cos_f32 v157, v153
    v_cos_f32 v158, v154
    v_cos_f32 v159, v155
    v_sin_f32 v160, v152
    v_sin_f32 v161, v153
    v_sin_f32 v162, v154
    v_sin_f32 v163, v155
    v_cvt_pk_bf16_f32 v32, v156, v157
    v_cvt_pk_bf16_f32 v33, v158, v159
    v_cvt_pk_bf16_f32 v48, v160, v161
    v_cvt_pk_bf16_f32 v49, v162, v163
    v_xor_b32 v40, 0x80008000, v48
    v_xor_b32 v41, 0x80008000, v49
    v_xor_b32 v34, v104, v32
    v_xor_b32 v36, 0x80000000, v32
    v_xor_b32 v38, v106, v32
    v_xor_b32 v35, v104, v33
    v_xor_b32 v37, 0x80000000, v33
    v_xor_b32 v39, v106, v33
    v_xor_b32 v42, v104, v40
    v_xor_b32 v44, 0x80000000, v40
    v_xor_b32 v46, v106, v40
    v_xor_b32 v43, v104, v41
    v_xor_b32 v45, 0x80000000, v41
    v_xor_b32 v47, v106, v41
    v_xor_b32 v50, v104, v48
    v_xor_b32 v52, 0x80000000, v48
    v_xor_b32 v54, v106, v48
    v_xor_b32 v51, v104, v49
    v_xor_b32 v53, 0x80000000, v49
    v_xor_b32 v55, v106, v49
    v_cvt_f32_u32 v6, s33
    v_add_f32 v6, v6, v4
    v_add_f32 v164, 0x00000000, v7
    v_mul_f32 v164, 0x3a000000, v164
    v_mul_f32 v165, v6, v164
    v_fmamk_f32 v152, v164, 0x00000000, v165
    v_fmamk_f32 v153, v164, 0x3f800000, v165
    v_fmamk_f32 v154, v164, 0x40000000, v165
    v_fmamk_f32 v155, v164, 0x40400000, v165
    v_cos_f32 v72, v152
    v_cos_f32 v73, v153
    v_cos_f32 v74, v154
    v_cos_f32 v75, v155
    v_sin_f32_e64 v80, v152
    v_sin_f32_e64 v81, v153
    v_sin_f32_e64 v82, v154
    v_sin_f32_e64 v83, v155
    v_add_f32 v164, 0x41800000, v7
    v_mul_f32 v164, 0x3a000000, v164
    v_mul_f32 v165, v6, v164
    v_fmamk_f32 v152, v164, 0x00000000, v165
    v_fmamk_f32 v153, v164, 0x3f800000, v165
    v_fmamk_f32 v154, v164, 0x40000000, v165
    v_fmamk_f32 v155, v164, 0x40400000, v165
    v_cos_f32 v76, v152
    v_cos_f32 v77, v153
    v_cos_f32 v78, v154
    v_cos_f32 v79, v155
    v_sin_f32_e64 v84, v152
    v_sin_f32_e64 v85, v153
    v_sin_f32_e64 v86, v154
    v_sin_f32_e64 v87, v155
    s_lshr_b32 s34, s3, 1
    s_lshl_b32 s34, s34, 10
    s_and_b32 s35, s3, 1
    s_lshl_b32 s35, s35, 9
    s_add_u32 s34, s34, s35
    v_lshrrev_b32 v6, 1, v2
    v_lshlrev_b32 v6, 8, v6
    v_lshl_add_u32 v6, v1, 4, v6
    v_and_b32 v7, 1, v2
    v_lshl_add_u32 v6, v7, 3, v6
    v_add_u32 v6, s34, v6
    v_lshlrev_b32 v7, 4, v0
    s_mov_b32 s36, 0x3acccccd
    v_mov_b32 v4, 0x3727c5ac
    s_mov_b32 s37, 0xffff0000
    s_waitcnt vmcnt(2)
    v_fma_f32 v136, v136, s36, v4
    v_fma_f32 v137, v137, s36, v4
    v_fma_f32 v138, v138, s36, v4
    v_fma_f32 v139, v139, s36, v4
    v_fma_f32 v140, v140, s36, v4
    v_fma_f32 v141, v141, s36, v4
    v_fma_f32 v142, v142, s36, v4
    v_fma_f32 v143, v143, s36, v4
    v_rsq_f32 v136, v136
    v_rsq_f32 v137, v137
    v_rsq_f32 v138, v138
    v_rsq_f32 v139, v139
    v_rsq_f32 v140, v140
    v_rsq_f32 v141, v141
    v_rsq_f32 v142, v142
    v_rsq_f32 v143, v143
    v_lshlrev_b32 v152, 16, v88
    v_and_b32 v153, s37, v88
    v_lshlrev_b32 v154, 16, v89
    v_and_b32 v155, s37, v89
    v_lshlrev_b32 v156, 16, v90
    v_and_b32 v157, s37, v90
    v_lshlrev_b32 v158, 16, v91
    v_and_b32 v159, s37, v91
    v_lshlrev_b32 v160, 16, v92
    v_and_b32 v161, s37, v92
    v_lshlrev_b32 v162, 16, v93
    v_and_b32 v163, s37, v93
    v_lshlrev_b32 v164, 16, v94
    v_and_b32 v165, s37, v94
    v_lshlrev_b32 v166, 16, v95
    v_and_b32 v167, s37, v95
    v_pk_mul_f32 v[152:153], v[152:153], v[136:137]
    v_pk_mul_f32 v[154:155], v[154:155], v[138:139]
    v_cvt_pk_bf16_f32 v152, v152, v153
    v_cvt_pk_bf16_f32 v153, v154, v155
    ds_write_b64 v6, v[152:153] offset:0
    v_pk_mul_f32 v[156:157], v[156:157], v[136:137]
    v_pk_mul_f32 v[158:159], v[158:159], v[138:139]
    v_cvt_pk_bf16_f32 v156, v156, v157
    v_cvt_pk_bf16_f32 v157, v158, v159
    ds_write_b64 v6, v[156:157] offset:4096
    v_pk_mul_f32 v[160:161], v[160:161], v[140:141]
    v_pk_mul_f32 v[162:163], v[162:163], v[142:143]
    v_cvt_pk_bf16_f32 v160, v160, v161
    v_cvt_pk_bf16_f32 v161, v162, v163
    ds_write_b64 v6, v[160:161] offset:2048
    v_pk_mul_f32 v[164:165], v[164:165], v[140:141]
    v_pk_mul_f32 v[166:167], v[166:167], v[142:143]
    v_cvt_pk_bf16_f32 v164, v164, v165
    v_cvt_pk_bf16_f32 v165, v166, v167
    ds_write_b64 v6, v[164:165] offset:6144
    s_waitcnt lgkmcnt(0)
    s_barrier
    ds_read_b128 v[104:107], v7 offset:0
    ds_read_b128 v[108:111], v7 offset:1024
    ds_read_b128 v[112:115], v7 offset:4096
    ds_read_b128 v[116:119], v7 offset:5120
    ds_read_b128 v[120:123], v7 offset:2048
    ds_read_b128 v[124:127], v7 offset:3072
    ds_read_b128 v[128:131], v7 offset:6144
    ds_read_b128 v[132:135], v7 offset:7168
    s_waitcnt lgkmcnt(4)
    v_mfma_f32_16x16x32_bf16 v[136:139], v[104:107], v[8:11], 0
    v_mfma_f32_16x16x32_bf16 v[144:147], v[104:107], v[16:19], 0
    v_mfma_f32_16x16x32_bf16 v[136:139], v[112:115], v[24:27], v[136:139]
    v_mfma_f32_16x16x32_bf16 v[144:147], v[112:115], v[8:11], v[144:147]
    v_mfma_f32_16x16x32_bf16 v[136:139], v[108:111], v[12:15], v[136:139]
    v_mfma_f32_16x16x32_bf16 v[144:147], v[108:111], v[20:23], v[144:147]
    v_mfma_f32_16x16x32_bf16 v[136:139], v[116:119], v[28:31], v[136:139]
    v_mfma_f32_16x16x32_bf16 v[144:147], v[116:119], v[12:15], v[144:147]
    s_waitcnt lgkmcnt(0)
    v_mfma_f32_16x16x32_bf16 v[140:143], v[120:123], v[8:11], 0
    v_mfma_f32_16x16x32_bf16 v[148:151], v[120:123], v[16:19], 0
    v_mfma_f32_16x16x32_bf16 v[140:143], v[128:131], v[24:27], v[140:143]
    v_mfma_f32_16x16x32_bf16 v[148:151], v[128:131], v[8:11], v[148:151]
    v_mfma_f32_16x16x32_bf16 v[140:143], v[124:127], v[12:15], v[140:143]
    v_mfma_f32_16x16x32_bf16 v[148:151], v[124:127], v[20:23], v[148:151]
    v_mfma_f32_16x16x32_bf16 v[140:143], v[132:135], v[28:31], v[140:143]
    v_mfma_f32_16x16x32_bf16 v[148:151], v[132:135], v[12:15], v[148:151]
    s_nop 7
    v_mul_f32 v152, v136, v56
    v_mul_f32 v160, v136, v64
    v_mul_f32 v153, v137, v57
    v_mul_f32 v161, v137, v65
    v_mul_f32 v154, v138, v58
    v_mul_f32 v162, v138, v66
    v_mul_f32 v155, v139, v59
    v_mul_f32 v163, v139, v67
    v_mul_f32 v156, v140, v60
    v_mul_f32 v164, v140, v68
    v_mul_f32 v157, v141, v61
    v_mul_f32 v165, v141, v69
    v_mul_f32 v158, v142, v62
    v_mul_f32 v166, v142, v70
    v_mul_f32 v159, v143, v63
    v_mul_f32 v167, v143, v71
    v_fma_f32 v152, -v144, v64, v152
    v_fmac_f32 v160, v144, v56
    v_fma_f32 v153, -v145, v65, v153
    v_fmac_f32 v161, v145, v57
    v_fma_f32 v154, -v146, v66, v154
    v_fmac_f32 v162, v146, v58
    v_fma_f32 v155, -v147, v67, v155
    v_fmac_f32 v163, v147, v59
    v_fma_f32 v156, -v148, v68, v156
    v_fmac_f32 v164, v148, v60
    v_fma_f32 v157, -v149, v69, v157
    v_fmac_f32 v165, v149, v61
    v_fma_f32 v158, -v150, v70, v158
    v_fmac_f32 v166, v150, v62
    v_fma_f32 v159, -v151, v71, v159
    v_fmac_f32 v167, v151, v63
    v_cvt_pk_bf16_f32 v104, v152, v153
    v_cvt_pk_bf16_f32 v108, v160, v161
    v_cvt_pk_bf16_f32 v105, v154, v155
    v_cvt_pk_bf16_f32 v109, v162, v163
    v_cvt_pk_bf16_f32 v106, v156, v157
    v_cvt_pk_bf16_f32 v110, v164, v165
    v_cvt_pk_bf16_f32 v107, v158, v159
    v_cvt_pk_bf16_f32 v111, v166, v167
    s_nop 1
    v_mfma_f32_16x16x32_bf16 v[136:139], v[32:35], v[104:107], 0
    v_mfma_f32_16x16x32_bf16 v[144:147], v[40:43], v[104:107], 0
    v_mfma_f32_16x16x32_bf16 v[136:139], v[48:51], v[108:111], v[136:139]
    v_mfma_f32_16x16x32_bf16 v[144:147], v[32:35], v[108:111], v[144:147]
    v_mfma_f32_16x16x32_bf16 v[140:143], v[36:39], v[104:107], 0
    v_mfma_f32_16x16x32_bf16 v[148:151], v[44:47], v[104:107], 0
    v_mfma_f32_16x16x32_bf16 v[140:143], v[52:55], v[108:111], v[140:143]
    v_mfma_f32_16x16x32_bf16 v[148:151], v[36:39], v[108:111], v[148:151]
    s_waitcnt vmcnt(0)
    v_lshlrev_b32 v112, 16, v96
    v_and_b32 v120, s37, v96
    v_lshlrev_b32 v113, 16, v97
    v_and_b32 v121, s37, v97
    v_lshlrev_b32 v114, 16, v98
    v_and_b32 v122, s37, v98
    v_lshlrev_b32 v115, 16, v99
    v_and_b32 v123, s37, v99
    v_lshlrev_b32 v116, 16, v100
    v_and_b32 v124, s37, v100
    v_lshlrev_b32 v117, 16, v101
    v_and_b32 v125, s37, v101
    v_lshlrev_b32 v118, 16, v102
    v_and_b32 v126, s37, v102
    v_lshlrev_b32 v119, 16, v103
    v_and_b32 v127, s37, v103
    v_mul_f32 v152, v136, v112
    v_mul_f32 v160, v136, v120
    v_mul_f32 v153, v137, v113
    v_mul_f32 v161, v137, v121
    v_mul_f32 v154, v138, v114
    v_mul_f32 v162, v138, v122
    v_mul_f32 v155, v139, v115
    v_mul_f32 v163, v139, v123
    v_mul_f32 v156, v140, v116
    v_mul_f32 v164, v140, v124
    v_mul_f32 v157, v141, v117
    v_mul_f32 v165, v141, v125
    v_mul_f32 v158, v142, v118
    v_mul_f32 v166, v142, v126
    v_mul_f32 v159, v143, v119
    v_mul_f32 v167, v143, v127
    v_fma_f32 v152, -v144, v120, v152
    v_fmac_f32 v160, v144, v112
    v_fma_f32 v153, -v145, v121, v153
    v_fmac_f32 v161, v145, v113
    v_fma_f32 v154, -v146, v122, v154
    v_fmac_f32 v162, v146, v114
    v_fma_f32 v155, -v147, v123, v155
    v_fmac_f32 v163, v147, v115
    v_fma_f32 v156, -v148, v124, v156
    v_fmac_f32 v164, v148, v116
    v_fma_f32 v157, -v149, v125, v157
    v_fmac_f32 v165, v149, v117
    v_fma_f32 v158, -v150, v126, v158
    v_fmac_f32 v166, v150, v118
    v_fma_f32 v159, -v151, v127, v159
    v_fmac_f32 v167, v151, v119
    v_cvt_pk_bf16_f32 v104, v152, v153
    v_cvt_pk_bf16_f32 v108, v160, v161
    v_cvt_pk_bf16_f32 v105, v154, v155
    v_cvt_pk_bf16_f32 v109, v162, v163
    v_cvt_pk_bf16_f32 v106, v156, v157
    v_cvt_pk_bf16_f32 v110, v164, v165
    v_cvt_pk_bf16_f32 v107, v158, v159
    v_cvt_pk_bf16_f32 v111, v166, v167
    s_nop 1
    v_mfma_f32_16x16x32_bf16 v[136:139], v[104:107], v[32:35], 0
    v_mfma_f32_16x16x32_bf16 v[144:147], v[104:107], v[48:51], 0
    v_mfma_f32_16x16x32_bf16 v[136:139], v[108:111], v[40:43], v[136:139]
    v_mfma_f32_16x16x32_bf16 v[144:147], v[108:111], v[32:35], v[144:147]
    v_mfma_f32_16x16x32_bf16 v[140:143], v[104:107], v[36:39], 0
    v_mfma_f32_16x16x32_bf16 v[148:151], v[104:107], v[52:55], 0
    v_mfma_f32_16x16x32_bf16 v[140:143], v[108:111], v[44:47], v[140:143]
    v_mfma_f32_16x16x32_bf16 v[148:151], v[108:111], v[36:39], v[148:151]
    s_nop 7
    v_mul_f32 v152, v136, v72
    v_mul_f32 v160, v136, v80
    v_mul_f32 v153, v137, v73
    v_mul_f32 v161, v137, v81
    v_mul_f32 v154, v138, v74
    v_mul_f32 v162, v138, v82
    v_mul_f32 v155, v139, v75
    v_mul_f32 v163, v139, v83
    v_mul_f32 v156, v140, v76
    v_mul_f32 v164, v140, v84
    v_mul_f32 v157, v141, v77
    v_mul_f32 v165, v141, v85
    v_mul_f32 v158, v142, v78
    v_mul_f32 v166, v142, v86
    v_mul_f32 v159, v143, v79
    v_mul_f32 v167, v143, v87
    v_fma_f32 v152, -v144, v80, v152
    v_fmac_f32 v160, v144, v72
    v_fma_f32 v153, -v145, v81, v153
    v_fmac_f32 v161, v145, v73
    v_fma_f32 v154, -v146, v82, v154
    v_fmac_f32 v162, v146, v74
    v_fma_f32 v155, -v147, v83, v155
    v_fmac_f32 v163, v147, v75
    v_fma_f32 v156, -v148, v84, v156
    v_fmac_f32 v164, v148, v76
    v_fma_f32 v157, -v149, v85, v157
    v_fmac_f32 v165, v149, v77
    v_fma_f32 v158, -v150, v86, v158
    v_fmac_f32 v166, v150, v78
    v_fma_f32 v159, -v151, v87, v159
    v_fmac_f32 v167, v151, v79
    v_cvt_pk_bf16_f32 v104, v152, v153
    v_cvt_pk_bf16_f32 v108, v160, v161
    v_cvt_pk_bf16_f32 v105, v154, v155
    v_cvt_pk_bf16_f32 v109, v162, v163
    v_cvt_pk_bf16_f32 v106, v156, v157
    v_cvt_pk_bf16_f32 v110, v164, v165
    v_cvt_pk_bf16_f32 v107, v158, v159
    v_cvt_pk_bf16_f32 v111, v166, v167
    s_nop 1
    ds_write_b64 v6, v[104:105] offset:8192
    ds_write_b64 v6, v[108:109] offset:12288
    ds_write_b64 v6, v[106:107] offset:10240
    ds_write_b64 v6, v[110:111] offset:14336
    s_waitcnt lgkmcnt(0)
    s_barrier
    ds_read_b128 v[104:107], v7 offset:8192
    ds_read_b128 v[108:111], v7 offset:9216
    ds_read_b128 v[112:115], v7 offset:12288
    ds_read_b128 v[116:119], v7 offset:13312
    ds_read_b128 v[120:123], v7 offset:10240
    ds_read_b128 v[124:127], v7 offset:11264
    ds_read_b128 v[128:131], v7 offset:14336
    ds_read_b128 v[132:135], v7 offset:15360
    v_lshlrev_b32 v152, 16, v88
    v_and_b32 v153, s37, v88
    v_lshlrev_b32 v154, 16, v89
    v_and_b32 v155, s37, v89
    v_lshlrev_b32 v156, 16, v90
    v_and_b32 v157, s37, v90
    v_lshlrev_b32 v158, 16, v91
    v_and_b32 v159, s37, v91
    v_lshlrev_b32 v160, 16, v92
    v_and_b32 v161, s37, v92
    v_lshlrev_b32 v162, 16, v93
    v_and_b32 v163, s37, v93
    v_lshlrev_b32 v164, 16, v94
    v_and_b32 v165, s37, v94
    v_lshlrev_b32 v166, 16, v95
    v_and_b32 v167, s37, v95
    s_waitcnt lgkmcnt(4)
    v_mfma_f32_16x16x32_bf16 v[136:139], v[8:11], v[104:107], 0
    v_mfma_f32_16x16x32_bf16 v[144:147], v[24:27], v[104:107], 0
    v_mfma_f32_16x16x32_bf16 v[136:139], v[16:19], v[112:115], v[136:139]
    v_mfma_f32_16x16x32_bf16 v[144:147], v[8:11], v[112:115], v[144:147]
    v_mfma_f32_16x16x32_bf16 v[136:139], v[12:15], v[108:111], v[136:139]
    v_mfma_f32_16x16x32_bf16 v[144:147], v[28:31], v[108:111], v[144:147]
    v_mfma_f32_16x16x32_bf16 v[136:139], v[20:23], v[116:119], v[136:139]
    v_mfma_f32_16x16x32_bf16 v[144:147], v[12:15], v[116:119], v[144:147]
    s_waitcnt lgkmcnt(0)
    v_mfma_f32_16x16x32_bf16 v[140:143], v[8:11], v[120:123], 0
    v_mfma_f32_16x16x32_bf16 v[148:151], v[24:27], v[120:123], 0
    v_mfma_f32_16x16x32_bf16 v[140:143], v[16:19], v[128:131], v[140:143]
    v_mfma_f32_16x16x32_bf16 v[148:151], v[8:11], v[128:131], v[148:151]
    v_mfma_f32_16x16x32_bf16 v[140:143], v[12:15], v[124:127], v[140:143]
    v_mfma_f32_16x16x32_bf16 v[148:151], v[28:31], v[124:127], v[148:151]
    v_mfma_f32_16x16x32_bf16 v[140:143], v[20:23], v[132:135], v[140:143]
    v_mfma_f32_16x16x32_bf16 v[148:151], v[12:15], v[132:135], v[148:151]
    s_mov_b32 s36, 0x3a000000
    s_cmp_eq_u32 s27, 0
    s_cselect_b32 s37, 0, s36
    s_nop 5
    v_fmac_f32 v152, s36, v136
    v_fmac_f32 v153, s36, v137
    v_fmac_f32 v154, s36, v138
    v_fmac_f32 v155, s36, v139
    v_cvt_pk_bf16_f32 v152, v152, v153
    v_cvt_pk_bf16_f32 v153, v154, v155
    buffer_store_dwordx2 v[152:153], v3, s[4:7], s28 offen offset:0 sc1
    v_fmac_f32 v156, s37, v144
    v_fmac_f32 v157, s37, v145
    v_fmac_f32 v158, s37, v146
    v_fmac_f32 v159, s37, v147
    v_cvt_pk_bf16_f32 v156, v156, v157
    v_cvt_pk_bf16_f32 v157, v158, v159
    buffer_store_dwordx2 v[156:157], v3, s[4:7], s28 offen offset:32 sc1
    v_fmac_f32 v160, s36, v140
    v_fmac_f32 v161, s36, v141
    v_fmac_f32 v162, s36, v142
    v_fmac_f32 v163, s36, v143
    v_cvt_pk_bf16_f32 v160, v160, v161
    v_cvt_pk_bf16_f32 v161, v162, v163
    buffer_store_dwordx2 v[160:161], v3, s[4:7], s29 offen offset:0 sc1
    v_fmac_f32 v164, s37, v148
    v_fmac_f32 v165, s37, v149
    v_fmac_f32 v166, s37, v150
    v_fmac_f32 v167, s37, v151
    v_cvt_pk_bf16_f32 v164, v164, v165
    v_cvt_pk_bf16_f32 v165, v166, v167
    buffer_store_dwordx2 v[164:165], v3, s[4:7], s29 offen offset:32 sc1
    s_endpgm
J_k6_kernel_2:
    s_mov_b32 s28, s18
    s_and_b32 s29, s19, 0xffff
    s_mov_b32 s30, 819200
    s_mov_b32 s31, 0x00020000
    s_lshl_b32 s32, s26, 2
    s_add_u32 s32, s32, s3
    s_mul_i32 s27, s32, 205
    s_lshr_b32 s27, s27, 11
    s_mul_i32 s36, s27, 10
    s_sub_u32 s32, s32, s36
    s_lshl_b32 s32, s32, 6
    v_add_u32 v1, s32, v0
    v_lshlrev_b32 v2, 1, v1
    v_lshrrev_b32 v3, 4, v1
    v_mul_u32_u24 v3, 20480, v3
    v_and_b32 v4, 15, v1
    v_lshl_add_u32 v3, v4, 4, v3
    s_cmp_ge_u32 s27, 16
    s_cbranch_scc1 L_k6_kernel_5
    s_mul_i32 s34, s27, 51200
    s_add_u32 s35, s34, 0
    buffer_load_ushort v8, v2, s[28:31], s35 offen
    s_add_u32 s35, s34, 1280
    buffer_load_ushort v9, v2, s[28:31], s35 offen
    s_add_u32 s35, s34, 2560
    buffer_load_ushort v10, v2, s[28:31], s35 offen
    s_add_u32 s35, s34, 3840
    buffer_load_ushort v11, v2, s[28:31], s35 offen
    s_add_u32 s35, s34, 10240
    buffer_load_ushort v12, v2, s[28:31], s35 offen
    s_add_u32 s35, s34, 11520
    buffer_load_ushort v13, v2, s[28:31], s35 offen
    s_add_u32 s35, s34, 12800
    buffer_load_ushort v14, v2, s[28:31], s35 offen
    s_add_u32 s35, s34, 14080
    buffer_load_ushort v15, v2, s[28:31], s35 offen
    s_add_u32 s35, s34, 5120
    buffer_load_ushort v16, v2, s[28:31], s35 offen
    s_add_u32 s35, s34, 6400
    buffer_load_ushort v17, v2, s[28:31], s35 offen
    s_add_u32 s35, s34, 7680
    buffer_load_ushort v18, v2, s[28:31], s35 offen
    s_add_u32 s35, s34, 8960
    buffer_load_ushort v19, v2, s[28:31], s35 offen
    s_add_u32 s35, s34, 15360
    buffer_load_ushort v20, v2, s[28:31], s35 offen
    s_add_u32 s35, s34, 16640
    buffer_load_ushort v21, v2, s[28:31], s35 offen
    s_add_u32 s35, s34, 17920
    buffer_load_ushort v22, v2, s[28:31], s35 offen
    s_add_u32 s35, s34, 19200
    buffer_load_ushort v23, v2, s[28:31], s35 offen
    s_add_u32 s35, s34, 25600
    buffer_load_ushort v24, v2, s[28:31], s35 offen
    s_add_u32 s35, s34, 26880
    buffer_load_ushort v25, v2, s[28:31], s35 offen
    s_add_u32 s35, s34, 28160
    buffer_load_ushort v26, v2, s[28:31], s35 offen
    s_add_u32 s35, s34, 29440
    buffer_load_ushort v27, v2, s[28:31], s35 offen
    s_add_u32 s35, s34, 35840
    buffer_load_ushort v28, v2, s[28:31], s35 offen
    s_add_u32 s35, s34, 37120
    buffer_load_ushort v29, v2, s[28:31], s35 offen
    s_add_u32 s35, s34, 38400
    buffer_load_ushort v30, v2, s[28:31], s35 offen
    s_add_u32 s35, s34, 39680
    buffer_load_ushort v31, v2, s[28:31], s35 offen
    s_add_u32 s35, s34, 30720
    buffer_load_ushort v32, v2, s[28:31], s35 offen
    s_add_u32 s35, s34, 32000
    buffer_load_ushort v33, v2, s[28:31], s35 offen
    s_add_u32 s35, s34, 33280
    buffer_load_ushort v34, v2, s[28:31], s35 offen
    s_add_u32 s35, s34, 34560
    buffer_load_ushort v35, v2, s[28:31], s35 offen
    s_add_u32 s35, s34, 40960
    buffer_load_ushort v36, v2, s[28:31], s35 offen
    s_add_u32 s35, s34, 42240
    buffer_load_ushort v37, v2, s[28:31], s35 offen
    s_add_u32 s35, s34, 43520
    buffer_load_ushort v38, v2, s[28:31], s35 offen
    s_add_u32 s35, s34, 44800
    buffer_load_ushort v39, v2, s[28:31], s35 offen
    s_branch L_k6_kernel_6
L_k6_kernel_5:
    s_sub_u32 s34, s27, 16
    s_mul_i32 s34, s34, 204800
    s_add_u32 s35, s34, 20480
    buffer_load_ushort v8, v2, s[28:31], s35 offen
    s_add_u32 s35, s34, 21760
    buffer_load_ushort v9, v2, s[28:31], s35 offen
    s_add_u32 s35, s34, 23040
    buffer_load_ushort v10, v2, s[28:31], s35 offen
    s_add_u32 s35, s34, 24320
    buffer_load_ushort v11, v2, s[28:31], s35 offen
    s_add_u32 s35, s34, 122880
    buffer_load_ushort v12, v2, s[28:31], s35 offen
    s_add_u32 s35, s34, 124160
    buffer_load_ushort v13, v2, s[28:31], s35 offen
    s_add_u32 s35, s34, 125440
    buffer_load_ushort v14, v2, s[28:31], s35 offen
    s_add_u32 s35, s34, 126720
    buffer_load_ushort v15, v2, s[28:31], s35 offen
    s_add_u32 s35, s34, 46080
    buffer_load_ushort v16, v2, s[28:31], s35 offen
    s_add_u32 s35, s34, 47360
    buffer_load_ushort v17, v2, s[28:31], s35 offen
    s_add_u32 s35, s34, 48640
    buffer_load_ushort v18, v2, s[28:31], s35 offen
    s_add_u32 s35, s34, 49920
    buffer_load_ushort v19, v2, s[28:31], s35 offen
    s_add_u32 s35, s34, 148480
    buffer_load_ushort v20, v2, s[28:31], s35 offen
    s_add_u32 s35, s34, 149760
    buffer_load_ushort v21, v2, s[28:31], s35 offen
    s_add_u32 s35, s34, 151040
    buffer_load_ushort v22, v2, s[28:31], s35 offen
    s_add_u32 s35, s34, 152320
    buffer_load_ushort v23, v2, s[28:31], s35 offen
    s_add_u32 s35, s34, 71680
    buffer_load_ushort v24, v2, s[28:31], s35 offen
    s_add_u32 s35, s34, 72960
    buffer_load_ushort v25, v2, s[28:31], s35 offen
    s_add_u32 s35, s34, 74240
    buffer_load_ushort v26, v2, s[28:31], s35 offen
    s_add_u32 s35, s34, 75520
    buffer_load_ushort v27, v2, s[28:31], s35 offen
    s_add_u32 s35, s34, 174080
    buffer_load_ushort v28, v2, s[28:31], s35 offen
    s_add_u32 s35, s34, 175360
    buffer_load_ushort v29, v2, s[28:31], s35 offen
    s_add_u32 s35, s34, 176640
    buffer_load_ushort v30, v2, s[28:31], s35 offen
    s_add_u32 s35, s34, 177920
    buffer_load_ushort v31, v2, s[28:31], s35 offen
    s_add_u32 s35, s34, 97280
    buffer_load_ushort v32, v2, s[28:31], s35 offen
    s_add_u32 s35, s34, 98560
    buffer_load_ushort v33, v2, s[28:31], s35 offen
    s_add_u32 s35, s34, 99840
    buffer_load_ushort v34, v2, s[28:31], s35 offen
    s_add_u32 s35, s34, 101120
    buffer_load_ushort v35, v2, s[28:31], s35 offen
    s_add_u32 s35, s34, 199680
    buffer_load_ushort v36, v2, s[28:31], s35 offen
    s_add_u32 s35, s34, 200960
    buffer_load_ushort v37, v2, s[28:31], s35 offen
    s_add_u32 s35, s34, 202240
    buffer_load_ushort v38, v2, s[28:31], s35 offen
    s_add_u32 s35, s34, 203520
    buffer_load_ushort v39, v2, s[28:31], s35 offen
L_k6_kernel_6:
    s_lshl_b32 s34, s27, 10
    s_add_u32 s34, s34, 10485760
    s_waitcnt vmcnt(0)
    v_lshl_or_b32 v40, v9, 16, v8
    v_lshl_or_b32 v41, v11, 16, v10
    v_lshl_or_b32 v42, v13, 16, v12
    v_lshl_or_b32 v43, v15, 16, v14
    v_lshl_or_b32 v44, v17, 16, v16
    v_lshl_or_b32 v45, v19, 16, v18
    v_lshl_or_b32 v46, v21, 16, v20
    v_lshl_or_b32 v47, v23, 16, v22
    v_lshl_or_b32 v48, v25, 16, v24
    v_lshl_or_b32 v49, v27, 16, v26
    v_lshl_or_b32 v50, v29, 16, v28
    v_lshl_or_b32 v51, v31, 16, v30
    v_lshl_or_b32 v52, v33, 16, v32
    v_lshl_or_b32 v53, v35, 16, v34
    v_lshl_or_b32 v54, v37, 16, v36
    v_lshl_or_b32 v55, v39, 16, v38
    buffer_store_dwordx4 v[40:43], v3, s[4:7], s34 offen offset:0 sc1
    buffer_store_dwordx4 v[44:47], v3, s[4:7], s34 offen offset:256 sc1
    buffer_store_dwordx4 v[48:51], v3, s[4:7], s34 offen offset:512 sc1
    buffer_store_dwordx4 v[52:55], v3, s[4:7], s34 offen offset:768 sc1
    s_endpgm
J_k6_kernel_3:
    s_lshl_b32 s32, s26, 2
    s_add_u32 s32, s32, s3
    s_mul_i32 s27, s32, 205
    s_lshr_b32 s27, s27, 11
    s_mul_i32 s36, s27, 10
    s_sub_u32 s32, s32, s36
    s_lshl_b32 s32, s32, 6
    v_add_u32 v1, s32, v0
    v_lshrrev_b32 v3, 4, v1
    v_mul_u32_u24 v4, 205, v3
    v_lshrrev_b32 v4, 11, v4
    v_mul_u32_u24 v4, 194560, v4
    v_lshl_add_u32 v3, v3, 10, v4
    v_and_b32 v4, 15, v1
    v_lshl_add_u32 v3, v4, 4, v3
    v_cvt_f32_u32 v2, v1
    v_mul_f32 v2, 0x3acccccd, v2
    s_mul_i32 s33, s27, 52
    s_lshr_b32 s33, s33, 8
    s_mul_i32 s34, s33, 5
    s_sub_u32 s34, s27, s34
    s_lshl_b32 s34, s34, 6
    s_add_u32 s34, s34, s33
    v_cvt_f32_u32 v4, s34
    v_mul_f32 v4, v4, v2
    s_mov_b32 s40, 0x3d64f92e
    v_fmamk_f32 v5, v2, 0x00000000, v4
    v_fract_f32 v5, v5
    v_cos_f32 v6, v5
    v_sin_f32_e64 v7, -v5
    v_mul_f32 v6, s40, v6
    v_mul_f32 v7, s40, v7
    v_cvt_pk_bf16_f32 v8, v6, v7
    v_fmamk_f32 v5, v2, 0x40800000, v4
    v_fract_f32 v5, v5
    v_cos_f32 v6, v5
    v_sin_f32_e64 v7, -v5
    v_mul_f32 v6, s40, v6
    v_mul_f32 v7, s40, v7
    v_cvt_pk_bf16_f32 v9, v6, v7
    v_fmamk_f32 v5, v2, 0x41000000, v4
    v_fract_f32 v5, v5
    v_cos_f32 v6, v5
    v_sin_f32_e64 v7, -v5
    v_mul_f32 v6, s40, v6
    v_mul_f32 v7, s40, v7
    v_cvt_pk_bf16_f32 v10, v6, v7
    v_fmamk_f32 v5, v2, 0x41400000, v4
    v_fract_f32 v5, v5
    v_cos_f32 v6, v5
    v_sin_f32_e64 v7, -v5
    v_mul_f32 v6, s40, v6
    v_mul_f32 v7, s40, v7
    v_cvt_pk_bf16_f32 v11, v6, v7
    v_fmamk_f32 v5, v2, 0x41800000, v4
    v_fract_f32 v5, v5
    v_cos_f32 v6, v5
    v_sin_f32_e64 v7, -v5
    v_mul_f32 v6, s40, v6
    v_mul_f32 v7, s40, v7
    v_cvt_pk_bf16_f32 v12, v6, v7
    v_fmamk_f32 v5, v2, 0x41a00000, v4
    v_fract_f32 v5, v5
    v_cos_f32 v6, v5
    v_sin_f32_e64 v7, -v5
    v_mul_f32 v6, s40, v6
    v_mul_f32 v7, s40, v7
    v_cvt_pk_bf16_f32 v13, v6, v7
    v_fmamk_f32 v5, v2, 0x41c00000, v4
    v_fract_f32 v5, v5
    v_cos_f32 v6, v5
    v_sin_f32_e64 v7, -v5
    v_mul_f32 v6, s40, v6
    v_mul_f32 v7, s40, v7
    v_cvt_pk_bf16_f32 v14, v6, v7
    v_fmamk_f32 v5, v2, 0x41e00000, v4
    v_fract_f32 v5, v5
    v_cos_f32 v6, v5
    v_sin_f32_e64 v7, -v5
    v_mul_f32 v6, s40, v6
    v_mul_f32 v7, s40, v7
    v_cvt_pk_bf16_f32 v15, v6, v7
    v_fmamk_f32 v5, v2, 0x42000000, v4
    v_fract_f32 v5, v5
    v_cos_f32 v6, v5
    v_sin_f32_e64 v7, -v5
    v_mul_f32 v6, s40, v6
    v_mul_f32 v7, s40, v7
    v_cvt_pk_bf16_f32 v16, v6, v7
    v_fmamk_f32 v5, v2, 0x42100000, v4
    v_fract_f32 v5, v5
    v_cos_f32 v6, v5
    v_sin_f32_e64 v7, -v5
    v_mul_f32 v6, s40, v6
    v_mul_f32 v7, s40, v7
    v_cvt_pk_bf16_f32 v17, v6, v7
    v_fmamk_f32 v5, v2, 0x42200000, v4
    v_fract_f32 v5, v5
    v_cos_f32 v6, v5
    v_sin_f32_e64 v7, -v5
    v_mul_f32 v6, s40, v6
    v_mul_f32 v7, s40, v7
    v_cvt_pk_bf16_f32 v18, v6, v7
    v_fmamk_f32 v5, v2, 0x42300000, v4
    v_fract_f32 v5, v5
    v_cos_f32 v6, v5
    v_sin_f32_e64 v7, -v5
    v_mul_f32 v6, s40, v6
    v_mul_f32 v7, s40, v7
    v_cvt_pk_bf16_f32 v19, v6, v7
    v_fmamk_f32 v5, v2, 0x42400000, v4
    v_fract_f32 v5, v5
    v_cos_f32 v6, v5
    v_sin_f32_e64 v7, -v5
    v_mul_f32 v6, s40, v6
    v_mul_f32 v7, s40, v7
    v_cvt_pk_bf16_f32 v20, v6, v7
    v_fmamk_f32 v5, v2, 0x42500000, v4
    v_fract_f32 v5, v5
    v_cos_f32 v6, v5
    v_sin_f32_e64 v7, -v5
    v_mul_f32 v6, s40, v6
    v_mul_f32 v7, s40, v7
    v_cvt_pk_bf16_f32 v21, v6, v7
    v_fmamk_f32 v5, v2, 0x42600000, v4
    v_fract_f32 v5, v5
    v_cos_f32 v6, v5
    v_sin_f32_e64 v7, -v5
    v_mul_f32 v6, s40, v6
    v_mul_f32 v7, s40, v7
    v_cvt_pk_bf16_f32 v22, v6, v7
    v_fmamk_f32 v5, v2, 0x42700000, v4
    v_fract_f32 v5, v5
    v_cos_f32 v6, v5
    v_sin_f32_e64 v7, -v5
    v_mul_f32 v6, s40, v6
    v_mul_f32 v7, s40, v7
    v_cvt_pk_bf16_f32 v23, v6, v7
    s_cmp_lg_u32 s27, 0
    s_cbranch_scc1 L_k6_kernel_7
    v_lshlrev_b32 v5, 31, v1
    v_mov_b32 v7, 0x3d21e89b
    v_xor_b32 v6, v5, v7
    v_cvt_pk_bf16_f32 v8, v6, v7
L_k6_kernel_7:
    s_mul_i32 s34, s27, 10240
    s_add_u32 s34, s34, 8749056
    buffer_store_dwordx4 v[8:11], v3, s[4:7], s34 offen offset:0 sc1
    buffer_store_dwordx4 v[12:15], v3, s[4:7], s34 offen offset:256 sc1
    buffer_store_dwordx4 v[16:19], v3, s[4:7], s34 offen offset:512 sc1
    buffer_store_dwordx4 v[20:23], v3, s[4:7], s34 offen offset:768 sc1
    s_endpgm

.globl k7_kernel
.p2align 8
.type k7_kernel,@function
k7_kernel:
    s_cmp_lt_u32 s2, 256
    s_cbranch_scc1 L_k7_kernel_1
    s_endpgm
L_k7_kernel_1:
    s_load_dwordx16 s[8:23], s[0:1], 0
    s_load_dwordx2 s[24:25], s[0:1], 64
    v_lshrrev_b32 v1, 6, v0
    v_and_b32 v0, 63, v0
    s_nop 0
    v_readfirstlane_b32 s3, v1
    s_waitcnt lgkmcnt(0)
    s_mov_b32 s4, s24
    s_and_b32 s5, s25, 0xffff
    s_mov_b32 s6, 30408704
    s_mov_b32 s7, 0x00020000
    s_and_b32 s27, s2, 7
    s_lshr_b32 s28, s2, 3
    s_lshr_b32 s29, s27, 1
    s_lshl_b32 s29, s29, 2
    s_and_b32 s30, s28, 3
    s_or_b32 s29, s29, s30
    s_and_b32 s27, s27, 1
    s_lshr_b32 s28, s28, 2
    s_mul_i32 s30, s27, 6
    s_lshl_b32 s31, s27, 1
    s_add_u32 s31, s31, 6
    s_cmp_lt_u32 s28, 6
    s_cselect_b32 s30, s30, s31
    s_add_u32 s28, s28, s30
    s_mov_b32 s27, s29
    v_lshrrev_b32 v2, 4, v0
    v_lshlrev_b32 v5, 4, v0
    s_cmp_lt_u32 s3, 4
    s_cbranch_scc1 L_k7_kernel_3
    s_sub_u32 s33, s3, 4
    v_and_b32 v3, 1, v2
    v_lshlrev_b32 v3, 7, v3
    v_xor_b32 v3, v3, v5
    v_add_u32 v4, 18560, v3
    s_lshl_b32 s37, s33, 12
    s_mul_i32 s36, s33, 5120
    s_lshl_b32 s31, s27, 3
    s_lshl_b32 s33, s33, 1
    s_add_u32 s31, s31, s33
    s_mul_i32 s31, s31, 20608
    s_add_u32 s31, s31, 0
    s_mul_i32 s32, s28, 204800
    s_add_u32 s32, s32, s36
    s_add_u32 s32, s32, 6291456
    s_add_u32 s36, s36, 16384
    v_lshrrev_b32 v6, 1, v0
    v_cmp_eq_u32 vcc, 1, v6
    s_cmp_ge_u32 s28, 12
    s_cselect_b32 s38, 20448, 0
    v_mov_b32 v6, s38
    v_cndmask_b32 v6, 0, v6, vcc
    v_add_u32 v7, v4, v6
    v_add_u32 v6, v3, v6
    s_add_u32 m0, s37, 0
    s_add_u32 s38, s36, 0
    buffer_load_dwordx4 v6, s[4:7], s31 offen lds
    buffer_load_dwordx4 v3, s[4:7], s31 offen offset:1024 lds
    buffer_load_dwordx4 v7, s[4:7], s31 offen offset:2048 lds
    buffer_load_dwordx4 v4, s[4:7], s31 offen offset:3072 lds
    s_mov_b32 m0, s38
    s_add_u32 s31, s31, 2048
    buffer_load_dwordx4 v5, s[4:7], s32 offen lds
    buffer_load_dwordx4 v5, s[4:7], s32 offen offset:1024 lds
    buffer_load_dwordx4 v5, s[4:7], s32 offen offset:2048 lds
    buffer_load_dwordx4 v5, s[4:7], s32 offen offset:3072 lds
    s_add_u32 m0, s38, 1024
    s_add_u32 s39, s32, 1024
    buffer_load_dwordx4 v5, s[4:7], s39 offen offset:3072 lds
    s_add_u32 s32, s32, 20480
    s_add_u32 m0, s37, 36864
    s_add_u32 s38, s36, 36864
    buffer_load_dwordx4 v3, s[4:7], s31 offen lds
    buffer_load_dwordx4 v3, s[4:7], s31 offen offset:1024 lds
    buffer_load_dwordx4 v4, s[4:7], s31 offen offset:2048 lds
    buffer_load_dwordx4 v4, s[4:7], s31 offen offset:3072 lds
    s_mov_b32 m0, s38
    s_add_u32 s31, s31, 2048
    buffer_load_dwordx4 v5, s[4:7], s32 offen lds
    buffer_load_dwordx4 v5, s[4:7], s32 offen offset:1024 lds
    buffer_load_dwordx4 v5, s[4:7], s32 offen offset:2048 lds
    buffer_load_dwordx4 v5, s[4:7], s32 offen offset:3072 lds
    s_add_u32 m0, s38, 1024
    s_add_u32 s39, s32, 1024
    buffer_load_dwordx4 v5, s[4:7], s39 offen offset:3072 lds
    s_add_u32 s32, s32, 20480
    s_waitcnt vmcnt(9)
    s_barrier
    s_add_u32 m0, s37, 73728
    s_add_u32 s38, s36, 73728
    buffer_load_dwordx4 v3, s[4:7], s31 offen lds
    buffer_load_dwordx4 v3, s[4:7], s31 offen offset:1024 lds
    buffer_load_dwordx4 v4, s[4:7], s31 offen offset:2048 lds
    buffer_load_dwordx4 v4, s[4:7], s31 offen offset:3072 lds
    s_mov_b32 m0, s38
    s_add_u32 s31, s31, 2048
    buffer_load_dwordx4 v5, s[4:7], s32 offen lds
    buffer_load_dwordx4 v5, s[4:7], s32 offen offset:1024 lds
    buffer_load_dwordx4 v5, s[4:7], s32 offen offset:2048 lds
    buffer_load_dwordx4 v5, s[4:7], s32 offen offset:3072 lds
    s_add_u32 m0, s38, 1024
    s_add_u32 s39, s32, 1024
    buffer_load_dwordx4 v5, s[4:7], s39 offen offset:3072 lds
    s_add_u32 s32, s32, 20480
    s_waitcnt vmcnt(9)
    s_barrier
    s_add_u32 m0, s37, 110592
    s_add_u32 s38, s36, 110592
    buffer_load_dwordx4 v3, s[4:7], s31 offen lds
    buffer_load_dwordx4 v3, s[4:7], s31 offen offset:1024 lds
    buffer_load_dwordx4 v4, s[4:7], s31 offen offset:2048 lds
    buffer_load_dwordx4 v4, s[4:7], s31 offen offset:3072 lds
    s_mov_b32 m0, s38
    s_add_u32 s31, s31, 2048
    buffer_load_dwordx4 v5, s[4:7], s32 offen lds
    buffer_load_dwordx4 v5, s[4:7], s32 offen offset:1024 lds
    buffer_load_dwordx4 v5, s[4:7], s32 offen offset:2048 lds
    buffer_load_dwordx4 v5, s[4:7], s32 offen offset:3072 lds
    s_add_u32 m0, s38, 1024
    s_add_u32 s39, s32, 1024
    buffer_load_dwordx4 v5, s[4:7], s39 offen offset:3072 lds
    s_add_u32 s32, s32, 20480
    s_waitcnt vmcnt(9)
    s_barrier
    s_add_u32 m0, s37, 0
    s_add_u32 s38, s36, 0
    buffer_load_dwordx4 v3, s[4:7], s31 offen lds
    buffer_load_dwordx4 v3, s[4:7], s31 offen offset:1024 lds
    buffer_load_dwordx4 v4, s[4:7], s31 offen offset:2048 lds
    buffer_load_dwordx4 v4, s[4:7], s31 offen offset:3072 lds
    s_mov_b32 m0, s38
    s_add_u32 s31, s31, 2048
    buffer_load_dwordx4 v5, s[4:7], s32 offen lds
    buffer_load_dwordx4 v5, s[4:7], s32 offen offset:1024 lds
    buffer_load_dwordx4 v5, s[4:7], s32 offen offset:2048 lds
    buffer_load_dwordx4 v5, s[4:7], s32 offen offset:3072 lds
    s_add_u32 m0, s38, 1024
    s_add_u32 s39, s32, 1024
    buffer_load_dwordx4 v5, s[4:7], s39 offen offset:3072 lds
    s_add_u32 s32, s32, 20480
    s_waitcnt vmcnt(9)
    s_barrier
    s_add_u32 m0, s37, 36864
    s_add_u32 s38, s36, 36864
    buffer_load_dwordx4 v3, s[4:7], s31 offen lds
    buffer_load_dwordx4 v3, s[4:7], s31 offen offset:1024 lds
    buffer_load_dwordx4 v4, s[4:7], s31 offen offset:2048 lds
    buffer_load_dwordx4 v4, s[4:7], s31 offen offset:3072 lds
    s_mov_b32 m0, s38
    s_add_u32 s31, s31, 2048
    buffer_load_dwordx4 v5, s[4:7], s32 offen lds
    buffer_load_dwordx4 v5, s[4:7], s32 offen offset:1024 lds
    buffer_load_dwordx4 v5, s[4:7], s32 offen offset:2048 lds
    buffer_load_dwordx4 v5, s[4:7], s32 offen offset:3072 lds
    s_add_u32 m0, s38, 1024
    s_add_u32 s39, s32, 1024
    buffer_load_dwordx4 v5, s[4:7], s39 offen offset:3072 lds
    s_add_u32 s32, s32, 20480
    s_waitcnt vmcnt(9)
    s_barrier
    s_add_u32 m0, s37, 73728
    s_add_u32 s38, s36, 73728
    buffer_load_dwordx4 v3, s[4:7], s31 offen lds
    buffer_load_dwordx4 v3, s[4:7], s31 offen offset:1024 lds
    buffer_load_dwordx4 v4, s[4:7], s31 offen offset:2048 lds
    buffer_load_dwordx4 v4, s[4:7], s31 offen offset:3072 lds
    s_mov_b32 m0, s38
    s_add_u32 s31, s31, 2048
    buffer_load_dwordx4 v5, s[4:7], s32 offen lds
    buffer_load_dwordx4 v5, s[4:7], s32 offen offset:1024 lds
    buffer_load_dwordx4 v5, s[4:7], s32 offen offset:2048 lds
    buffer_load_dwordx4 v5, s[4:7], s32 offen offset:3072 lds
    s_add_u32 m0, s38, 1024
    s_add_u32 s39, s32, 1024
    buffer_load_dwordx4 v5, s[4:7], s39 offen offset:3072 lds
    s_add_u32 s32, s32, 20480
    s_waitcnt vmcnt(9)
    s_barrier
    s_add_u32 m0, s37, 110592
    s_add_u32 s38, s36, 110592
    buffer_load_dwordx4 v3, s[4:7], s31 offen lds
    buffer_load_dwordx4 v3, s[4:7], s31 offen offset:1024 lds
    buffer_load_dwordx4 v4, s[4:7], s31 offen offset:2048 lds
    buffer_load_dwordx4 v4, s[4:7], s31 offen offset:3072 lds
    s_mov_b32 m0, s38
    s_add_u32 s31, s31, 2048
    buffer_load_dwordx4 v5, s[4:7], s32 offen lds
    buffer_load_dwordx4 v5, s[4:7], s32 offen offset:1024 lds
    buffer_load_dwordx4 v5, s[4:7], s32 offen offset:2048 lds
    buffer_load_dwordx4 v5, s[4:7], s32 offen offset:3072 lds
    s_add_u32 m0, s38, 1024
    s_add_u32 s39, s32, 1024
    buffer_load_dwordx4 v5, s[4:7], s39 offen offset:3072 lds
    s_add_u32 s32, s32, 20480
    s_waitcnt vmcnt(9)
    s_barrier
    s_add_u32 m0, s37, 0
    s_add_u32 s38, s36, 0
    buffer_load_dwordx4 v3, s[4:7], s31 offen lds
    buffer_load_dwordx4 v3, s[4:7], s31 offen offset:1024 lds
    buffer_load_dwordx4 v4, s[4:7], s31 offen offset:2048 lds
    buffer_load_dwordx4 v4, s[4:7], s31 offen offset:3072 lds
    s_mov_b32 m0, s38
    s_add_u32 s31, s31, 2048
    buffer_load_dwordx4 v5, s[4:7], s32 offen lds
    buffer_load_dwordx4 v5, s[4:7], s32 offen offset:1024 lds
    buffer_load_dwordx4 v5, s[4:7], s32 offen offset:2048 lds
    buffer_load_dwordx4 v5, s[4:7], s32 offen offset:3072 lds
    s_add_u32 m0, s38, 1024
    s_add_u32 s39, s32, 1024
    buffer_load_dwordx4 v5, s[4:7], s39 offen offset:3072 lds
    s_add_u32 s32, s32, 20480
    s_waitcnt vmcnt(9)
    s_barrier
    s_add_u32 m0, s37, 36864
    s_add_u32 s38, s36, 36864
    buffer_load_dwordx4 v3, s[4:7], s31 offen lds
    buffer_load_dwordx4 v3, s[4:7], s31 offen offset:1024 lds
    buffer_load_dwordx4 v4, s[4:7], s31 offen offset:2048 lds
    buffer_load_dwordx4 v4, s[4:7], s31 offen offset:3072 lds
    s_mov_b32 m0, s38
    s_add_u32 s31, s31, 2048
    buffer_load_dwordx4 v5, s[4:7], s32 offen lds
    buffer_load_dwordx4 v5, s[4:7], s32 offen offset:1024 lds
    buffer_load_dwordx4 v5, s[4:7], s32 offen offset:2048 lds
    buffer_load_dwordx4 v5, s[4:7], s32 offen offset:3072 lds
    s_add_u32 m0, s38, 1024
    s_add_u32 s39, s32, 1024
    buffer_load_dwordx4 v5, s[4:7], s39 offen offset:3072 lds
    s_add_u32 s32, s32, 20480
    s_waitcnt vmcnt(9)
    s_barrier
    s_waitcnt vmcnt(0)
    s_barrier
    s_cmp_lg_u32 s2, 0
    s_cbranch_scc1 L_k7_kernel_4
    v_mov_b32 v1, 20576
    v_mov_b32 v2, 1
    buffer_store_dword v2, v1, s[4:7], 0 offen sc1
    v_lshlrev_b32 v1, 7, v0
    v_mov_b32 v8, 0
    v_mov_b32 v9, 0
    v_mov_b32 v10, 0
    v_mov_b32 v11, 0
    s_lshl_b32 s38, s3, 13
    s_add_u32 s38, s38, 26198016
    buffer_store_dwordx4 v[8:11], v1, s[4:7], s38 offen sc1
L_k7_kernel_4:
    s_endpgm
L_k7_kernel_3:
    s_lshr_b32 s29, s3, 1
    s_and_b32 s30, s3, 1
    v_and_b32 v1, 15, v0
    v_lshlrev_b32 v12, 8, v2
    v_lshl_add_u32 v12, v1, 3, v12
    v_and_b32 v13, 1, v2
    v_lshl_add_u32 v12, v13, 7, v12
    s_lshl_b32 s38, s3, 12
    v_add_u32 v12, s38, v12
    v_xor_b32 v13, 0x80, v12
    v_xor_b32 v14, 0x1000, v12
    v_xor_b32 v15, 0x1000, v13
    s_mul_i32 s38, s30, 5120
    s_add_u32 s38, s38, 16384
    v_add_u32 v16, s38, v5
    s_mov_b32 s34, 0
    s_mov_b32 s35, 0
    v_mov_b32 v7, v12
    v_mov_b32 v8, v13
    v_mov_b32 v9, v14
    v_mov_b32 v10, v15
    v_mov_b32 v11, v16
    v_mov_b32 v92, 0
    v_mov_b32 v93, 0
    v_mov_b32 v94, 0
    v_mov_b32 v95, 0
    v_mov_b32 v96, 0
    v_mov_b32 v97, 0
    v_mov_b32 v98, 0
    v_mov_b32 v99, 0
    v_mov_b32 v100, 0
    v_mov_b32 v101, 0
    v_mov_b32 v102, 0
    v_mov_b32 v103, 0
    v_mov_b32 v104, 0
    v_mov_b32 v105, 0
    v_mov_b32 v106, 0
    v_mov_b32 v107, 0
    v_mov_b32 v108, 0
    v_mov_b32 v109, 0
    v_mov_b32 v110, 0
    v_mov_b32 v111, 0
    v_mov_b32 v112, 0
    v_mov_b32 v113, 0
    v_mov_b32 v114, 0
    v_mov_b32 v115, 0
    v_mov_b32 v116, 0
    v_mov_b32 v117, 0
    v_mov_b32 v118, 0
    v_mov_b32 v119, 0
    v_mov_b32 v120, 0
    v_mov_b32 v121, 0
    v_mov_b32 v122, 0
    v_mov_b32 v123, 0
    v_mov_b32 v124, 0
    v_mov_b32 v125, 0
    v_mov_b32 v126, 0
    v_mov_b32 v127, 0
    v_mov_b32 v128, 0
    v_mov_b32 v129, 0
    v_mov_b32 v130, 0
    v_mov_b32 v131, 0
    v_mov_b32 v132, 0
    v_mov_b32 v133, 0
    v_mov_b32 v134, 0
    v_mov_b32 v135, 0
    v_mov_b32 v136, 0
    v_mov_b32 v137, 0
    v_mov_b32 v138, 0
    v_mov_b32 v139, 0
    v_mov_b32 v140, 0
    v_mov_b32 v141, 0
    v_mov_b32 v142, 0
    v_mov_b32 v143, 0
    v_mov_b32 v144, 0
    v_mov_b32 v145, 0
    v_mov_b32 v146, 0
    v_mov_b32 v147, 0
    v_mov_b32 v148, 0
    v_mov_b32 v149, 0
    v_mov_b32 v150, 0
    v_mov_b32 v151, 0
    v_mov_b32 v152, 0
    v_mov_b32 v153, 0
    v_mov_b32 v154, 0
    v_mov_b32 v155, 0
    v_mov_b32 v156, 0
    v_mov_b32 v157, 0
    v_mov_b32 v158, 0
    v_mov_b32 v159, 0
    v_mov_b32 v160, 0
    v_mov_b32 v161, 0
    v_mov_b32 v162, 0
    v_mov_b32 v163, 0
    v_mov_b32 v164, 0
    v_mov_b32 v165, 0
    v_mov_b32 v166, 0
    v_mov_b32 v167, 0
    v_mov_b32 v168, 0
    v_mov_b32 v169, 0
    v_mov_b32 v170, 0
    v_mov_b32 v171, 0
    v_mov_b32 v172, 0
    v_mov_b32 v173, 0
    v_mov_b32 v174, 0
    v_mov_b32 v175, 0
    v_mov_b32 v176, 0
    v_mov_b32 v177, 0
    v_mov_b32 v178, 0
    v_mov_b32 v179, 0
    s_barrier
    ds_read_b64_tr_b16 v[20:21], v7 offset:0
    ds_read_b64_tr_b16 v[22:23], v8 offset:0
    ds_read_b128 v[36:39], v11 offset:0
    ds_read_b64_tr_b16 v[24:25], v7 offset:2048
    ds_read_b64_tr_b16 v[26:27], v8 offset:2048
    ds_read_b128 v[40:43], v11 offset:1024
    ds_read_b64_tr_b16 v[28:29], v9 offset:0
    ds_read_b64_tr_b16 v[30:31], v10 offset:0
    ds_read_b128 v[44:47], v11 offset:2048
    ds_read_b64_tr_b16 v[32:33], v9 offset:2048
    ds_read_b64_tr_b16 v[34:35], v10 offset:2048
    ds_read_b128 v[48:51], v11 offset:3072
    ds_read_b128 v[52:55], v11 offset:4096
    s_lshr_b32 s38, s28, 2
    s_cmp_eq_u32 s38, 2
    s_cbranch_scc1 L_k7_kernel_6
L_k7_kernel_5:
L_k7_kernel_7:
    s_waitcnt lgkmcnt(0)
    v_mfma_f32_16x16x32_bf16 v[172:175], v[20:23], v[20:23], v[172:175]
    ds_read_b64_tr_b16 v[56:57], v7 offset:1024
    v_mfma_f32_16x16x32_bf16 v[176:179], v[24:27], v[24:27], v[176:179]
    ds_read_b64_tr_b16 v[58:59], v8 offset:1024
    v_mfma_f32_16x16x32_bf16 v[92:95], v[36:39], v[20:23], v[92:95]
    ds_read_b128 v[72:75], v11 offset:10240
    v_mfma_f32_16x16x32_bf16 v[96:99], v[40:43], v[20:23], v[96:99]
    ds_read_b64_tr_b16 v[60:61], v7 offset:3072
    v_mfma_f32_16x16x32_bf16 v[100:103], v[44:47], v[20:23], v[100:103]
    ds_read_b64_tr_b16 v[62:63], v8 offset:3072
    v_mfma_f32_16x16x32_bf16 v[104:107], v[48:51], v[20:23], v[104:107]
    ds_read_b128 v[76:79], v11 offset:11264
    v_mfma_f32_16x16x32_bf16 v[108:111], v[52:55], v[20:23], v[108:111]
    ds_read_b64_tr_b16 v[64:65], v9 offset:1024
    v_mfma_f32_16x16x32_bf16 v[112:115], v[36:39], v[24:27], v[112:115]
    ds_read_b64_tr_b16 v[66:67], v10 offset:1024
    v_mfma_f32_16x16x32_bf16 v[116:119], v[40:43], v[24:27], v[116:119]
    ds_read_b128 v[80:83], v11 offset:12288
    v_mfma_f32_16x16x32_bf16 v[120:123], v[44:47], v[24:27], v[120:123]
    ds_read_b64_tr_b16 v[68:69], v9 offset:3072
    v_mfma_f32_16x16x32_bf16 v[124:127], v[48:51], v[24:27], v[124:127]
    ds_read_b64_tr_b16 v[70:71], v10 offset:3072
    v_mfma_f32_16x16x32_bf16 v[128:131], v[52:55], v[24:27], v[128:131]
    ds_read_b128 v[84:87], v11 offset:13312
    v_mfma_f32_16x16x32_bf16 v[132:135], v[36:39], v[28:31], v[132:135]
    ds_read_b128 v[88:91], v11 offset:14336
    v_mfma_f32_16x16x32_bf16 v[136:139], v[40:43], v[28:31], v[136:139]
    s_add_u32 s34, s34, 1
    s_add_u32 s35, s35, 36864
    v_mfma_f32_16x16x32_bf16 v[140:143], v[44:47], v[28:31], v[140:143]
    s_cmp_ge_u32 s35, 147456
    s_cselect_b32 s35, 0, s35
    v_mfma_f32_16x16x32_bf16 v[144:147], v[48:51], v[28:31], v[144:147]
    v_add_u32 v7, s35, v12
    v_mfma_f32_16x16x32_bf16 v[148:151], v[52:55], v[28:31], v[148:151]
    v_add_u32 v8, s35, v13
    v_mfma_f32_16x16x32_bf16 v[152:155], v[36:39], v[32:35], v[152:155]
    v_add_u32 v9, s35, v14
    v_mfma_f32_16x16x32_bf16 v[156:159], v[40:43], v[32:35], v[156:159]
    v_add_u32 v10, s35, v15
    v_mfma_f32_16x16x32_bf16 v[160:163], v[44:47], v[32:35], v[160:163]
    v_add_u32 v11, s35, v16
    v_mfma_f32_16x16x32_bf16 v[164:167], v[48:51], v[32:35], v[164:167]
    s_cmp_eq_u32 s34, 10
    v_mfma_f32_16x16x32_bf16 v[168:171], v[52:55], v[32:35], v[168:171]
    s_waitcnt lgkmcnt(0)
    s_cbranch_scc1 L_k7_kernel_8
    s_barrier
    v_mfma_f32_16x16x32_bf16 v[172:175], v[56:59], v[56:59], v[172:175]
    ds_read_b64_tr_b16 v[20:21], v7 offset:0
    v_mfma_f32_16x16x32_bf16 v[176:179], v[60:63], v[60:63], v[176:179]
    ds_read_b64_tr_b16 v[22:23], v8 offset:0
    v_mfma_f32_16x16x32_bf16 v[92:95], v[72:75], v[56:59], v[92:95]
    ds_read_b128 v[36:39], v11 offset:0
    v_mfma_f32_16x16x32_bf16 v[96:99], v[76:79], v[56:59], v[96:99]
    ds_read_b64_tr_b16 v[24:25], v7 offset:2048
    v_mfma_f32_16x16x32_bf16 v[100:103], v[80:83], v[56:59], v[100:103]
    ds_read_b64_tr_b16 v[26:27], v8 offset:2048
    v_mfma_f32_16x16x32_bf16 v[104:107], v[84:87], v[56:59], v[104:107]
    ds_read_b128 v[40:43], v11 offset:1024
    v_mfma_f32_16x16x32_bf16 v[108:111], v[88:91], v[56:59], v[108:111]
    ds_read_b64_tr_b16 v[28:29], v9 offset:0
    v_mfma_f32_16x16x32_bf16 v[112:115], v[72:75], v[60:63], v[112:115]
    ds_read_b64_tr_b16 v[30:31], v10 offset:0
    v_mfma_f32_16x16x32_bf16 v[116:119], v[76:79], v[60:63], v[116:119]
    ds_read_b128 v[44:47], v11 offset:2048
    v_mfma_f32_16x16x32_bf16 v[120:123], v[80:83], v[60:63], v[120:123]
    ds_read_b64_tr_b16 v[32:33], v9 offset:2048
    v_mfma_f32_16x16x32_bf16 v[124:127], v[84:87], v[60:63], v[124:127]
    ds_read_b64_tr_b16 v[34:35], v10 offset:2048
    v_mfma_f32_16x16x32_bf16 v[128:131], v[88:91], v[60:63], v[128:131]
    ds_read_b128 v[48:51], v11 offset:3072
    v_mfma_f32_16x16x32_bf16 v[132:135], v[72:75], v[64:67], v[132:135]
    ds_read_b128 v[52:55], v11 offset:4096
    v_mfma_f32_16x16x32_bf16 v[136:139], v[76:79], v[64:67], v[136:139]
    v_mfma_f32_16x16x32_bf16 v[140:143], v[80:83], v[64:67], v[140:143]
    v_mfma_f32_16x16x32_bf16 v[144:147], v[84:87], v[64:67], v[144:147]
    v_mfma_f32_16x16x32_bf16 v[148:151], v[88:91], v[64:67], v[148:151]
    v_mfma_f32_16x16x32_bf16 v[152:155], v[72:75], v[68:71], v[152:155]
    v_mfma_f32_16x16x32_bf16 v[156:159], v[76:79], v[68:71], v[156:159]
    v_mfma_f32_16x16x32_bf16 v[160:163], v[80:83], v[68:71], v[160:163]
    v_mfma_f32_16x16x32_bf16 v[164:167], v[84:87], v[68:71], v[164:167]
    v_mfma_f32_16x16x32_bf16 v[168:171], v[88:91], v[68:71], v[168:171]
    s_branch L_k7_kernel_7
L_k7_kernel_8:
    v_mfma_f32_16x16x32_bf16 v[172:175], v[56:59], v[56:59], v[172:175]
    s_lshl_b32 s38, s3, 7
    v_lshlrev_b32 v7, 2, v1
    v_mfma_f32_16x16x32_bf16 v[176:179], v[60:63], v[60:63], v[176:179]
    v_add_u32 v7, s38, v7
    v_lshrrev_b32 v10, 2, v1
    v_mfma_f32_16x16x32_bf16 v[92:95], v[72:75], v[56:59], v[92:95]
    v_cmp_eq_u32 s[44:45], v10, v2
    v_and_b32 v10, 3, v1
    v_mfma_f32_16x16x32_bf16 v[96:99], v[76:79], v[56:59], v[96:99]
    v_cmp_eq_u32 s[46:47], 1, v10
    v_cmp_eq_u32 s[48:49], 2, v10
    v_mfma_f32_16x16x32_bf16 v[100:103], v[80:83], v[56:59], v[100:103]
    v_cmp_eq_u32 s[50:51], 3, v10
    v_add_u32 v11, 512, v5
    v_mfma_f32_16x16x32_bf16 v[104:107], v[84:87], v[56:59], v[104:107]
    v_cndmask_b32 v6, v11, v7, s[44:45]
    v_mov_b32 v8, 0x3727c5ac
    s_mov_b32 s39, 0x3acccccd
    v_mfma_f32_16x16x32_bf16 v[108:111], v[88:91], v[56:59], v[108:111]
    v_cndmask_b32 v10, v172, v173, s[46:47]
    v_cndmask_b32 v11, v176, v177, s[46:47]
    v_mfma_f32_16x16x32_bf16 v[112:115], v[72:75], v[60:63], v[112:115]
    v_cndmask_b32 v10, v10, v174, s[48:49]
    v_cndmask_b32 v11, v11, v178, s[48:49]
    v_mfma_f32_16x16x32_bf16 v[116:119], v[76:79], v[60:63], v[116:119]
    v_cndmask_b32 v10, v10, v175, s[50:51]
    v_cndmask_b32 v11, v11, v179, s[50:51]
    v_mfma_f32_16x16x32_bf16 v[120:123], v[80:83], v[60:63], v[120:123]
    v_fma_f32 v10, v10, s39, v8
    v_fma_f32 v11, v11, s39, v8
    v_add_u32 v6, 147456, v6
    v_mfma_f32_16x16x32_bf16 v[124:127], v[84:87], v[60:63], v[124:127]
    v_rsq_f32 v10, v10
    v_rsq_f32 v11, v11
    s_add_u32 s38, s38, 147456
    v_mfma_f32_16x16x32_bf16 v[128:131], v[88:91], v[60:63], v[128:131]
    ds_write_b32 v6, v10
    ds_write_b32 v6, v11 offset:64
    v_lshlrev_b32 v7, 2, v1
    v_mfma_f32_16x16x32_bf16 v[132:135], v[72:75], v[64:67], v[132:135]
    v_add_u32 v7, s38, v7
    v_xor_b32 v8, 0x80, v7
    v_mfma_f32_16x16x32_bf16 v[136:139], v[76:79], v[64:67], v[136:139]
    s_waitcnt lgkmcnt(0)
    s_barrier
    v_mfma_f32_16x16x32_bf16 v[140:143], v[80:83], v[64:67], v[140:143]
    ds_read_b32 v20, v7 offset:0
    ds_read_b32 v24, v7 offset:64
    ds_read_b32 v28, v8 offset:0
    ds_read_b32 v32, v8 offset:64
    v_mfma_f32_16x16x32_bf16 v[144:147], v[84:87], v[64:67], v[144:147]
    v_mfma_f32_16x16x32_bf16 v[148:151], v[88:91], v[64:67], v[148:151]
    v_mfma_f32_16x16x32_bf16 v[152:155], v[72:75], v[68:71], v[152:155]
    v_mfma_f32_16x16x32_bf16 v[156:159], v[76:79], v[68:71], v[156:159]
    v_mfma_f32_16x16x32_bf16 v[160:163], v[80:83], v[68:71], v[160:163]
    v_mfma_f32_16x16x32_bf16 v[164:167], v[84:87], v[68:71], v[164:167]
    v_mfma_f32_16x16x32_bf16 v[168:171], v[88:91], v[68:71], v[168:171]
    s_cmp_ge_u32 s28, 12
    s_cbranch_scc1 L_k7_kernel_9
    s_lshl_b32 s38, s27, 2
    s_add_u32 s38, s38, s3
    s_xor_b32 s39, s38, 1
    s_and_b32 s40, s28, 3
    s_lshl_b32 s40, s40, 1
    s_add_u32 s40, s40, s30
    s_lshl_b32 s40, s40, 8
    s_add_u32 s41, s40, s39
    s_add_u32 s40, s40, s38
    s_movk_i32 s42, 2560
    s_mov_b32 s43, 16777216
    s_cmp_lt_u32 s28, 4
    s_cselect_b32 s42, 1280, s42
    s_cselect_b32 s43, 12582912, s43
    s_mul_i32 s40, s40, s42
    s_mul_i32 s41, s41, s42
    s_add_u32 s40, s40, s43
    s_add_u32 s41, s41, s43
    s_lshl_b32 s42, s42, 6
    v_mul_lo_u32 v3, v2, s42
    v_lshl_add_u32 v3, v1, 3, v3
    s_waitcnt lgkmcnt(0)
    v_pk_mul_f32 v[108:109], v[108:109], v[20:21] op_sel_hi:[1,0]
    v_pk_mul_f32 v[110:111], v[110:111], v[20:21] op_sel_hi:[1,0]
    v_cvt_pk_bf16_f32 v108, v108, v109
    v_cvt_pk_bf16_f32 v109, v110, v111
    buffer_store_dwordx2 v[108:109], v3, s[4:7], s40 offen offset:1024 sc1
    v_pk_mul_f32 v[128:129], v[128:129], v[24:25] op_sel_hi:[1,0]
    v_pk_mul_f32 v[130:131], v[130:131], v[24:25] op_sel_hi:[1,0]
    v_cvt_pk_bf16_f32 v128, v128, v129
    v_cvt_pk_bf16_f32 v129, v130, v131
    buffer_store_dwordx2 v[128:129], v3, s[4:7], s40 offen offset:1152 sc1
    v_pk_mul_f32 v[92:93], v[92:93], v[20:21] op_sel_hi:[1,0]
    v_pk_mul_f32 v[94:95], v[94:95], v[20:21] op_sel_hi:[1,0]
    v_pk_mul_f32 v[112:113], v[112:113], v[24:25] op_sel_hi:[1,0]
    v_pk_mul_f32 v[114:115], v[114:115], v[24:25] op_sel_hi:[1,0]
    v_cvt_pk_bf16_f32 v92, v92, v93
    v_cvt_pk_bf16_f32 v93, v94, v95
    v_cvt_pk_bf16_f32 v94, v112, v113
    v_cvt_pk_bf16_f32 v95, v114, v115
    s_nop 1
    v_permlane16_swap_b32 v92, v94
    v_permlane16_swap_b32 v93, v95
    buffer_store_dwordx4 v[92:95], v5, s[4:7], s40 offen offset:0 sc1
    s_add_u32 s40, s40, s42
    v_pk_mul_f32 v[96:97], v[96:97], v[20:21] op_sel_hi:[1,0]
    v_pk_mul_f32 v[98:99], v[98:99], v[20:21] op_sel_hi:[1,0]
    v_pk_mul_f32 v[116:117], v[116:117], v[24:25] op_sel_hi:[1,0]
    v_pk_mul_f32 v[118:119], v[118:119], v[24:25] op_sel_hi:[1,0]
    v_cvt_pk_bf16_f32 v96, v96, v97
    v_cvt_pk_bf16_f32 v97, v98, v99
    v_cvt_pk_bf16_f32 v98, v116, v117
    v_cvt_pk_bf16_f32 v99, v118, v119
    s_nop 1
    v_permlane16_swap_b32 v96, v98
    v_permlane16_swap_b32 v97, v99
    buffer_store_dwordx4 v[96:99], v5, s[4:7], s40 offen offset:0 sc1
    s_add_u32 s40, s40, s42
    v_pk_mul_f32 v[100:101], v[100:101], v[20:21] op_sel_hi:[1,0]
    v_pk_mul_f32 v[102:103], v[102:103], v[20:21] op_sel_hi:[1,0]
    v_pk_mul_f32 v[120:121], v[120:121], v[24:25] op_sel_hi:[1,0]
    v_pk_mul_f32 v[122:123], v[122:123], v[24:25] op_sel_hi:[1,0]
    v_cvt_pk_bf16_f32 v100, v100, v101
    v_cvt_pk_bf16_f32 v101, v102, v103
    v_cvt_pk_bf16_f32 v102, v120, v121
    v_cvt_pk_bf16_f32 v103, v122, v123
    s_nop 1
    v_permlane16_swap_b32 v100, v102
    v_permlane16_swap_b32 v101, v103
    buffer_store_dwordx4 v[100:103], v5, s[4:7], s40 offen offset:0 sc1
    s_add_u32 s40, s40, s42
    v_pk_mul_f32 v[104:105], v[104:105], v[20:21] op_sel_hi:[1,0]
    v_pk_mul_f32 v[106:107], v[106:107], v[20:21] op_sel_hi:[1,0]
    v_pk_mul_f32 v[124:125], v[124:125], v[24:25] op_sel_hi:[1,0]
    v_pk_mul_f32 v[126:127], v[126:127], v[24:25] op_sel_hi:[1,0]
    v_cvt_pk_bf16_f32 v104, v104, v105
    v_cvt_pk_bf16_f32 v105, v106, v107
    v_cvt_pk_bf16_f32 v106, v124, v125
    v_cvt_pk_bf16_f32 v107, v126, v127
    s_nop 1
    v_permlane16_swap_b32 v104, v106
    v_permlane16_swap_b32 v105, v107
    buffer_store_dwordx4 v[104:107], v5, s[4:7], s40 offen offset:0 sc1
    v_pk_mul_f32 v[148:149], v[148:149], v[28:29] op_sel_hi:[1,0]
    v_pk_mul_f32 v[150:151], v[150:151], v[28:29] op_sel_hi:[1,0]
    v_cvt_pk_bf16_f32 v148, v148, v149
    v_cvt_pk_bf16_f32 v149, v150, v151
    buffer_store_dwordx2 v[148:149], v3, s[4:7], s41 offen offset:1024 sc1
    v_pk_mul_f32 v[168:169], v[168:169], v[32:33] op_sel_hi:[1,0]
    v_pk_mul_f32 v[170:171], v[170:171], v[32:33] op_sel_hi:[1,0]
    v_cvt_pk_bf16_f32 v168, v168, v169
    v_cvt_pk_bf16_f32 v169, v170, v171
    buffer_store_dwordx2 v[168:169], v3, s[4:7], s41 offen offset:1152 sc1
    v_pk_mul_f32 v[132:133], v[132:133], v[28:29] op_sel_hi:[1,0]
    v_pk_mul_f32 v[134:135], v[134:135], v[28:29] op_sel_hi:[1,0]
    v_pk_mul_f32 v[152:153], v[152:153], v[32:33] op_sel_hi:[1,0]
    v_pk_mul_f32 v[154:155], v[154:155], v[32:33] op_sel_hi:[1,0]
    v_cvt_pk_bf16_f32 v132, v132, v133
    v_cvt_pk_bf16_f32 v133, v134, v135
    v_cvt_pk_bf16_f32 v134, v152, v153
    v_cvt_pk_bf16_f32 v135, v154, v155
    s_nop 1
    v_permlane16_swap_b32 v132, v134
    v_permlane16_swap_b32 v133, v135
    buffer_store_dwordx4 v[132:135], v5, s[4:7], s41 offen offset:0 sc1
    s_add_u32 s41, s41, s42
    v_pk_mul_f32 v[136:137], v[136:137], v[28:29] op_sel_hi:[1,0]
    v_pk_mul_f32 v[138:139], v[138:139], v[28:29] op_sel_hi:[1,0]
    v_pk_mul_f32 v[156:157], v[156:157], v[32:33] op_sel_hi:[1,0]
    v_pk_mul_f32 v[158:159], v[158:159], v[32:33] op_sel_hi:[1,0]
    v_cvt_pk_bf16_f32 v136, v136, v137
    v_cvt_pk_bf16_f32 v137, v138, v139
    v_cvt_pk_bf16_f32 v138, v156, v157
    v_cvt_pk_bf16_f32 v139, v158, v159
    s_nop 1
    v_permlane16_swap_b32 v136, v138
    v_permlane16_swap_b32 v137, v139
    buffer_store_dwordx4 v[136:139], v5, s[4:7], s41 offen offset:0 sc1
    s_add_u32 s41, s41, s42
    v_pk_mul_f32 v[140:141], v[140:141], v[28:29] op_sel_hi:[1,0]
    v_pk_mul_f32 v[142:143], v[142:143], v[28:29] op_sel_hi:[1,0]
    v_pk_mul_f32 v[160:161], v[160:161], v[32:33] op_sel_hi:[1,0]
    v_pk_mul_f32 v[162:163], v[162:163], v[32:33] op_sel_hi:[1,0]
    v_cvt_pk_bf16_f32 v140, v140, v141
    v_cvt_pk_bf16_f32 v141, v142, v143
    v_cvt_pk_bf16_f32 v142, v160, v161
    v_cvt_pk_bf16_f32 v143, v162, v163
    s_nop 1
    v_permlane16_swap_b32 v140, v142
    v_permlane16_swap_b32 v141, v143
    buffer_store_dwordx4 v[140:143], v5, s[4:7], s41 offen offset:0 sc1
    s_add_u32 s41, s41, s42
    v_pk_mul_f32 v[144:145], v[144:145], v[28:29] op_sel_hi:[1,0]
    v_pk_mul_f32 v[146:147], v[146:147], v[28:29] op_sel_hi:[1,0]
    v_pk_mul_f32 v[164:165], v[164:165], v[32:33] op_sel_hi:[1,0]
    v_pk_mul_f32 v[166:167], v[166:167], v[32:33] op_sel_hi:[1,0]
    v_cvt_pk_bf16_f32 v144, v144, v145
    v_cvt_pk_bf16_f32 v145, v146, v147
    v_cvt_pk_bf16_f32 v146, v164, v165
    v_cvt_pk_bf16_f32 v147, v166, v167
    s_nop 1
    v_permlane16_swap_b32 v144, v146
    v_permlane16_swap_b32 v145, v147
    buffer_store_dwordx4 v[144:147], v5, s[4:7], s41 offen offset:0 sc1
    s_endpgm
L_k7_kernel_9:
    s_lshl_b32 s38, s27, 1
    s_add_u32 s38, s38, s29
    s_lshl_b32 s38, s38, 2
    s_add_u32 s38, s38, s28
    s_sub_u32 s38, s38, 12
    s_lshl_b32 s38, s38, 1
    s_add_u32 s38, s38, s30
    s_mul_i32 s38, s38, 10240
    s_add_u32 s38, s38, 27262976
    s_mul_i32 s39, s30, 5120
    s_add_u32 s40, s38, s39
    s_sub_u32 s41, s38, s39
    s_add_u32 s41, s41, 5120
    s_add_u32 s42, s40, 4096
    s_add_u32 s43, s41, 4096
    v_cvt_pk_bf16_f32 v92, v92, v93
    v_cvt_pk_bf16_f32 v93, v94, v95
    v_cvt_pk_bf16_f32 v94, v112, v113
    v_cvt_pk_bf16_f32 v95, v114, v115
    buffer_store_dwordx4 v[92:95], v5, s[4:7], s40 offen offset:0 sc1
    v_cvt_pk_bf16_f32 v96, v96, v97
    v_cvt_pk_bf16_f32 v97, v98, v99
    v_cvt_pk_bf16_f32 v98, v116, v117
    v_cvt_pk_bf16_f32 v99, v118, v119
    buffer_store_dwordx4 v[96:99], v5, s[4:7], s40 offen offset:1024 sc1
    v_cvt_pk_bf16_f32 v100, v100, v101
    v_cvt_pk_bf16_f32 v101, v102, v103
    v_cvt_pk_bf16_f32 v102, v120, v121
    v_cvt_pk_bf16_f32 v103, v122, v123
    buffer_store_dwordx4 v[100:103], v5, s[4:7], s40 offen offset:2048 sc1
    v_cvt_pk_bf16_f32 v104, v104, v105
    v_cvt_pk_bf16_f32 v105, v106, v107
    v_cvt_pk_bf16_f32 v106, v124, v125
    v_cvt_pk_bf16_f32 v107, v126, v127
    buffer_store_dwordx4 v[104:107], v5, s[4:7], s40 offen offset:3072 sc1
    v_cvt_pk_bf16_f32 v108, v108, v109
    v_cvt_pk_bf16_f32 v109, v110, v111
    v_cvt_pk_bf16_f32 v110, v128, v129
    v_cvt_pk_bf16_f32 v111, v130, v131
    buffer_store_dwordx4 v[108:111], v5, s[4:7], s42 offen offset:0 sc1
    v_cvt_pk_bf16_f32 v132, v132, v133
    v_cvt_pk_bf16_f32 v133, v134, v135
    v_cvt_pk_bf16_f32 v134, v152, v153
    v_cvt_pk_bf16_f32 v135, v154, v155
    buffer_store_dwordx4 v[132:135], v5, s[4:7], s41 offen offset:0 sc1
    v_cvt_pk_bf16_f32 v136, v136, v137
    v_cvt_pk_bf16_f32 v137, v138, v139
    v_cvt_pk_bf16_f32 v138, v156, v157
    v_cvt_pk_bf16_f32 v139, v158, v159
    buffer_store_dwordx4 v[136:139], v5, s[4:7], s41 offen offset:1024 sc1
    v_cvt_pk_bf16_f32 v140, v140, v141
    v_cvt_pk_bf16_f32 v141, v142, v143
    v_cvt_pk_bf16_f32 v142, v160, v161
    v_cvt_pk_bf16_f32 v143, v162, v163
    buffer_store_dwordx4 v[140:143], v5, s[4:7], s41 offen offset:2048 sc1
    v_cvt_pk_bf16_f32 v144, v144, v145
    v_cvt_pk_bf16_f32 v145, v146, v147
    v_cvt_pk_bf16_f32 v146, v164, v165
    v_cvt_pk_bf16_f32 v147, v166, v167
    buffer_store_dwordx4 v[144:147], v5, s[4:7], s41 offen offset:3072 sc1
    v_cvt_pk_bf16_f32 v148, v148, v149
    v_cvt_pk_bf16_f32 v149, v150, v151
    v_cvt_pk_bf16_f32 v150, v168, v169
    v_cvt_pk_bf16_f32 v151, v170, v171
    buffer_store_dwordx4 v[148:151], v5, s[4:7], s43 offen offset:0 sc1
    s_endpgm
L_k7_kernel_6:
L_k7_kernel_10:
    s_waitcnt lgkmcnt(0)
    v_mfma_f32_16x16x32_bf16 v[172:175], v[20:23], v[20:23], v[172:175]
    ds_read_b64_tr_b16 v[56:57], v7 offset:1024
    v_mfma_f32_16x16x32_bf16 v[176:179], v[24:27], v[24:27], v[176:179]
    ds_read_b64_tr_b16 v[58:59], v8 offset:1024
    v_mfma_f32_16x16x32_bf16 v[92:95], v[20:23], v[36:39], v[92:95]
    ds_read_b128 v[72:75], v11 offset:10240
    v_mfma_f32_16x16x32_bf16 v[96:99], v[20:23], v[40:43], v[96:99]
    ds_read_b64_tr_b16 v[60:61], v7 offset:3072
    v_mfma_f32_16x16x32_bf16 v[100:103], v[20:23], v[44:47], v[100:103]
    ds_read_b64_tr_b16 v[62:63], v8 offset:3072
    v_mfma_f32_16x16x32_bf16 v[104:107], v[20:23], v[48:51], v[104:107]
    ds_read_b128 v[76:79], v11 offset:11264
    v_mfma_f32_16x16x32_bf16 v[108:111], v[20:23], v[52:55], v[108:111]
    ds_read_b64_tr_b16 v[64:65], v9 offset:1024
    v_mfma_f32_16x16x32_bf16 v[112:115], v[24:27], v[36:39], v[112:115]
    ds_read_b64_tr_b16 v[66:67], v10 offset:1024
    v_mfma_f32_16x16x32_bf16 v[116:119], v[24:27], v[40:43], v[116:119]
    ds_read_b128 v[80:83], v11 offset:12288
    v_mfma_f32_16x16x32_bf16 v[120:123], v[24:27], v[44:47], v[120:123]
    ds_read_b64_tr_b16 v[68:69], v9 offset:3072
    v_mfma_f32_16x16x32_bf16 v[124:127], v[24:27], v[48:51], v[124:127]
    ds_read_b64_tr_b16 v[70:71], v10 offset:3072
    v_mfma_f32_16x16x32_bf16 v[128:131], v[24:27], v[52:55], v[128:131]
    ds_read_b128 v[84:87], v11 offset:13312
    v_mfma_f32_16x16x32_bf16 v[132:135], v[28:31], v[36:39], v[132:135]
    ds_read_b128 v[88:91], v11 offset:14336
    v_mfma_f32_16x16x32_bf16 v[136:139], v[28:31], v[40:43], v[136:139]
    s_add_u32 s34, s34, 1
    s_add_u32 s35, s35, 36864
    v_mfma_f32_16x16x32_bf16 v[140:143], v[28:31], v[44:47], v[140:143]
    s_cmp_ge_u32 s35, 147456
    s_cselect_b32 s35, 0, s35
    v_mfma_f32_16x16x32_bf16 v[144:147], v[28:31], v[48:51], v[144:147]
    v_add_u32 v7, s35, v12
    v_mfma_f32_16x16x32_bf16 v[148:151], v[28:31], v[52:55], v[148:151]
    v_add_u32 v8, s35, v13
    v_mfma_f32_16x16x32_bf16 v[152:155], v[32:35], v[36:39], v[152:155]
    v_add_u32 v9, s35, v14
    v_mfma_f32_16x16x32_bf16 v[156:159], v[32:35], v[40:43], v[156:159]
    v_add_u32 v10, s35, v15
    v_mfma_f32_16x16x32_bf16 v[160:163], v[32:35], v[44:47], v[160:163]
    v_add_u32 v11, s35, v16
    v_mfma_f32_16x16x32_bf16 v[164:167], v[32:35], v[48:51], v[164:167]
    s_cmp_eq_u32 s34, 10
    v_mfma_f32_16x16x32_bf16 v[168:171], v[32:35], v[52:55], v[168:171]
    s_waitcnt lgkmcnt(0)
    s_cbranch_scc1 L_k7_kernel_11
    s_barrier
    v_mfma_f32_16x16x32_bf16 v[172:175], v[56:59], v[56:59], v[172:175]
    ds_read_b64_tr_b16 v[20:21], v7 offset:0
    v_mfma_f32_16x16x32_bf16 v[176:179], v[60:63], v[60:63], v[176:179]
    ds_read_b64_tr_b16 v[22:23], v8 offset:0
    v_mfma_f32_16x16x32_bf16 v[92:95], v[56:59], v[72:75], v[92:95]
    ds_read_b128 v[36:39], v11 offset:0
    v_mfma_f32_16x16x32_bf16 v[96:99], v[56:59], v[76:79], v[96:99]
    ds_read_b64_tr_b16 v[24:25], v7 offset:2048
    v_mfma_f32_16x16x32_bf16 v[100:103], v[56:59], v[80:83], v[100:103]
    ds_read_b64_tr_b16 v[26:27], v8 offset:2048
    v_mfma_f32_16x16x32_bf16 v[104:107], v[56:59], v[84:87], v[104:107]
    ds_read_b128 v[40:43], v11 offset:1024
    v_mfma_f32_16x16x32_bf16 v[108:111], v[56:59], v[88:91], v[108:111]
    ds_read_b64_tr_b16 v[28:29], v9 offset:0
    v_mfma_f32_16x16x32_bf16 v[112:115], v[60:63], v[72:75], v[112:115]
    ds_read_b64_tr_b16 v[30:31], v10 offset:0
    v_mfma_f32_16x16x32_bf16 v[116:119], v[60:63], v[76:79], v[116:119]
    ds_read_b128 v[44:47], v11 offset:2048
    v_mfma_f32_16x16x32_bf16 v[120:123], v[60:63], v[80:83], v[120:123]
    ds_read_b64_tr_b16 v[32:33], v9 offset:2048
    v_mfma_f32_16x16x32_bf16 v[124:127], v[60:63], v[84:87], v[124:127]
    ds_read_b64_tr_b16 v[34:35], v10 offset:2048
    v_mfma_f32_16x16x32_bf16 v[128:131], v[60:63], v[88:91], v[128:131]
    ds_read_b128 v[48:51], v11 offset:3072
    v_mfma_f32_16x16x32_bf16 v[132:135], v[64:67], v[72:75], v[132:135]
    ds_read_b128 v[52:55], v11 offset:4096
    v_mfma_f32_16x16x32_bf16 v[136:139], v[64:67], v[76:79], v[136:139]
    v_mfma_f32_16x16x32_bf16 v[140:143], v[64:67], v[80:83], v[140:143]
    v_mfma_f32_16x16x32_bf16 v[144:147], v[64:67], v[84:87], v[144:147]
    v_mfma_f32_16x16x32_bf16 v[148:151], v[64:67], v[88:91], v[148:151]
    v_mfma_f32_16x16x32_bf16 v[152:155], v[68:71], v[72:75], v[152:155]
    v_mfma_f32_16x16x32_bf16 v[156:159], v[68:71], v[76:79], v[156:159]
    v_mfma_f32_16x16x32_bf16 v[160:163], v[68:71], v[80:83], v[160:163]
    v_mfma_f32_16x16x32_bf16 v[164:167], v[68:71], v[84:87], v[164:167]
    v_mfma_f32_16x16x32_bf16 v[168:171], v[68:71], v[88:91], v[168:171]
    s_branch L_k7_kernel_10
L_k7_kernel_11:
    v_mfma_f32_16x16x32_bf16 v[172:175], v[56:59], v[56:59], v[172:175]
    s_lshl_b32 s38, s3, 7
    v_lshlrev_b32 v7, 2, v1
    v_mfma_f32_16x16x32_bf16 v[176:179], v[60:63], v[60:63], v[176:179]
    v_add_u32 v7, s38, v7
    v_lshrrev_b32 v10, 2, v1
    v_mfma_f32_16x16x32_bf16 v[92:95], v[56:59], v[72:75], v[92:95]
    v_cmp_eq_u32 s[44:45], v10, v2
    v_and_b32 v10, 3, v1
    v_mfma_f32_16x16x32_bf16 v[96:99], v[56:59], v[76:79], v[96:99]
    v_cmp_eq_u32 s[46:47], 1, v10
    v_cmp_eq_u32 s[48:49], 2, v10
    v_mfma_f32_16x16x32_bf16 v[100:103], v[56:59], v[80:83], v[100:103]
    v_cmp_eq_u32 s[50:51], 3, v10
    v_add_u32 v11, 512, v5
    v_mfma_f32_16x16x32_bf16 v[104:107], v[56:59], v[84:87], v[104:107]
    v_cndmask_b32 v6, v11, v7, s[44:45]
    v_mov_b32 v8, 0x3727c5ac
    s_mov_b32 s39, 0x3acccccd
    v_mfma_f32_16x16x32_bf16 v[108:111], v[56:59], v[88:91], v[108:111]
    v_cndmask_b32 v10, v172, v173, s[46:47]
    v_cndmask_b32 v11, v176, v177, s[46:47]
    v_mfma_f32_16x16x32_bf16 v[112:115], v[60:63], v[72:75], v[112:115]
    v_cndmask_b32 v10, v10, v174, s[48:49]
    v_cndmask_b32 v11, v11, v178, s[48:49]
    v_mfma_f32_16x16x32_bf16 v[116:119], v[60:63], v[76:79], v[116:119]
    v_cndmask_b32 v10, v10, v175, s[50:51]
    v_cndmask_b32 v11, v11, v179, s[50:51]
    v_mfma_f32_16x16x32_bf16 v[120:123], v[60:63], v[80:83], v[120:123]
    v_fma_f32 v10, v10, s39, v8
    v_fma_f32 v11, v11, s39, v8
    v_add_u32 v6, 147456, v6
    v_mfma_f32_16x16x32_bf16 v[124:127], v[60:63], v[84:87], v[124:127]
    v_rsq_f32 v10, v10
    v_rsq_f32 v11, v11
    s_add_u32 s38, s38, 147456
    v_mfma_f32_16x16x32_bf16 v[128:131], v[60:63], v[88:91], v[128:131]
    ds_write_b32 v6, v10
    ds_write_b32 v6, v11 offset:64
    v_lshlrev_b32 v7, 4, v2
    v_mfma_f32_16x16x32_bf16 v[132:135], v[64:67], v[72:75], v[132:135]
    v_add_u32 v7, s38, v7
    v_xor_b32 v8, 0x80, v7
    v_mfma_f32_16x16x32_bf16 v[136:139], v[64:67], v[76:79], v[136:139]
    s_waitcnt lgkmcnt(0)
    s_barrier
    v_mfma_f32_16x16x32_bf16 v[140:143], v[64:67], v[80:83], v[140:143]
    ds_read_b128 v[20:23], v7 offset:0
    ds_read_b128 v[24:27], v7 offset:64
    ds_read_b128 v[28:31], v8 offset:0
    ds_read_b128 v[32:35], v8 offset:64
    v_mfma_f32_16x16x32_bf16 v[144:147], v[64:67], v[84:87], v[144:147]
    v_mfma_f32_16x16x32_bf16 v[148:151], v[64:67], v[88:91], v[148:151]
    v_mfma_f32_16x16x32_bf16 v[152:155], v[68:71], v[72:75], v[152:155]
    v_mfma_f32_16x16x32_bf16 v[156:159], v[68:71], v[76:79], v[156:159]
    v_mfma_f32_16x16x32_bf16 v[160:163], v[68:71], v[80:83], v[160:163]
    v_mfma_f32_16x16x32_bf16 v[164:167], v[68:71], v[84:87], v[164:167]
    v_mfma_f32_16x16x32_bf16 v[168:171], v[68:71], v[88:91], v[168:171]
    s_lshl_b32 s38, s27, 2
    s_add_u32 s38, s38, s3
    s_xor_b32 s39, s38, 1
    s_and_b32 s40, s28, 3
    s_lshl_b32 s40, s40, 1
    s_add_u32 s40, s40, s30
    s_lshl_b32 s40, s40, 8
    s_add_u32 s41, s40, s39
    s_add_u32 s40, s40, s38
    s_movk_i32 s42, 2560
    s_mov_b32 s43, 16777216
    s_cmp_lt_u32 s28, 4
    s_cselect_b32 s42, 1280, s42
    s_cselect_b32 s43, 12582912, s43
    s_mul_i32 s40, s40, s42
    s_mul_i32 s41, s41, s42
    s_add_u32 s40, s40, s43
    s_add_u32 s41, s41, s43
    s_lshl_b32 s42, s42, 6
    v_lshrrev_b32 v3, 5, v0
    v_mul_u32_u24 v3, 640, v3
    v_and_b32 v4, 1, v2
    v_mul_u32_u24 v4, 320, v4
    v_add_u32 v3, v3, v4
    v_and_b32 v4, 3, v1
    v_lshl_add_u32 v4, v4, 4, v3
    v_lshl_add_u32 v3, v1, 4, v3
    v_lshrrev_b32 v6, 2, v1
    v_mul_u32_u24 v6, 163840, v6
    v_add_u32 v4, v4, v6
    s_waitcnt lgkmcnt(0)
    v_pk_mul_f32 v[108:109], v[108:109], v[20:21]
    v_pk_mul_f32 v[110:111], v[110:111], v[22:23]
    v_pk_mul_f32 v[128:129], v[128:129], v[24:25]
    v_pk_mul_f32 v[130:131], v[130:131], v[26:27]
    v_cvt_pk_bf16_f32 v108, v108, v109
    v_cvt_pk_bf16_f32 v109, v110, v111
    v_cvt_pk_bf16_f32 v110, v128, v129
    v_cvt_pk_bf16_f32 v111, v130, v131
    s_nop 1
    v_permlane32_swap_b32 v108, v110
    v_permlane32_swap_b32 v109, v111
    buffer_store_dwordx4 v[108:111], v4, s[4:7], s40 offen offset:1536 sc1
    v_pk_mul_f32 v[92:93], v[92:93], v[20:21]
    v_pk_mul_f32 v[94:95], v[94:95], v[22:23]
    v_pk_mul_f32 v[112:113], v[112:113], v[24:25]
    v_pk_mul_f32 v[114:115], v[114:115], v[26:27]
    v_cvt_pk_bf16_f32 v92, v92, v93
    v_cvt_pk_bf16_f32 v93, v94, v95
    v_cvt_pk_bf16_f32 v94, v112, v113
    v_cvt_pk_bf16_f32 v95, v114, v115
    s_nop 1
    v_permlane32_swap_b32 v92, v94
    v_permlane32_swap_b32 v93, v95
    buffer_store_dwordx4 v[92:95], v3, s[4:7], s40 offen offset:1280 sc1
    s_add_u32 s40, s40, s42
    v_pk_mul_f32 v[96:97], v[96:97], v[20:21]
    v_pk_mul_f32 v[98:99], v[98:99], v[22:23]
    v_pk_mul_f32 v[116:117], v[116:117], v[24:25]
    v_pk_mul_f32 v[118:119], v[118:119], v[26:27]
    v_cvt_pk_bf16_f32 v96, v96, v97
    v_cvt_pk_bf16_f32 v97, v98, v99
    v_cvt_pk_bf16_f32 v98, v116, v117
    v_cvt_pk_bf16_f32 v99, v118, v119
    s_nop 1
    v_permlane32_swap_b32 v96, v98
    v_permlane32_swap_b32 v97, v99
    buffer_store_dwordx4 v[96:99], v3, s[4:7], s40 offen offset:1280 sc1
    s_add_u32 s40, s40, s42
    v_pk_mul_f32 v[100:101], v[100:101], v[20:21]
    v_pk_mul_f32 v[102:103], v[102:103], v[22:23]
    v_pk_mul_f32 v[120:121], v[120:121], v[24:25]
    v_pk_mul_f32 v[122:123], v[122:123], v[26:27]
    v_cvt_pk_bf16_f32 v100, v100, v101
    v_cvt_pk_bf16_f32 v101, v102, v103
    v_cvt_pk_bf16_f32 v102, v120, v121
    v_cvt_pk_bf16_f32 v103, v122, v123
    s_nop 1
    v_permlane32_swap_b32 v100, v102
    v_permlane32_swap_b32 v101, v103
    buffer_store_dwordx4 v[100:103], v3, s[4:7], s40 offen offset:1280 sc1
    s_add_u32 s40, s40, s42
    v_pk_mul_f32 v[104:105], v[104:105], v[20:21]
    v_pk_mul_f32 v[106:107], v[106:107], v[22:23]
    v_pk_mul_f32 v[124:125], v[124:125], v[24:25]
    v_pk_mul_f32 v[126:127], v[126:127], v[26:27]
    v_cvt_pk_bf16_f32 v104, v104, v105
    v_cvt_pk_bf16_f32 v105, v106, v107
    v_cvt_pk_bf16_f32 v106, v124, v125
    v_cvt_pk_bf16_f32 v107, v126, v127
    s_nop 1
    v_permlane32_swap_b32 v104, v106
    v_permlane32_swap_b32 v105, v107
    buffer_store_dwordx4 v[104:107], v3, s[4:7], s40 offen offset:1280 sc1
    v_pk_mul_f32 v[148:149], v[148:149], v[28:29]
    v_pk_mul_f32 v[150:151], v[150:151], v[30:31]
    v_pk_mul_f32 v[168:169], v[168:169], v[32:33]
    v_pk_mul_f32 v[170:171], v[170:171], v[34:35]
    v_cvt_pk_bf16_f32 v148, v148, v149
    v_cvt_pk_bf16_f32 v149, v150, v151
    v_cvt_pk_bf16_f32 v150, v168, v169
    v_cvt_pk_bf16_f32 v151, v170, v171
    s_nop 1
    v_permlane32_swap_b32 v148, v150
    v_permlane32_swap_b32 v149, v151
    buffer_store_dwordx4 v[148:151], v4, s[4:7], s41 offen offset:1536 sc1
    v_pk_mul_f32 v[132:133], v[132:133], v[28:29]
    v_pk_mul_f32 v[134:135], v[134:135], v[30:31]
    v_pk_mul_f32 v[152:153], v[152:153], v[32:33]
    v_pk_mul_f32 v[154:155], v[154:155], v[34:35]
    v_cvt_pk_bf16_f32 v132, v132, v133
    v_cvt_pk_bf16_f32 v133, v134, v135
    v_cvt_pk_bf16_f32 v134, v152, v153
    v_cvt_pk_bf16_f32 v135, v154, v155
    s_nop 1
    v_permlane32_swap_b32 v132, v134
    v_permlane32_swap_b32 v133, v135
    buffer_store_dwordx4 v[132:135], v3, s[4:7], s41 offen offset:1280 sc1
    s_add_u32 s41, s41, s42
    v_pk_mul_f32 v[136:137], v[136:137], v[28:29]
    v_pk_mul_f32 v[138:139], v[138:139], v[30:31]
    v_pk_mul_f32 v[156:157], v[156:157], v[32:33]
    v_pk_mul_f32 v[158:159], v[158:159], v[34:35]
    v_cvt_pk_bf16_f32 v136, v136, v137
    v_cvt_pk_bf16_f32 v137, v138, v139
    v_cvt_pk_bf16_f32 v138, v156, v157
    v_cvt_pk_bf16_f32 v139, v158, v159
    s_nop 1
    v_permlane32_swap_b32 v136, v138
    v_permlane32_swap_b32 v137, v139
    buffer_store_dwordx4 v[136:139], v3, s[4:7], s41 offen offset:1280 sc1
    s_add_u32 s41, s41, s42
    v_pk_mul_f32 v[140:141], v[140:141], v[28:29]
    v_pk_mul_f32 v[142:143], v[142:143], v[30:31]
    v_pk_mul_f32 v[160:161], v[160:161], v[32:33]
    v_pk_mul_f32 v[162:163], v[162:163], v[34:35]
    v_cvt_pk_bf16_f32 v140, v140, v141
    v_cvt_pk_bf16_f32 v141, v142, v143
    v_cvt_pk_bf16_f32 v142, v160, v161
    v_cvt_pk_bf16_f32 v143, v162, v163
    s_nop 1
    v_permlane32_swap_b32 v140, v142
    v_permlane32_swap_b32 v141, v143
    buffer_store_dwordx4 v[140:143], v3, s[4:7], s41 offen offset:1280 sc1
    s_add_u32 s41, s41, s42
    v_pk_mul_f32 v[144:145], v[144:145], v[28:29]
    v_pk_mul_f32 v[146:147], v[146:147], v[30:31]
    v_pk_mul_f32 v[164:165], v[164:165], v[32:33]
    v_pk_mul_f32 v[166:167], v[166:167], v[34:35]
    v_cvt_pk_bf16_f32 v144, v144, v145
    v_cvt_pk_bf16_f32 v145, v146, v147
    v_cvt_pk_bf16_f32 v146, v164, v165
    v_cvt_pk_bf16_f32 v147, v166, v167
    s_nop 1
    v_permlane32_swap_b32 v144, v146
    v_permlane32_swap_b32 v145, v147
    buffer_store_dwordx4 v[144:147], v3, s[4:7], s41 offen offset:1280 sc1
    s_endpgm

.p2align 8
code_end:
.section .rodata,"a"
.p2align 6
.amdhsa_kernel k1_kernel
  .amdhsa_next_free_vgpr 168
  .amdhsa_next_free_sgpr 96
  .amdhsa_accum_offset 168
  .amdhsa_group_segment_fixed_size 0
  .amdhsa_kernarg_size 72
  .amdhsa_user_sgpr_count 2
  .amdhsa_user_sgpr_kernarg_segment_ptr 1
  .amdhsa_system_sgpr_workgroup_id_x 1
.end_amdhsa_kernel

.p2align 6
.amdhsa_kernel k2_kernel
  .amdhsa_next_free_vgpr 208
  .amdhsa_next_free_sgpr 96
  .amdhsa_accum_offset 208
  .amdhsa_group_segment_fixed_size 0
  .amdhsa_kernarg_size 72
  .amdhsa_user_sgpr_count 2
  .amdhsa_user_sgpr_kernarg_segment_ptr 1
  .amdhsa_system_sgpr_workgroup_id_x 1
.end_amdhsa_kernel

.p2align 6
.amdhsa_kernel k3_kernel
  .amdhsa_next_free_vgpr 184
  .amdhsa_next_free_sgpr 96
  .amdhsa_accum_offset 184
  .amdhsa_group_segment_fixed_size 0
  .amdhsa_kernarg_size 72
  .amdhsa_user_sgpr_count 2
  .amdhsa_user_sgpr_kernarg_segment_ptr 1
  .amdhsa_system_sgpr_workgroup_id_x 1
.end_amdhsa_kernel

.p2align 6
.amdhsa_kernel k4_kernel
  .amdhsa_next_free_vgpr 240
  .amdhsa_next_free_sgpr 96
  .amdhsa_accum_offset 140
  .amdhsa_group_segment_fixed_size 0
  .amdhsa_kernarg_size 72
  .amdhsa_user_sgpr_count 2
  .amdhsa_user_sgpr_kernarg_segment_ptr 1
  .amdhsa_system_sgpr_workgroup_id_x 1
.end_amdhsa_kernel

.p2align 6
.amdhsa_kernel k6_kernel
  .amdhsa_next_free_vgpr 168
  .amdhsa_next_free_sgpr 96
  .amdhsa_accum_offset 168
  .amdhsa_group_segment_fixed_size 0
  .amdhsa_kernarg_size 72
  .amdhsa_user_sgpr_count 2
  .amdhsa_user_sgpr_kernarg_segment_ptr 1
  .amdhsa_system_sgpr_workgroup_id_x 1
.end_amdhsa_kernel

.p2align 6
.amdhsa_kernel k7_kernel
  .amdhsa_next_free_vgpr 184
  .amdhsa_next_free_sgpr 96
  .amdhsa_accum_offset 184
  .amdhsa_group_segment_fixed_size 0
  .amdhsa_kernarg_size 72
  .amdhsa_user_sgpr_count 2
  .amdhsa_user_sgpr_kernarg_segment_ptr 1
  .amdhsa_system_sgpr_workgroup_id_x 1
.end_amdhsa_kernel
```
